```python
import torch

def _softmax(x, axis=-1):
    return torch.softmax(x, dim=axis)

def _gelu(x):
    return torch.nn.functional.gelu(x, approximate='tanh')

def _silu(x):
    return torch.nn.functional.silu(x)

def _sigmoid(x):
    return torch.sigmoid(x)

def _layernorm(x, axis=-1, eps=1e-05):
    m = x.mean(dim=axis, keepdim=True)
    v = x.var(dim=axis, keepdim=True, unbiased=False)
    return (x - m) / torch.sqrt(v + eps)

def _scatter_add(tgt, idx, src, axis=0):
    return tgt.clone().index_add_(axis, idx, src)

def _segment_sum(src, seg, n):
    out = torch.zeros((n,) + src.shape[1:], dtype=src.dtype)
    return out.index_add_(0, seg, src)

def _pad(x, pw):
    flat = tuple((v for pair in reversed(pw) for v in pair))
    return torch.nn.functional.pad(x, flat)
kernel_name = 'gated_mix__sliding_local_dilated__mixer_gmlp__prompt'

def setup_inputs():

    _w = lambda a: (lambda t: t.to(torch.bfloat16) if t.is_floating_point() else t)(torch.as_tensor(a))

    def _A_setup():
        B, S, D = (1, 2048, 640)
        return {'x': _w((lambda *s: torch.randn(*s, dtype=torch.bfloat16) * 0.05)(B, S, D)), 'wqkv': _w((lambda *s: torch.randn(*s, dtype=torch.bfloat16) * 0.8)(D, 3 * D)), 'wo': _w((lambda *s: torch.randn(*s, dtype=torch.bfloat16) * 0.05)(D, D))}
    _A_in = _A_setup()

    def _B_setup():
        B, S, D, F = (1, 2048, 640, 1536)
        Fh = F // 2
        return {'x': _w((lambda *s: torch.randn(*s, dtype=torch.bfloat16) * 0.05)(B, S, D)), 'w_in': _w((lambda *s: torch.randn(*s, dtype=torch.bfloat16) * 0.8)(D, 2 * Fh)), 'w_sp': _w(0.01 * (lambda *s: torch.randn(*s, dtype=torch.bfloat16) * 0.8)(S, S)), 'b_sp': _w(1.0 + 0.01 * (lambda *s: torch.randn(*s, dtype=torch.bfloat16) * 0.05)(S)), 'w_out': _w((lambda *s: torch.randn(*s, dtype=torch.bfloat16) * 0.05)(Fh, D))}
    _B_in = _B_setup()
    return {'A_x': _A_in['x'], 'A_wqkv': _A_in['wqkv'], 'A_wo': _A_in['wo'], 'B_x': _B_in['x'], 'B_w_in': _B_in['w_in'], 'B_w_sp': _B_in['w_sp'], 'B_b_sp': _B_in['b_sp'], 'B_w_out': _B_in['w_out'], 'gate_w': _w((lambda *s: torch.randn(*s, dtype=torch.bfloat16) * 0.05)(640) * 16.0)}

def reference(A_x, A_wqkv, A_wo, B_x, B_w_in, B_w_sp, B_b_sp, B_w_out, gate_w):

    def _A_ref(x, wqkv, wo):
        B, S, D = x.shape
        H = 32
        Dh = D // H
        W, dil = (8, 2)
        qkv = (lambda x, *d: x.permute(*d))((x @ wqkv).reshape(B, S, 3, H, Dh), 2, 0, 3, 1, 4)
        q, k, v = (qkv[0], qkv[1], qkv[2])
        scale = Dh ** (-0.5)
        pos = torch.arange(S)
        off = torch.arange(W) * dil
        idx = pos[:, None] - off[None, :]
        mask = idx >= 0
        idx_c = torch.where(mask, idx, 0).reshape(-1)
        kg = k[:, :, idx_c, :].reshape(B, H, S, W, Dh)
        vg = v[:, :, idx_c, :].reshape(B, H, S, W, Dh)
        logits = torch.einsum('bhsd,bhswd->bhsw', q, kg) * scale
        logits = torch.where(mask[None, None, :, :], logits, -1000000000.0)
        attn = _softmax(logits, axis=-1)
        o = torch.einsum('bhsw,bhswd->bhsd', attn, vg)
        return (lambda x, *d: x.permute(*d))(o, 0, 2, 1, 3).reshape(B, S, D) @ wo

    def _B_ref(x, w_in, w_sp, b_sp, w_out):
        B, S, D = x.shape
        F = w_in.shape[-1]
        Fh = F // 2
        z = _gelu(torch.einsum('bsd,df->bsf', x, w_in))
        z1 = z[..., :Fh].clone()
        z2 = _layernorm(z[..., Fh:], axis=-1)
        g = torch.einsum('ts,bsf->btf', w_sp, z2) + b_sp[None, :, None]
        return torch.einsum('bsf,fd->bsd', z1 * g, w_out)
    x = A_x
    g = _sigmoid((x * gate_w).sum(-1, keepdims=True))
    a = _A_ref(x, A_wqkv, A_wo)
    b = _B_ref(x, B_w_in, B_w_sp, B_b_sp, B_w_out)
    return g * a + (1 - g) * b
```

```asm
; @launch grid=(256,1,1) block=(512,1,1) lds=163840
.amdgcn_target "amdgcn-amd-amdhsa--gfx950"
.text
.globl gated_mix__sliding_local_dilated__mixer_gmlp__prompt_kernel
.p2align 8
.type gated_mix__sliding_local_dilated__mixer_gmlp__prompt_kernel,@function
gated_mix__sliding_local_dilated__mixer_gmlp__prompt_kernel:
    s_cmp_ge_u32 s2, 256
    s_cbranch_scc1 Lexit_147
    s_load_dwordx16 s[36:51], s[0:1], 0
    s_load_dwordx8 s[52:59], s[0:1], 64
    v_lshrrev_b32 v1, 6, v0
    v_and_b32 v0, 63, v0
    v_readfirstlane_b32 s3, v1
    s_waitcnt lgkmcnt(0)
    s_mov_b32 s99, 4096
    s_and_b32 s6, s2, 7
    s_lshr_b32 s7, s2, 3
    s_lshr_b32 s4, s6, 1
    s_lshl_b32 s4, s4, 3
    s_lshr_b32 s5, s7, 2
    s_add_u32 s4, s4, s5
    s_and_b32 s5, s6, 1
    s_lshl_b32 s5, s5, 2
    s_and_b32 s7, s7, 3
    s_add_u32 s5, s5, s7
    s_mov_b32 s60, s4
    s_mov_b32 s61, s5
    s_and_b32 s6, s2, 7
    s_lshr_b32 s7, s2, 3
    s_and_b32 s4, s6, 2
    s_lshl_b32 s4, s4, 2
    s_lshr_b32 s5, s7, 2
    s_add_u32 s4, s4, s5
    s_and_b32 s5, s6, 1
    s_lshl_b32 s5, s5, 2
    s_and_b32 s7, s7, 3
    s_add_u32 s5, s5, s7
    s_lshr_b32 s6, s6, 2
    s_lshr_b32 s7, s2, 5
    s_and_b32 s7, s7, 7
    s_lshr_b32 s16, s2, 3
    s_and_b32 s16, s16, 3
    s_mul_i32 s16, s16, 3
    s_add_u32 s7, s7, s16
    s_cmp_ge_u32 s7, 10
    s_cselect_b32 s16, 10, 0
    s_sub_u32 s7, s7, s16
    s_cmp_ge_u32 s3, 4
    s_cbranch_scc1 Lprio_148
    s_setprio 1
Lprio_148:
    s_mov_b32 s100, 0
    s_mov_b32 s101, 0
    s_cmp_ge_u32 s3, 4
    s_cbranch_scc1 Lnotc_152
    s_lshl_b32 s16, s2, 3
    s_add_u32 s16, s16, s3
    s_cmp_lg_u32 s16, 3
    s_cbranch_scc1 Lpub_153
    s_mov_b32 s28, s56
    s_mov_b32 s29, s57
    s_mov_b32 s30, 256
    s_mov_b32 s31, 0x00020000
    s_memrealtime s[32:33]
    s_waitcnt lgkmcnt(0)
    s_or_b32 s32, s32, 1
    v_mov_b32 v6, 0
    v_mov_b32 v7, s32
    buffer_store_dword v7, v6, s[28:31], 0 offen sc1
Lpub_153:
    s_cmp_lg_u32 s3, 3
    s_cbranch_scc1 Lw3_154
    s_getpc_b64 s[16:17]
Lpc_155:
    s_sub_u32 s16, s16, Lpc_155-gated_mix__sliding_local_dilated__mixer_gmlp__prompt_kernel
    s_subb_u32 s17, s17, 0
    s_lshr_b32 s18, s2, 3
    s_mul_i32 s18, s18, 1792
    v_lshlrev_b32 v240, 7, v0
    v_add_u32 v240, s18, v240
    v_cmp_gt_u32 vcc, 14, v0
    s_nop 1
    s_and_saveexec_b64 s[18:19], vcc
    v_min_u32 v240, 55836, v240
    global_load_dword v255, v240, s[16:17]
    s_mov_b64 exec, s[18:19]
Lw3_154:
Lnotc_152:
    s_cmp_eq_u32 s6, 1
    s_cbranch_scc1 Lz_role_151
    s_cmp_eq_u32 s3, 7
    s_cbranch_scc1 Lq_x_157
    s_cmp_ge_u32 s3, 4
    s_cbranch_scc1 Lq_w_156
    v_and_b32 v1, 15, v0
    v_lshrrev_b32 v2, 4, v0
    v_lshrrev_b32 v3, 1, v1
    v_xor_b32 v3, v3, v2
    v_lshlrev_b32 v3, 4, v3
    v_lshl_add_u32 v226, v1, 7, v3
    v_xor_b32 v227, 64, v226
    v_lshrrev_b32 v3, 2, v1
    v_lshl_add_u32 v3, v2, 3, v3
    s_movk_i32 s19, 576
    v_mul_u32_u24 v3, s19, v3
    v_and_b32 v4, 3, v1
    v_lshl_add_u32 v3, v4, 3, v3
    s_and_b32 s20, s5, 1
    s_lshl_b32 s21, s20, 5
    v_add_u32 v3, s21, v3
    v_and_b32 v4, 1, v2
    v_lshlrev_b32 v4, 5, v4
    s_lshl_b32 s21, s3, 2
    s_add_u32 s21, s21, 0
    s_mul_i32 s22, s21, 52
    s_lshr_b32 s22, s22, 8
    s_mul_i32 s23, s22, 5
    s_sub_u32 s23, s21, s23
    s_mul_i32 s22, s22, 6
    s_add_u32 s22, s22, s23
    s_lshl_b32 s22, s22, 5
    s_add_u32 s23, s23, s20
    s_and_b32 s23, s23, 1
    v_add_u32 v5, v3, v4
    v_sub_u32 v6, v3, v4
    s_cmp_eq_u32 s23, 0
    s_cselect_b64 vcc, -1, 0
    v_cndmask_b32 v5, v6, v5, vcc
    v_add_u32 v220, s22, v5
    s_lshl_b32 s21, s3, 2
    s_add_u32 s21, s21, 1
    s_mul_i32 s22, s21, 52
    s_lshr_b32 s22, s22, 8
    s_mul_i32 s23, s22, 5
    s_sub_u32 s23, s21, s23
    s_mul_i32 s22, s22, 6
    s_add_u32 s22, s22, s23
    s_lshl_b32 s22, s22, 5
    s_add_u32 s23, s23, s20
    s_and_b32 s23, s23, 1
    v_add_u32 v5, v3, v4
    v_sub_u32 v6, v3, v4
    s_cmp_eq_u32 s23, 0
    s_cselect_b64 vcc, -1, 0
    v_cndmask_b32 v5, v6, v5, vcc
    v_add_u32 v221, s22, v5
    s_lshl_b32 s21, s3, 2
    s_add_u32 s21, s21, 2
    s_mul_i32 s22, s21, 52
    s_lshr_b32 s22, s22, 8
    s_mul_i32 s23, s22, 5
    s_sub_u32 s23, s21, s23
    s_mul_i32 s22, s22, 6
    s_add_u32 s22, s22, s23
    s_lshl_b32 s22, s22, 5
    s_add_u32 s23, s23, s20
    s_and_b32 s23, s23, 1
    v_add_u32 v5, v3, v4
    v_sub_u32 v6, v3, v4
    s_cmp_eq_u32 s23, 0
    s_cselect_b64 vcc, -1, 0
    v_cndmask_b32 v5, v6, v5, vcc
    v_add_u32 v222, s22, v5
    s_lshl_b32 s21, s3, 2
    s_add_u32 s21, s21, 3
    s_mul_i32 s22, s21, 52
    s_lshr_b32 s22, s22, 8
    s_mul_i32 s23, s22, 5
    s_sub_u32 s23, s21, s23
    s_mul_i32 s22, s22, 6
    s_add_u32 s22, s22, s23
    s_lshl_b32 s22, s22, 5
    s_add_u32 s23, s23, s20
    s_and_b32 s23, s23, 1
    v_add_u32 v5, v3, v4
    v_sub_u32 v6, v3, v4
    s_cmp_eq_u32 s23, 0
    s_cselect_b64 vcc, -1, 0
    v_cndmask_b32 v5, v6, v5, vcc
    v_add_u32 v223, s22, v5
    s_cmp_eq_u32 s3, 3
    s_cbranch_scc1 Lq_c3_160
    v_mov_b32 v16, 0
    v_mov_b32 v17, 0
    v_mov_b32 v18, 0
    v_mov_b32 v19, 0
    v_mov_b32 v20, 0
    v_mov_b32 v21, 0
    v_mov_b32 v22, 0
    v_mov_b32 v23, 0
    v_mov_b32 v24, 0
    v_mov_b32 v25, 0
    v_mov_b32 v26, 0
    v_mov_b32 v27, 0
    v_mov_b32 v28, 0
    v_mov_b32 v29, 0
    v_mov_b32 v30, 0
    v_mov_b32 v31, 0
    v_mov_b32 v32, 0
    v_mov_b32 v33, 0
    v_mov_b32 v34, 0
    v_mov_b32 v35, 0
    v_mov_b32 v36, 0
    v_mov_b32 v37, 0
    v_mov_b32 v38, 0
    v_mov_b32 v39, 0
    v_mov_b32 v40, 0
    v_mov_b32 v41, 0
    v_mov_b32 v42, 0
    v_mov_b32 v43, 0
    v_mov_b32 v44, 0
    v_mov_b32 v45, 0
    v_mov_b32 v46, 0
    v_mov_b32 v47, 0
    v_mov_b32 v48, 0
    v_mov_b32 v49, 0
    v_mov_b32 v50, 0
    v_mov_b32 v51, 0
    v_mov_b32 v52, 0
    v_mov_b32 v53, 0
    v_mov_b32 v54, 0
    v_mov_b32 v55, 0
    v_mov_b32 v56, 0
    v_mov_b32 v57, 0
    v_mov_b32 v58, 0
    v_mov_b32 v59, 0
    v_mov_b32 v60, 0
    v_mov_b32 v61, 0
    v_mov_b32 v62, 0
    v_mov_b32 v63, 0
    v_mov_b32 v64, 0
    v_mov_b32 v65, 0
    v_mov_b32 v66, 0
    v_mov_b32 v67, 0
    v_mov_b32 v68, 0
    v_mov_b32 v69, 0
    v_mov_b32 v70, 0
    v_mov_b32 v71, 0
    v_mov_b32 v72, 0
    v_mov_b32 v73, 0
    v_mov_b32 v74, 0
    v_mov_b32 v75, 0
    v_mov_b32 v76, 0
    v_mov_b32 v77, 0
    v_mov_b32 v78, 0
    v_mov_b32 v79, 0
    v_mov_b32 v80, 0
    v_mov_b32 v81, 0
    v_mov_b32 v82, 0
    v_mov_b32 v83, 0
    v_mov_b32 v84, 0
    v_mov_b32 v85, 0
    v_mov_b32 v86, 0
    v_mov_b32 v87, 0
    v_mov_b32 v88, 0
    v_mov_b32 v89, 0
    v_mov_b32 v90, 0
    v_mov_b32 v91, 0
    v_mov_b32 v92, 0
    v_mov_b32 v93, 0
    v_mov_b32 v94, 0
    v_mov_b32 v95, 0
    v_mov_b32 v96, 0
    v_mov_b32 v97, 0
    v_mov_b32 v98, 0
    v_mov_b32 v99, 0
    v_mov_b32 v100, 0
    v_mov_b32 v101, 0
    v_mov_b32 v102, 0
    v_mov_b32 v103, 0
    v_mov_b32 v104, 0
    v_mov_b32 v105, 0
    v_mov_b32 v106, 0
    v_mov_b32 v107, 0
    v_mov_b32 v108, 0
    v_mov_b32 v109, 0
    v_mov_b32 v110, 0
    v_mov_b32 v111, 0
    v_mov_b32 v112, 0
    v_mov_b32 v113, 0
    v_mov_b32 v114, 0
    v_mov_b32 v115, 0
    v_mov_b32 v116, 0
    v_mov_b32 v117, 0
    v_mov_b32 v118, 0
    v_mov_b32 v119, 0
    v_mov_b32 v120, 0
    v_mov_b32 v121, 0
    v_mov_b32 v122, 0
    v_mov_b32 v123, 0
    v_mov_b32 v124, 0
    v_mov_b32 v125, 0
    v_mov_b32 v126, 0
    v_mov_b32 v127, 0
    v_mov_b32 v128, 0
    v_mov_b32 v129, 0
    v_mov_b32 v130, 0
    v_mov_b32 v131, 0
    v_mov_b32 v132, 0
    v_mov_b32 v133, 0
    v_mov_b32 v134, 0
    v_mov_b32 v135, 0
    v_mov_b32 v136, 0
    v_mov_b32 v137, 0
    v_mov_b32 v138, 0
    v_mov_b32 v139, 0
    v_mov_b32 v140, 0
    v_mov_b32 v141, 0
    v_mov_b32 v142, 0
    v_mov_b32 v143, 0
    v_mov_b32 v144, 0
    v_mov_b32 v145, 0
    v_mov_b32 v146, 0
    v_mov_b32 v147, 0
    v_mov_b32 v148, 0
    v_mov_b32 v149, 0
    v_mov_b32 v150, 0
    v_mov_b32 v151, 0
    v_mov_b32 v152, 0
    v_mov_b32 v153, 0
    v_mov_b32 v154, 0
    v_mov_b32 v155, 0
    v_mov_b32 v156, 0
    v_mov_b32 v157, 0
    v_mov_b32 v158, 0
    v_mov_b32 v159, 0
    s_mov_b32 s22, 0
    s_mov_b32 s23, 92160
    s_mov_b32 s24, 0
    v_add_u32 v216, s22, v220
    v_add_u32 v217, s22, v221
    v_add_u32 v218, s22, v222
    v_add_u32 v219, s22, v223
    v_add_u32 v224, s23, v226
    v_add_u32 v225, s23, v227
    s_barrier
    ds_read_b64_tr_b16 v[160:161], v216 offset:0
    ds_read_b64_tr_b16 v[162:163], v216 offset:2304
    ds_read_b64_tr_b16 v[164:165], v217 offset:0
    ds_read_b64_tr_b16 v[166:167], v217 offset:2304
    ds_read_b64_tr_b16 v[168:169], v218 offset:0
    ds_read_b64_tr_b16 v[170:171], v218 offset:2304
    ds_read_b64_tr_b16 v[172:173], v219 offset:0
    ds_read_b64_tr_b16 v[174:175], v219 offset:2304
    ds_read_b128 v[192:195], v224 offset:0
    ds_read_b128 v[196:199], v224 offset:2048
    ds_read_b128 v[200:203], v224 offset:4096
    ds_read_b128 v[204:207], v224 offset:6144
Lqkv_161:
    s_cmp_lg_u32 s24, 3
    s_cbranch_scc1 Lmid_162
    s_lshl_b32 s26, s60, 18
    s_lshl_b32 s27, s61, 15
    s_add_u32 s26, s26, s27
    s_lshl_b32 s27, s3, 13
    s_add_u32 s26, s26, s27
    s_mov_b32 s28, s46
    s_mov_b32 s29, s47
    s_mov_b32 s30, 8388608
    s_mov_b32 s31, 0x00020000
    v_lshlrev_b32 v240, 7, v0
    buffer_load_dword v254, v240, s[28:31], s26 offen
    s_mov_b32 s28, s56
    s_mov_b32 s29, s57
    s_mov_b32 s30, 256
    s_mov_b32 s31, 0x00020000
    v_mov_b32 v14, 0
    buffer_load_dword v15, v14, s[28:31], 0 offen sc1
Lmid_162:
    s_waitcnt lgkmcnt(3)
    v_mfma_f32_16x16x32_bf16 v[16:19], v[160:163], v[192:195], v[16:19]
    ds_read_b128 v[208:211], v224 offset:8192
    v_mfma_f32_16x16x32_bf16 v[52:55], v[164:167], v[192:195], v[52:55]
    s_add_u32 s22, s22, 18432
    v_mfma_f32_16x16x32_bf16 v[88:91], v[168:171], v[192:195], v[88:91]
    s_cmp_eq_u32 s22, 92160
    s_cselect_b32 s22, 0, s22
    v_mfma_f32_16x16x32_bf16 v[124:127], v[172:175], v[192:195], v[124:127]
    s_waitcnt lgkmcnt(3)
    v_mfma_f32_16x16x32_bf16 v[20:23], v[160:163], v[196:199], v[20:23]
    ds_read_b128 v[212:215], v224 offset:10240
    v_add_u32 v216, s22, v220
    v_mfma_f32_16x16x32_bf16 v[56:59], v[164:167], v[196:199], v[56:59]
    v_add_u32 v217, s22, v221
    v_mfma_f32_16x16x32_bf16 v[92:95], v[168:171], v[196:199], v[92:95]
    v_add_u32 v218, s22, v222
    v_mfma_f32_16x16x32_bf16 v[128:131], v[172:175], v[196:199], v[128:131]
    v_add_u32 v219, s22, v223
    s_waitcnt lgkmcnt(3)
    v_mfma_f32_16x16x32_bf16 v[24:27], v[160:163], v[200:203], v[24:27]
    ds_read_b128 v[192:195], v224 offset:12288
    v_mfma_f32_16x16x32_bf16 v[60:63], v[164:167], v[200:203], v[60:63]
    v_mfma_f32_16x16x32_bf16 v[96:99], v[168:171], v[200:203], v[96:99]
    v_mfma_f32_16x16x32_bf16 v[132:135], v[172:175], v[200:203], v[132:135]
    s_barrier
    s_waitcnt lgkmcnt(3)
    v_mfma_f32_16x16x32_bf16 v[28:31], v[160:163], v[204:207], v[28:31]
    ds_read_b128 v[196:199], v224 offset:14336
    v_mfma_f32_16x16x32_bf16 v[64:67], v[164:167], v[204:207], v[64:67]
    ds_read_b64_tr_b16 v[176:177], v216 offset:0
    v_mfma_f32_16x16x32_bf16 v[100:103], v[168:171], v[204:207], v[100:103]
    ds_read_b64_tr_b16 v[178:179], v216 offset:2304
    v_mfma_f32_16x16x32_bf16 v[136:139], v[172:175], v[204:207], v[136:139]
    s_waitcnt lgkmcnt(5)
    v_mfma_f32_16x16x32_bf16 v[32:35], v[160:163], v[208:211], v[32:35]
    ds_read_b128 v[200:203], v224 offset:16384
    v_mfma_f32_16x16x32_bf16 v[68:71], v[164:167], v[208:211], v[68:71]
    ds_read_b64_tr_b16 v[180:181], v217 offset:0
    v_mfma_f32_16x16x32_bf16 v[104:107], v[168:171], v[208:211], v[104:107]
    ds_read_b64_tr_b16 v[182:183], v217 offset:2304
    v_mfma_f32_16x16x32_bf16 v[140:143], v[172:175], v[208:211], v[140:143]
    s_waitcnt lgkmcnt(7)
    v_mfma_f32_16x16x32_bf16 v[36:39], v[160:163], v[212:215], v[36:39]
    ds_read_b128 v[204:207], v225 offset:0
    v_mfma_f32_16x16x32_bf16 v[72:75], v[164:167], v[212:215], v[72:75]
    ds_read_b64_tr_b16 v[184:185], v218 offset:0
    v_mfma_f32_16x16x32_bf16 v[108:111], v[168:171], v[212:215], v[108:111]
    ds_read_b64_tr_b16 v[186:187], v218 offset:2304
    v_mfma_f32_16x16x32_bf16 v[144:147], v[172:175], v[212:215], v[144:147]
    s_waitcnt lgkmcnt(9)
    v_mfma_f32_16x16x32_bf16 v[40:43], v[160:163], v[192:195], v[40:43]
    ds_read_b128 v[208:211], v225 offset:2048
    v_mfma_f32_16x16x32_bf16 v[76:79], v[164:167], v[192:195], v[76:79]
    ds_read_b64_tr_b16 v[188:189], v219 offset:0
    v_mfma_f32_16x16x32_bf16 v[112:115], v[168:171], v[192:195], v[112:115]
    ds_read_b64_tr_b16 v[190:191], v219 offset:2304
    v_mfma_f32_16x16x32_bf16 v[148:151], v[172:175], v[192:195], v[148:151]
    s_waitcnt lgkmcnt(11)
    v_mfma_f32_16x16x32_bf16 v[44:47], v[160:163], v[196:199], v[44:47]
    ds_read_b128 v[212:215], v225 offset:4096
    v_mfma_f32_16x16x32_bf16 v[80:83], v[164:167], v[196:199], v[80:83]
    v_mfma_f32_16x16x32_bf16 v[116:119], v[168:171], v[196:199], v[116:119]
    v_mfma_f32_16x16x32_bf16 v[152:155], v[172:175], v[196:199], v[152:155]
    s_waitcnt lgkmcnt(9)
    v_mfma_f32_16x16x32_bf16 v[48:51], v[160:163], v[200:203], v[48:51]
    ds_read_b128 v[192:195], v225 offset:6144
    v_mfma_f32_16x16x32_bf16 v[84:87], v[164:167], v[200:203], v[84:87]
    v_mfma_f32_16x16x32_bf16 v[120:123], v[168:171], v[200:203], v[120:123]
    v_mfma_f32_16x16x32_bf16 v[156:159], v[172:175], v[200:203], v[156:159]
    s_waitcnt lgkmcnt(7)
    v_mfma_f32_16x16x32_bf16 v[16:19], v[176:179], v[204:207], v[16:19]
    ds_read_b128 v[196:199], v225 offset:8192
    v_mfma_f32_16x16x32_bf16 v[52:55], v[180:183], v[204:207], v[52:55]
    s_add_u32 s22, s22, 18432
    s_waitcnt lgkmcnt(6)
    v_mfma_f32_16x16x32_bf16 v[88:91], v[184:187], v[204:207], v[88:91]
    s_cmp_eq_u32 s22, 92160
    s_cselect_b32 s22, 0, s22
    s_waitcnt lgkmcnt(3)
    v_mfma_f32_16x16x32_bf16 v[124:127], v[188:191], v[204:207], v[124:127]
    v_mfma_f32_16x16x32_bf16 v[20:23], v[176:179], v[208:211], v[20:23]
    ds_read_b128 v[200:203], v225 offset:10240
    v_add_u32 v216, s22, v220
    v_mfma_f32_16x16x32_bf16 v[56:59], v[180:183], v[208:211], v[56:59]
    v_add_u32 v217, s22, v221
    v_mfma_f32_16x16x32_bf16 v[92:95], v[184:187], v[208:211], v[92:95]
    v_add_u32 v218, s22, v222
    v_mfma_f32_16x16x32_bf16 v[128:131], v[188:191], v[208:211], v[128:131]
    v_add_u32 v219, s22, v223
    s_waitcnt lgkmcnt(3)
    v_mfma_f32_16x16x32_bf16 v[24:27], v[176:179], v[212:215], v[24:27]
    ds_read_b128 v[204:207], v225 offset:12288
    v_mfma_f32_16x16x32_bf16 v[60:63], v[180:183], v[212:215], v[60:63]
    s_add_u32 s23, s23, 18432
    v_mfma_f32_16x16x32_bf16 v[96:99], v[184:187], v[212:215], v[96:99]
    s_cmp_eq_u32 s23, 147456
    s_cselect_b32 s23, 92160, s23
    v_mfma_f32_16x16x32_bf16 v[132:135], v[188:191], v[212:215], v[132:135]
    s_barrier
    s_waitcnt lgkmcnt(3)
    v_mfma_f32_16x16x32_bf16 v[28:31], v[176:179], v[192:195], v[28:31]
    ds_read_b128 v[208:211], v225 offset:14336
    v_mfma_f32_16x16x32_bf16 v[64:67], v[180:183], v[192:195], v[64:67]
    ds_read_b64_tr_b16 v[160:161], v216 offset:0
    v_mfma_f32_16x16x32_bf16 v[100:103], v[184:187], v[192:195], v[100:103]
    ds_read_b64_tr_b16 v[162:163], v216 offset:2304
    v_mfma_f32_16x16x32_bf16 v[136:139], v[188:191], v[192:195], v[136:139]
    s_waitcnt lgkmcnt(5)
    v_mfma_f32_16x16x32_bf16 v[32:35], v[176:179], v[196:199], v[32:35]
    ds_read_b128 v[212:215], v225 offset:16384
    v_mfma_f32_16x16x32_bf16 v[68:71], v[180:183], v[196:199], v[68:71]
    ds_read_b64_tr_b16 v[164:165], v217 offset:0
    v_add_u32 v224, s23, v226
    v_mfma_f32_16x16x32_bf16 v[104:107], v[184:187], v[196:199], v[104:107]
    ds_read_b64_tr_b16 v[166:167], v217 offset:2304
    v_mfma_f32_16x16x32_bf16 v[140:143], v[188:191], v[196:199], v[140:143]
    v_add_u32 v225, s23, v227
    s_waitcnt lgkmcnt(7)
    v_mfma_f32_16x16x32_bf16 v[36:39], v[176:179], v[200:203], v[36:39]
    ds_read_b128 v[192:195], v224 offset:0
    v_mfma_f32_16x16x32_bf16 v[72:75], v[180:183], v[200:203], v[72:75]
    ds_read_b64_tr_b16 v[168:169], v218 offset:0
    v_mfma_f32_16x16x32_bf16 v[108:111], v[184:187], v[200:203], v[108:111]
    ds_read_b64_tr_b16 v[170:171], v218 offset:2304
    v_mfma_f32_16x16x32_bf16 v[144:147], v[188:191], v[200:203], v[144:147]
    s_waitcnt lgkmcnt(9)
    v_mfma_f32_16x16x32_bf16 v[40:43], v[176:179], v[204:207], v[40:43]
    ds_read_b128 v[196:199], v224 offset:2048
    v_mfma_f32_16x16x32_bf16 v[76:79], v[180:183], v[204:207], v[76:79]
    ds_read_b64_tr_b16 v[172:173], v219 offset:0
    v_mfma_f32_16x16x32_bf16 v[112:115], v[184:187], v[204:207], v[112:115]
    ds_read_b64_tr_b16 v[174:175], v219 offset:2304
    v_mfma_f32_16x16x32_bf16 v[148:151], v[188:191], v[204:207], v[148:151]
    s_waitcnt lgkmcnt(11)
    v_mfma_f32_16x16x32_bf16 v[44:47], v[176:179], v[208:211], v[44:47]
    ds_read_b128 v[200:203], v224 offset:4096
    v_mfma_f32_16x16x32_bf16 v[80:83], v[180:183], v[208:211], v[80:83]
    v_mfma_f32_16x16x32_bf16 v[116:119], v[184:187], v[208:211], v[116:119]
    v_mfma_f32_16x16x32_bf16 v[152:155], v[188:191], v[208:211], v[152:155]
    s_waitcnt lgkmcnt(9)
    v_mfma_f32_16x16x32_bf16 v[48:51], v[176:179], v[212:215], v[48:51]
    ds_read_b128 v[204:207], v224 offset:6144
    v_mfma_f32_16x16x32_bf16 v[84:87], v[180:183], v[212:215], v[84:87]
    v_mfma_f32_16x16x32_bf16 v[120:123], v[184:187], v[212:215], v[120:123]
    v_mfma_f32_16x16x32_bf16 v[156:159], v[188:191], v[212:215], v[156:159]
    s_add_u32 s24, s24, 1
    s_cmp_lt_u32 s24, 9
    s_cbranch_scc1 Lqkv_161
    s_waitcnt lgkmcnt(7)
    v_mfma_f32_16x16x32_bf16 v[16:19], v[160:163], v[192:195], v[16:19]
    ds_read_b128 v[208:211], v224 offset:8192
    v_mfma_f32_16x16x32_bf16 v[52:55], v[164:167], v[192:195], v[52:55]
    s_add_u32 s22, s22, 18432
    s_waitcnt lgkmcnt(6)
    v_mfma_f32_16x16x32_bf16 v[88:91], v[168:171], v[192:195], v[88:91]
    s_cmp_eq_u32 s22, 92160
    s_cselect_b32 s22, 0, s22
    s_waitcnt lgkmcnt(3)
    v_mfma_f32_16x16x32_bf16 v[124:127], v[172:175], v[192:195], v[124:127]
    v_mfma_f32_16x16x32_bf16 v[20:23], v[160:163], v[196:199], v[20:23]
    ds_read_b128 v[212:215], v224 offset:10240
    v_add_u32 v216, s22, v220
    v_mfma_f32_16x16x32_bf16 v[56:59], v[164:167], v[196:199], v[56:59]
    v_add_u32 v217, s22, v221
    v_mfma_f32_16x16x32_bf16 v[92:95], v[168:171], v[196:199], v[92:95]
    v_add_u32 v218, s22, v222
    v_mfma_f32_16x16x32_bf16 v[128:131], v[172:175], v[196:199], v[128:131]
    v_add_u32 v219, s22, v223
    s_waitcnt lgkmcnt(3)
    v_mfma_f32_16x16x32_bf16 v[24:27], v[160:163], v[200:203], v[24:27]
    ds_read_b128 v[192:195], v224 offset:12288
    v_mfma_f32_16x16x32_bf16 v[60:63], v[164:167], v[200:203], v[60:63]
    v_mfma_f32_16x16x32_bf16 v[96:99], v[168:171], v[200:203], v[96:99]
    v_mfma_f32_16x16x32_bf16 v[132:135], v[172:175], v[200:203], v[132:135]
    s_barrier
    s_waitcnt lgkmcnt(3)
    v_mfma_f32_16x16x32_bf16 v[28:31], v[160:163], v[204:207], v[28:31]
    ds_read_b128 v[196:199], v224 offset:14336
    v_mfma_f32_16x16x32_bf16 v[64:67], v[164:167], v[204:207], v[64:67]
    ds_read_b64_tr_b16 v[176:177], v216 offset:0
    v_mfma_f32_16x16x32_bf16 v[100:103], v[168:171], v[204:207], v[100:103]
    ds_read_b64_tr_b16 v[178:179], v216 offset:2304
    v_mfma_f32_16x16x32_bf16 v[136:139], v[172:175], v[204:207], v[136:139]
    s_waitcnt lgkmcnt(5)
    v_mfma_f32_16x16x32_bf16 v[32:35], v[160:163], v[208:211], v[32:35]
    ds_read_b128 v[200:203], v224 offset:16384
    v_mfma_f32_16x16x32_bf16 v[68:71], v[164:167], v[208:211], v[68:71]
    ds_read_b64_tr_b16 v[180:181], v217 offset:0
    v_mfma_f32_16x16x32_bf16 v[104:107], v[168:171], v[208:211], v[104:107]
    ds_read_b64_tr_b16 v[182:183], v217 offset:2304
    v_mfma_f32_16x16x32_bf16 v[140:143], v[172:175], v[208:211], v[140:143]
    s_waitcnt lgkmcnt(7)
    v_mfma_f32_16x16x32_bf16 v[36:39], v[160:163], v[212:215], v[36:39]
    ds_read_b128 v[204:207], v225 offset:0
    v_mfma_f32_16x16x32_bf16 v[72:75], v[164:167], v[212:215], v[72:75]
    ds_read_b64_tr_b16 v[184:185], v218 offset:0
    v_mfma_f32_16x16x32_bf16 v[108:111], v[168:171], v[212:215], v[108:111]
    ds_read_b64_tr_b16 v[186:187], v218 offset:2304
    v_mfma_f32_16x16x32_bf16 v[144:147], v[172:175], v[212:215], v[144:147]
    s_waitcnt lgkmcnt(9)
    v_mfma_f32_16x16x32_bf16 v[40:43], v[160:163], v[192:195], v[40:43]
    ds_read_b128 v[208:211], v225 offset:2048
    v_mfma_f32_16x16x32_bf16 v[76:79], v[164:167], v[192:195], v[76:79]
    ds_read_b64_tr_b16 v[188:189], v219 offset:0
    v_mfma_f32_16x16x32_bf16 v[112:115], v[168:171], v[192:195], v[112:115]
    ds_read_b64_tr_b16 v[190:191], v219 offset:2304
    v_mfma_f32_16x16x32_bf16 v[148:151], v[172:175], v[192:195], v[148:151]
    s_waitcnt lgkmcnt(11)
    v_mfma_f32_16x16x32_bf16 v[44:47], v[160:163], v[196:199], v[44:47]
    ds_read_b128 v[212:215], v225 offset:4096
    v_mfma_f32_16x16x32_bf16 v[80:83], v[164:167], v[196:199], v[80:83]
    v_mfma_f32_16x16x32_bf16 v[116:119], v[168:171], v[196:199], v[116:119]
    v_mfma_f32_16x16x32_bf16 v[152:155], v[172:175], v[196:199], v[152:155]
    s_waitcnt lgkmcnt(9)
    v_mfma_f32_16x16x32_bf16 v[48:51], v[160:163], v[200:203], v[48:51]
    ds_read_b128 v[192:195], v225 offset:6144
    v_mfma_f32_16x16x32_bf16 v[84:87], v[164:167], v[200:203], v[84:87]
    v_mfma_f32_16x16x32_bf16 v[120:123], v[168:171], v[200:203], v[120:123]
    v_mfma_f32_16x16x32_bf16 v[156:159], v[172:175], v[200:203], v[156:159]
    s_waitcnt lgkmcnt(7)
    v_mfma_f32_16x16x32_bf16 v[16:19], v[176:179], v[204:207], v[16:19]
    ds_read_b128 v[196:199], v225 offset:8192
    v_mfma_f32_16x16x32_bf16 v[52:55], v[180:183], v[204:207], v[52:55]
    s_waitcnt lgkmcnt(6)
    v_mfma_f32_16x16x32_bf16 v[88:91], v[184:187], v[204:207], v[88:91]
    s_waitcnt lgkmcnt(3)
    v_mfma_f32_16x16x32_bf16 v[124:127], v[188:191], v[204:207], v[124:127]
    v_mfma_f32_16x16x32_bf16 v[20:23], v[176:179], v[208:211], v[20:23]
    ds_read_b128 v[200:203], v225 offset:10240
    v_mfma_f32_16x16x32_bf16 v[56:59], v[180:183], v[208:211], v[56:59]
    v_mfma_f32_16x16x32_bf16 v[92:95], v[184:187], v[208:211], v[92:95]
    v_mfma_f32_16x16x32_bf16 v[128:131], v[188:191], v[208:211], v[128:131]
    s_waitcnt lgkmcnt(3)
    v_mfma_f32_16x16x32_bf16 v[24:27], v[176:179], v[212:215], v[24:27]
    ds_read_b128 v[204:207], v225 offset:12288
    v_mfma_f32_16x16x32_bf16 v[60:63], v[180:183], v[212:215], v[60:63]
    v_mfma_f32_16x16x32_bf16 v[96:99], v[184:187], v[212:215], v[96:99]
    v_mfma_f32_16x16x32_bf16 v[132:135], v[188:191], v[212:215], v[132:135]
    s_waitcnt lgkmcnt(3)
    v_mfma_f32_16x16x32_bf16 v[28:31], v[176:179], v[192:195], v[28:31]
    ds_read_b128 v[208:211], v225 offset:14336
    v_mfma_f32_16x16x32_bf16 v[64:67], v[180:183], v[192:195], v[64:67]
    v_mfma_f32_16x16x32_bf16 v[100:103], v[184:187], v[192:195], v[100:103]
    v_mfma_f32_16x16x32_bf16 v[136:139], v[188:191], v[192:195], v[136:139]
    s_waitcnt lgkmcnt(3)
    v_mfma_f32_16x16x32_bf16 v[32:35], v[176:179], v[196:199], v[32:35]
    ds_read_b128 v[212:215], v225 offset:16384
    v_mfma_f32_16x16x32_bf16 v[68:71], v[180:183], v[196:199], v[68:71]
    v_mfma_f32_16x16x32_bf16 v[104:107], v[184:187], v[196:199], v[104:107]
    v_mfma_f32_16x16x32_bf16 v[140:143], v[188:191], v[196:199], v[140:143]
    s_waitcnt lgkmcnt(3)
    v_mfma_f32_16x16x32_bf16 v[36:39], v[176:179], v[200:203], v[36:39]
    v_mfma_f32_16x16x32_bf16 v[72:75], v[180:183], v[200:203], v[72:75]
    v_mfma_f32_16x16x32_bf16 v[108:111], v[184:187], v[200:203], v[108:111]
    v_mfma_f32_16x16x32_bf16 v[144:147], v[188:191], v[200:203], v[144:147]
    s_waitcnt lgkmcnt(2)
    v_mfma_f32_16x16x32_bf16 v[40:43], v[176:179], v[204:207], v[40:43]
    v_mfma_f32_16x16x32_bf16 v[76:79], v[180:183], v[204:207], v[76:79]
    v_mfma_f32_16x16x32_bf16 v[112:115], v[184:187], v[204:207], v[112:115]
    v_mfma_f32_16x16x32_bf16 v[148:151], v[188:191], v[204:207], v[148:151]
    s_waitcnt lgkmcnt(1)
    v_mfma_f32_16x16x32_bf16 v[44:47], v[176:179], v[208:211], v[44:47]
    v_mfma_f32_16x16x32_bf16 v[80:83], v[180:183], v[208:211], v[80:83]
    v_mfma_f32_16x16x32_bf16 v[116:119], v[184:187], v[208:211], v[116:119]
    v_mfma_f32_16x16x32_bf16 v[152:155], v[188:191], v[208:211], v[152:155]
    s_waitcnt lgkmcnt(0)
    v_mfma_f32_16x16x32_bf16 v[48:51], v[176:179], v[212:215], v[48:51]
    v_mfma_f32_16x16x32_bf16 v[84:87], v[180:183], v[212:215], v[84:87]
    v_mfma_f32_16x16x32_bf16 v[120:123], v[184:187], v[212:215], v[120:123]
    v_mfma_f32_16x16x32_bf16 v[156:159], v[188:191], v[212:215], v[156:159]
    s_waitcnt vmcnt(0)
    v_readfirstlane_b32 s62, v15
    s_nop 1
    s_cmp_lg_u32 s62, 0
    s_cbranch_scc1 Lnok_163
    s_mov_b32 s28, s56
    s_mov_b32 s29, s57
    s_mov_b32 s30, 256
    s_mov_b32 s31, 0x00020000
    v_mov_b32 v14, 0
    s_mov_b32 s32, 0
Lnonce_164:
    buffer_load_dword v15, v14, s[28:31], 0 offen sc1
    s_waitcnt vmcnt(0)
    v_readfirstlane_b32 s62, v15
    s_add_u32 s32, s32, 1
    s_cmp_gt_u32 s32, 65536
    s_cbranch_scc1 Lnonce_o_165
    s_cmp_eq_u32 s62, 0
    s_cbranch_scc1 Lnonce_164
Lnonce_o_165:
Lnok_163:
    s_movk_i32 s19, 488
    v_mul_u32_u24 v3, s19, v1
    v_lshl_add_u32 v3, v2, 3, v3
    s_lshl_b32 s19, s3, 7
    v_add_u32 v3, s19, v3
    v_cvt_pk_bf16_f32 v160, v16, v17
    v_cvt_pk_bf16_f32 v161, v18, v19
    ds_write_b64 v3, v[160:161] offset:0
    v_cvt_pk_bf16_f32 v162, v20, v21
    v_cvt_pk_bf16_f32 v163, v22, v23
    ds_write_b64 v3, v[162:163] offset:7808
    v_cvt_pk_bf16_f32 v164, v24, v25
    v_cvt_pk_bf16_f32 v165, v26, v27
    ds_write_b64 v3, v[164:165] offset:15616
    v_cvt_pk_bf16_f32 v166, v28, v29
    v_cvt_pk_bf16_f32 v167, v30, v31
    ds_write_b64 v3, v[166:167] offset:23424
    v_cvt_pk_bf16_f32 v168, v32, v33
    v_cvt_pk_bf16_f32 v169, v34, v35
    ds_write_b64 v3, v[168:169] offset:31232
    v_cvt_pk_bf16_f32 v170, v36, v37
    v_cvt_pk_bf16_f32 v171, v38, v39
    ds_write_b64 v3, v[170:171] offset:39040
    v_cvt_pk_bf16_f32 v172, v40, v41
    v_cvt_pk_bf16_f32 v173, v42, v43
    ds_write_b64 v3, v[172:173] offset:46848
    v_cvt_pk_bf16_f32 v174, v44, v45
    v_cvt_pk_bf16_f32 v175, v46, v47
    ds_write_b64 v3, v[174:175] offset:54656
    v_cvt_pk_bf16_f32 v176, v48, v49
    v_cvt_pk_bf16_f32 v177, v50, v51
    ds_write_b64 v3, v[176:177] offset:62464
    v_cvt_pk_bf16_f32 v178, v52, v53
    v_cvt_pk_bf16_f32 v179, v54, v55
    ds_write_b64 v3, v[178:179] offset:32
    v_cvt_pk_bf16_f32 v180, v56, v57
    v_cvt_pk_bf16_f32 v181, v58, v59
    ds_write_b64 v3, v[180:181] offset:7840
    v_cvt_pk_bf16_f32 v182, v60, v61
    v_cvt_pk_bf16_f32 v183, v62, v63
    ds_write_b64 v3, v[182:183] offset:15648
    v_cvt_pk_bf16_f32 v160, v64, v65
    v_cvt_pk_bf16_f32 v161, v66, v67
    ds_write_b64 v3, v[160:161] offset:23456
    v_cvt_pk_bf16_f32 v162, v68, v69
    v_cvt_pk_bf16_f32 v163, v70, v71
    ds_write_b64 v3, v[162:163] offset:31264
    v_cvt_pk_bf16_f32 v164, v72, v73
    v_cvt_pk_bf16_f32 v165, v74, v75
    ds_write_b64 v3, v[164:165] offset:39072
    v_cvt_pk_bf16_f32 v166, v76, v77
    v_cvt_pk_bf16_f32 v167, v78, v79
    ds_write_b64 v3, v[166:167] offset:46880
    v_cvt_pk_bf16_f32 v168, v80, v81
    v_cvt_pk_bf16_f32 v169, v82, v83
    ds_write_b64 v3, v[168:169] offset:54688
    v_cvt_pk_bf16_f32 v170, v84, v85
    v_cvt_pk_bf16_f32 v171, v86, v87
    ds_write_b64 v3, v[170:171] offset:62496
    v_cvt_pk_bf16_f32 v172, v88, v89
    v_cvt_pk_bf16_f32 v173, v90, v91
    ds_write_b64 v3, v[172:173] offset:64
    v_cvt_pk_bf16_f32 v174, v92, v93
    v_cvt_pk_bf16_f32 v175, v94, v95
    ds_write_b64 v3, v[174:175] offset:7872
    v_cvt_pk_bf16_f32 v176, v96, v97
    v_cvt_pk_bf16_f32 v177, v98, v99
    ds_write_b64 v3, v[176:177] offset:15680
    v_cvt_pk_bf16_f32 v178, v100, v101
    v_cvt_pk_bf16_f32 v179, v102, v103
    ds_write_b64 v3, v[178:179] offset:23488
    v_cvt_pk_bf16_f32 v180, v104, v105
    v_cvt_pk_bf16_f32 v181, v106, v107
    ds_write_b64 v3, v[180:181] offset:31296
    v_cvt_pk_bf16_f32 v182, v108, v109
    v_cvt_pk_bf16_f32 v183, v110, v111
    ds_write_b64 v3, v[182:183] offset:39104
    v_cvt_pk_bf16_f32 v160, v112, v113
    v_cvt_pk_bf16_f32 v161, v114, v115
    ds_write_b64 v3, v[160:161] offset:46912
    v_cvt_pk_bf16_f32 v162, v116, v117
    v_cvt_pk_bf16_f32 v163, v118, v119
    ds_write_b64 v3, v[162:163] offset:54720
    v_cvt_pk_bf16_f32 v164, v120, v121
    v_cvt_pk_bf16_f32 v165, v122, v123
    ds_write_b64 v3, v[164:165] offset:62528
    v_cvt_pk_bf16_f32 v166, v124, v125
    v_cvt_pk_bf16_f32 v167, v126, v127
    ds_write_b64 v3, v[166:167] offset:96
    v_cvt_pk_bf16_f32 v168, v128, v129
    v_cvt_pk_bf16_f32 v169, v130, v131
    ds_write_b64 v3, v[168:169] offset:7904
    v_cvt_pk_bf16_f32 v170, v132, v133
    v_cvt_pk_bf16_f32 v171, v134, v135
    ds_write_b64 v3, v[170:171] offset:15712
    v_cvt_pk_bf16_f32 v172, v136, v137
    v_cvt_pk_bf16_f32 v173, v138, v139
    ds_write_b64 v3, v[172:173] offset:23520
    v_cvt_pk_bf16_f32 v174, v140, v141
    v_cvt_pk_bf16_f32 v175, v142, v143
    ds_write_b64 v3, v[174:175] offset:31328
    v_cvt_pk_bf16_f32 v176, v144, v145
    v_cvt_pk_bf16_f32 v177, v146, v147
    ds_write_b64 v3, v[176:177] offset:39136
    v_cvt_pk_bf16_f32 v178, v148, v149
    v_cvt_pk_bf16_f32 v179, v150, v151
    ds_write_b64 v3, v[178:179] offset:46944
    v_cvt_pk_bf16_f32 v180, v152, v153
    v_cvt_pk_bf16_f32 v181, v154, v155
    ds_write_b64 v3, v[180:181] offset:54752
    v_cvt_pk_bf16_f32 v182, v156, v157
    v_cvt_pk_bf16_f32 v183, v158, v159
    ds_write_b64 v3, v[182:183] offset:62560
    s_waitcnt lgkmcnt(0)
    s_barrier
    s_branch Lq_att_158
Lq_c3_160:
    v_mov_b32 v16, 0
    v_mov_b32 v17, 0
    v_mov_b32 v18, 0
    v_mov_b32 v19, 0
    v_mov_b32 v20, 0
    v_mov_b32 v21, 0
    v_mov_b32 v22, 0
    v_mov_b32 v23, 0
    v_mov_b32 v24, 0
    v_mov_b32 v25, 0
    v_mov_b32 v26, 0
    v_mov_b32 v27, 0
    v_mov_b32 v28, 0
    v_mov_b32 v29, 0
    v_mov_b32 v30, 0
    v_mov_b32 v31, 0
    v_mov_b32 v32, 0
    v_mov_b32 v33, 0
    v_mov_b32 v34, 0
    v_mov_b32 v35, 0
    v_mov_b32 v36, 0
    v_mov_b32 v37, 0
    v_mov_b32 v38, 0
    v_mov_b32 v39, 0
    v_mov_b32 v40, 0
    v_mov_b32 v41, 0
    v_mov_b32 v42, 0
    v_mov_b32 v43, 0
    v_mov_b32 v44, 0
    v_mov_b32 v45, 0
    v_mov_b32 v46, 0
    v_mov_b32 v47, 0
    v_mov_b32 v48, 0
    v_mov_b32 v49, 0
    v_mov_b32 v50, 0
    v_mov_b32 v51, 0
    v_mov_b32 v52, 0
    v_mov_b32 v53, 0
    v_mov_b32 v54, 0
    v_mov_b32 v55, 0
    v_mov_b32 v56, 0
    v_mov_b32 v57, 0
    v_mov_b32 v58, 0
    v_mov_b32 v59, 0
    v_mov_b32 v60, 0
    v_mov_b32 v61, 0
    v_mov_b32 v62, 0
    v_mov_b32 v63, 0
    v_mov_b32 v64, 0
    v_mov_b32 v65, 0
    v_mov_b32 v66, 0
    v_mov_b32 v67, 0
    v_mov_b32 v68, 0
    v_mov_b32 v69, 0
    v_mov_b32 v70, 0
    v_mov_b32 v71, 0
    v_mov_b32 v72, 0
    v_mov_b32 v73, 0
    v_mov_b32 v74, 0
    v_mov_b32 v75, 0
    v_mov_b32 v76, 0
    v_mov_b32 v77, 0
    v_mov_b32 v78, 0
    v_mov_b32 v79, 0
    v_mov_b32 v80, 0
    v_mov_b32 v81, 0
    v_mov_b32 v82, 0
    v_mov_b32 v83, 0
    v_mov_b32 v84, 0
    v_mov_b32 v85, 0
    v_mov_b32 v86, 0
    v_mov_b32 v87, 0
    v_mov_b32 v88, 0
    v_mov_b32 v89, 0
    v_mov_b32 v90, 0
    v_mov_b32 v91, 0
    v_mov_b32 v92, 0
    v_mov_b32 v93, 0
    v_mov_b32 v94, 0
    v_mov_b32 v95, 0
    v_mov_b32 v96, 0
    v_mov_b32 v97, 0
    v_mov_b32 v98, 0
    v_mov_b32 v99, 0
    v_mov_b32 v100, 0
    v_mov_b32 v101, 0
    v_mov_b32 v102, 0
    v_mov_b32 v103, 0
    v_mov_b32 v104, 0
    v_mov_b32 v105, 0
    v_mov_b32 v106, 0
    v_mov_b32 v107, 0
    v_mov_b32 v108, 0
    v_mov_b32 v109, 0
    v_mov_b32 v110, 0
    v_mov_b32 v111, 0
    v_mov_b32 v112, 0
    v_mov_b32 v113, 0
    v_mov_b32 v114, 0
    v_mov_b32 v115, 0
    v_mov_b32 v116, 0
    v_mov_b32 v117, 0
    v_mov_b32 v118, 0
    v_mov_b32 v119, 0
    v_mov_b32 v120, 0
    v_mov_b32 v121, 0
    v_mov_b32 v122, 0
    v_mov_b32 v123, 0
    v_mov_b32 v124, 0
    v_mov_b32 v125, 0
    v_mov_b32 v126, 0
    v_mov_b32 v127, 0
    v_mov_b32 v128, 0
    v_mov_b32 v129, 0
    v_mov_b32 v130, 0
    v_mov_b32 v131, 0
    v_mov_b32 v132, 0
    v_mov_b32 v133, 0
    v_mov_b32 v134, 0
    v_mov_b32 v135, 0
    v_mov_b32 v136, 0
    v_mov_b32 v137, 0
    v_mov_b32 v138, 0
    v_mov_b32 v139, 0
    v_mov_b32 v140, 0
    v_mov_b32 v141, 0
    v_mov_b32 v142, 0
    v_mov_b32 v143, 0
    v_mov_b32 v144, 0
    v_mov_b32 v145, 0
    v_mov_b32 v146, 0
    v_mov_b32 v147, 0
    v_mov_b32 v148, 0
    v_mov_b32 v149, 0
    v_mov_b32 v150, 0
    v_mov_b32 v151, 0
    v_mov_b32 v152, 0
    v_mov_b32 v153, 0
    v_mov_b32 v154, 0
    v_mov_b32 v155, 0
    v_mov_b32 v156, 0
    v_mov_b32 v157, 0
    v_mov_b32 v158, 0
    v_mov_b32 v159, 0
    v_lshlrev_b32 v229, 4, v2
    v_add_u32 v229, 147456, v229
    s_lshl_b32 s18, s7, 7
    v_add_u32 v228, s18, v229
    s_mov_b32 s22, 0
    s_mov_b32 s23, 92160
    s_mov_b32 s24, 0
    v_add_u32 v216, s22, v220
    v_add_u32 v217, s22, v221
    v_add_u32 v218, s22, v222
    v_add_u32 v219, s22, v223
    v_add_u32 v224, s23, v226
    v_add_u32 v225, s23, v227
    s_barrier
    ds_read_b64_tr_b16 v[160:161], v216 offset:0
    ds_read_b64_tr_b16 v[162:163], v216 offset:2304
    ds_read_b64_tr_b16 v[164:165], v217 offset:0
    ds_read_b64_tr_b16 v[166:167], v217 offset:2304
    ds_read_b64_tr_b16 v[168:169], v218 offset:0
    ds_read_b64_tr_b16 v[170:171], v218 offset:2304
    ds_read_b128 v[172:175], v228
    s_add_u32 s18, s18, 64
    s_cmp_eq_u32 s18, 1280
    s_cselect_b32 s18, 0, s18
    v_add_u32 v228, s18, v229
    ds_read_b128 v[192:195], v224 offset:0
    ds_read_b128 v[196:199], v224 offset:2048
    ds_read_b128 v[200:203], v224 offset:4096
    ds_read_b128 v[204:207], v224 offset:6144
Lqkv_166:
    s_cmp_lg_u32 s24, 3
    s_cbranch_scc1 Lmid_167
    s_lshl_b32 s26, s60, 18
    s_lshl_b32 s27, s61, 15
    s_add_u32 s26, s26, s27
    s_lshl_b32 s27, s3, 13
    s_add_u32 s26, s26, s27
    s_mov_b32 s28, s46
    s_mov_b32 s29, s47
    s_mov_b32 s30, 8388608
    s_mov_b32 s31, 0x00020000
    v_lshlrev_b32 v240, 7, v0
    buffer_load_dword v254, v240, s[28:31], s26 offen
    s_mov_b32 s28, s56
    s_mov_b32 s29, s57
    s_mov_b32 s30, 256
    s_mov_b32 s31, 0x00020000
    v_mov_b32 v14, 0
    buffer_load_dword v15, v14, s[28:31], 0 offen sc1
Lmid_167:
    s_waitcnt lgkmcnt(3)
    v_mfma_f32_16x16x32_bf16 v[16:19], v[160:163], v[192:195], v[16:19]
    ds_read_b128 v[208:211], v224 offset:8192
    v_mfma_f32_16x16x32_bf16 v[52:55], v[164:167], v[192:195], v[52:55]
    s_add_u32 s22, s22, 18432
    v_mfma_f32_16x16x32_bf16 v[88:91], v[168:171], v[192:195], v[88:91]
    s_cmp_eq_u32 s22, 92160
    s_cselect_b32 s22, 0, s22
    v_mfma_f32_16x16x32_bf16 v[124:127], v[172:175], v[192:195], v[124:127]
    s_waitcnt lgkmcnt(3)
    v_mfma_f32_16x16x32_bf16 v[20:23], v[160:163], v[196:199], v[20:23]
    ds_read_b128 v[212:215], v224 offset:10240
    v_add_u32 v216, s22, v220
    v_mfma_f32_16x16x32_bf16 v[56:59], v[164:167], v[196:199], v[56:59]
    v_add_u32 v217, s22, v221
    v_mfma_f32_16x16x32_bf16 v[92:95], v[168:171], v[196:199], v[92:95]
    v_add_u32 v218, s22, v222
    v_mfma_f32_16x16x32_bf16 v[128:131], v[172:175], v[196:199], v[128:131]
    v_add_u32 v219, s22, v223
    s_waitcnt lgkmcnt(3)
    v_mfma_f32_16x16x32_bf16 v[24:27], v[160:163], v[200:203], v[24:27]
    ds_read_b128 v[192:195], v224 offset:12288
    v_mfma_f32_16x16x32_bf16 v[60:63], v[164:167], v[200:203], v[60:63]
    v_mfma_f32_16x16x32_bf16 v[96:99], v[168:171], v[200:203], v[96:99]
    v_mfma_f32_16x16x32_bf16 v[132:135], v[172:175], v[200:203], v[132:135]
    s_barrier
    s_waitcnt lgkmcnt(3)
    v_mfma_f32_16x16x32_bf16 v[28:31], v[160:163], v[204:207], v[28:31]
    ds_read_b128 v[196:199], v224 offset:14336
    v_mfma_f32_16x16x32_bf16 v[64:67], v[164:167], v[204:207], v[64:67]
    ds_read_b64_tr_b16 v[176:177], v216 offset:0
    v_mfma_f32_16x16x32_bf16 v[100:103], v[168:171], v[204:207], v[100:103]
    ds_read_b64_tr_b16 v[178:179], v216 offset:2304
    v_mfma_f32_16x16x32_bf16 v[136:139], v[172:175], v[204:207], v[136:139]
    s_waitcnt lgkmcnt(5)
    v_mfma_f32_16x16x32_bf16 v[32:35], v[160:163], v[208:211], v[32:35]
    ds_read_b128 v[200:203], v224 offset:16384
    v_mfma_f32_16x16x32_bf16 v[68:71], v[164:167], v[208:211], v[68:71]
    ds_read_b64_tr_b16 v[180:181], v217 offset:0
    v_mfma_f32_16x16x32_bf16 v[104:107], v[168:171], v[208:211], v[104:107]
    ds_read_b64_tr_b16 v[182:183], v217 offset:2304
    v_mfma_f32_16x16x32_bf16 v[140:143], v[172:175], v[208:211], v[140:143]
    s_waitcnt lgkmcnt(7)
    v_mfma_f32_16x16x32_bf16 v[36:39], v[160:163], v[212:215], v[36:39]
    ds_read_b128 v[204:207], v225 offset:0
    v_mfma_f32_16x16x32_bf16 v[72:75], v[164:167], v[212:215], v[72:75]
    ds_read_b64_tr_b16 v[184:185], v218 offset:0
    v_mfma_f32_16x16x32_bf16 v[108:111], v[168:171], v[212:215], v[108:111]
    ds_read_b64_tr_b16 v[186:187], v218 offset:2304
    v_mfma_f32_16x16x32_bf16 v[144:147], v[172:175], v[212:215], v[144:147]
    s_waitcnt lgkmcnt(9)
    v_mfma_f32_16x16x32_bf16 v[40:43], v[160:163], v[192:195], v[40:43]
    ds_read_b128 v[208:211], v225 offset:2048
    v_mfma_f32_16x16x32_bf16 v[76:79], v[164:167], v[192:195], v[76:79]
    ds_read_b128 v[188:191], v228
    v_mfma_f32_16x16x32_bf16 v[112:115], v[168:171], v[192:195], v[112:115]
    s_add_u32 s18, s18, 64
    s_cmp_eq_u32 s18, 1280
    s_cselect_b32 s18, 0, s18
    v_add_u32 v228, s18, v229
    v_mfma_f32_16x16x32_bf16 v[148:151], v[172:175], v[192:195], v[148:151]
    s_waitcnt lgkmcnt(10)
    v_mfma_f32_16x16x32_bf16 v[44:47], v[160:163], v[196:199], v[44:47]
    ds_read_b128 v[212:215], v225 offset:4096
    v_mfma_f32_16x16x32_bf16 v[80:83], v[164:167], v[196:199], v[80:83]
    v_mfma_f32_16x16x32_bf16 v[116:119], v[168:171], v[196:199], v[116:119]
    v_mfma_f32_16x16x32_bf16 v[152:155], v[172:175], v[196:199], v[152:155]
    s_waitcnt lgkmcnt(8)
    v_mfma_f32_16x16x32_bf16 v[48:51], v[160:163], v[200:203], v[48:51]
    ds_read_b128 v[192:195], v225 offset:6144
    v_mfma_f32_16x16x32_bf16 v[84:87], v[164:167], v[200:203], v[84:87]
    v_mfma_f32_16x16x32_bf16 v[120:123], v[168:171], v[200:203], v[120:123]
    v_mfma_f32_16x16x32_bf16 v[156:159], v[172:175], v[200:203], v[156:159]
    s_waitcnt lgkmcnt(6)
    v_mfma_f32_16x16x32_bf16 v[16:19], v[176:179], v[204:207], v[16:19]
    ds_read_b128 v[196:199], v225 offset:8192
    v_mfma_f32_16x16x32_bf16 v[52:55], v[180:183], v[204:207], v[52:55]
    s_add_u32 s22, s22, 18432
    s_waitcnt lgkmcnt(5)
    v_mfma_f32_16x16x32_bf16 v[88:91], v[184:187], v[204:207], v[88:91]
    s_cmp_eq_u32 s22, 92160
    s_cselect_b32 s22, 0, s22
    s_waitcnt lgkmcnt(3)
    v_mfma_f32_16x16x32_bf16 v[124:127], v[188:191], v[204:207], v[124:127]
    v_mfma_f32_16x16x32_bf16 v[20:23], v[176:179], v[208:211], v[20:23]
    ds_read_b128 v[200:203], v225 offset:10240
    v_add_u32 v216, s22, v220
    v_mfma_f32_16x16x32_bf16 v[56:59], v[180:183], v[208:211], v[56:59]
    v_add_u32 v217, s22, v221
    v_mfma_f32_16x16x32_bf16 v[92:95], v[184:187], v[208:211], v[92:95]
    v_add_u32 v218, s22, v222
    v_mfma_f32_16x16x32_bf16 v[128:131], v[188:191], v[208:211], v[128:131]
    v_add_u32 v219, s22, v223
    s_waitcnt lgkmcnt(3)
    v_mfma_f32_16x16x32_bf16 v[24:27], v[176:179], v[212:215], v[24:27]
    ds_read_b128 v[204:207], v225 offset:12288
    v_mfma_f32_16x16x32_bf16 v[60:63], v[180:183], v[212:215], v[60:63]
    s_add_u32 s23, s23, 18432
    v_mfma_f32_16x16x32_bf16 v[96:99], v[184:187], v[212:215], v[96:99]
    s_cmp_eq_u32 s23, 147456
    s_cselect_b32 s23, 92160, s23
    v_mfma_f32_16x16x32_bf16 v[132:135], v[188:191], v[212:215], v[132:135]
    s_barrier
    s_waitcnt lgkmcnt(3)
    v_mfma_f32_16x16x32_bf16 v[28:31], v[176:179], v[192:195], v[28:31]
    ds_read_b128 v[208:211], v225 offset:14336
    v_mfma_f32_16x16x32_bf16 v[64:67], v[180:183], v[192:195], v[64:67]
    ds_read_b64_tr_b16 v[160:161], v216 offset:0
    v_mfma_f32_16x16x32_bf16 v[100:103], v[184:187], v[192:195], v[100:103]
    ds_read_b64_tr_b16 v[162:163], v216 offset:2304
    v_mfma_f32_16x16x32_bf16 v[136:139], v[188:191], v[192:195], v[136:139]
    s_waitcnt lgkmcnt(5)
    v_mfma_f32_16x16x32_bf16 v[32:35], v[176:179], v[196:199], v[32:35]
    ds_read_b128 v[212:215], v225 offset:16384
    v_mfma_f32_16x16x32_bf16 v[68:71], v[180:183], v[196:199], v[68:71]
    ds_read_b64_tr_b16 v[164:165], v217 offset:0
    v_add_u32 v224, s23, v226
    v_mfma_f32_16x16x32_bf16 v[104:107], v[184:187], v[196:199], v[104:107]
    ds_read_b64_tr_b16 v[166:167], v217 offset:2304
    v_mfma_f32_16x16x32_bf16 v[140:143], v[188:191], v[196:199], v[140:143]
    v_add_u32 v225, s23, v227
    s_waitcnt lgkmcnt(7)
    v_mfma_f32_16x16x32_bf16 v[36:39], v[176:179], v[200:203], v[36:39]
    ds_read_b128 v[192:195], v224 offset:0
    v_mfma_f32_16x16x32_bf16 v[72:75], v[180:183], v[200:203], v[72:75]
    ds_read_b64_tr_b16 v[168:169], v218 offset:0
    v_mfma_f32_16x16x32_bf16 v[108:111], v[184:187], v[200:203], v[108:111]
    ds_read_b64_tr_b16 v[170:171], v218 offset:2304
    v_mfma_f32_16x16x32_bf16 v[144:147], v[188:191], v[200:203], v[144:147]
    s_waitcnt lgkmcnt(9)
    v_mfma_f32_16x16x32_bf16 v[40:43], v[176:179], v[204:207], v[40:43]
    ds_read_b128 v[196:199], v224 offset:2048
    v_mfma_f32_16x16x32_bf16 v[76:79], v[180:183], v[204:207], v[76:79]
    ds_read_b128 v[172:175], v228
    v_mfma_f32_16x16x32_bf16 v[112:115], v[184:187], v[204:207], v[112:115]
    s_add_u32 s18, s18, 64
    s_cmp_eq_u32 s18, 1280
    s_cselect_b32 s18, 0, s18
    v_add_u32 v228, s18, v229
    v_mfma_f32_16x16x32_bf16 v[148:151], v[188:191], v[204:207], v[148:151]
    s_waitcnt lgkmcnt(10)
    v_mfma_f32_16x16x32_bf16 v[44:47], v[176:179], v[208:211], v[44:47]
    ds_read_b128 v[200:203], v224 offset:4096
    v_mfma_f32_16x16x32_bf16 v[80:83], v[180:183], v[208:211], v[80:83]
    v_mfma_f32_16x16x32_bf16 v[116:119], v[184:187], v[208:211], v[116:119]
    v_mfma_f32_16x16x32_bf16 v[152:155], v[188:191], v[208:211], v[152:155]
    s_waitcnt lgkmcnt(8)
    v_mfma_f32_16x16x32_bf16 v[48:51], v[176:179], v[212:215], v[48:51]
    ds_read_b128 v[204:207], v224 offset:6144
    v_mfma_f32_16x16x32_bf16 v[84:87], v[180:183], v[212:215], v[84:87]
    v_mfma_f32_16x16x32_bf16 v[120:123], v[184:187], v[212:215], v[120:123]
    v_mfma_f32_16x16x32_bf16 v[156:159], v[188:191], v[212:215], v[156:159]
    s_add_u32 s24, s24, 1
    s_cmp_lt_u32 s24, 9
    s_cbranch_scc1 Lqkv_166
    s_waitcnt lgkmcnt(6)
    v_mfma_f32_16x16x32_bf16 v[16:19], v[160:163], v[192:195], v[16:19]
    ds_read_b128 v[208:211], v224 offset:8192
    v_mfma_f32_16x16x32_bf16 v[52:55], v[164:167], v[192:195], v[52:55]
    s_add_u32 s22, s22, 18432
    s_waitcnt lgkmcnt(5)
    v_mfma_f32_16x16x32_bf16 v[88:91], v[168:171], v[192:195], v[88:91]
    s_cmp_eq_u32 s22, 92160
    s_cselect_b32 s22, 0, s22
    s_waitcnt lgkmcnt(3)
    v_mfma_f32_16x16x32_bf16 v[124:127], v[172:175], v[192:195], v[124:127]
    v_mfma_f32_16x16x32_bf16 v[20:23], v[160:163], v[196:199], v[20:23]
    ds_read_b128 v[212:215], v224 offset:10240
    v_add_u32 v216, s22, v220
    v_mfma_f32_16x16x32_bf16 v[56:59], v[164:167], v[196:199], v[56:59]
    v_add_u32 v217, s22, v221
    v_mfma_f32_16x16x32_bf16 v[92:95], v[168:171], v[196:199], v[92:95]
    v_add_u32 v218, s22, v222
    v_mfma_f32_16x16x32_bf16 v[128:131], v[172:175], v[196:199], v[128:131]
    v_add_u32 v219, s22, v223
    s_waitcnt lgkmcnt(3)
    v_mfma_f32_16x16x32_bf16 v[24:27], v[160:163], v[200:203], v[24:27]
    ds_read_b128 v[192:195], v224 offset:12288
    v_mfma_f32_16x16x32_bf16 v[60:63], v[164:167], v[200:203], v[60:63]
    v_mfma_f32_16x16x32_bf16 v[96:99], v[168:171], v[200:203], v[96:99]
    v_mfma_f32_16x16x32_bf16 v[132:135], v[172:175], v[200:203], v[132:135]
    s_barrier
    s_waitcnt lgkmcnt(3)
    v_mfma_f32_16x16x32_bf16 v[28:31], v[160:163], v[204:207], v[28:31]
    ds_read_b128 v[196:199], v224 offset:14336
    v_mfma_f32_16x16x32_bf16 v[64:67], v[164:167], v[204:207], v[64:67]
    ds_read_b64_tr_b16 v[176:177], v216 offset:0
    v_mfma_f32_16x16x32_bf16 v[100:103], v[168:171], v[204:207], v[100:103]
    ds_read_b64_tr_b16 v[178:179], v216 offset:2304
    v_mfma_f32_16x16x32_bf16 v[136:139], v[172:175], v[204:207], v[136:139]
    s_waitcnt lgkmcnt(5)
    v_mfma_f32_16x16x32_bf16 v[32:35], v[160:163], v[208:211], v[32:35]
    ds_read_b128 v[200:203], v224 offset:16384
    v_mfma_f32_16x16x32_bf16 v[68:71], v[164:167], v[208:211], v[68:71]
    ds_read_b64_tr_b16 v[180:181], v217 offset:0
    v_mfma_f32_16x16x32_bf16 v[104:107], v[168:171], v[208:211], v[104:107]
    ds_read_b64_tr_b16 v[182:183], v217 offset:2304
    v_mfma_f32_16x16x32_bf16 v[140:143], v[172:175], v[208:211], v[140:143]
    s_waitcnt lgkmcnt(7)
    v_mfma_f32_16x16x32_bf16 v[36:39], v[160:163], v[212:215], v[36:39]
    ds_read_b128 v[204:207], v225 offset:0
    v_mfma_f32_16x16x32_bf16 v[72:75], v[164:167], v[212:215], v[72:75]
    ds_read_b64_tr_b16 v[184:185], v218 offset:0
    v_mfma_f32_16x16x32_bf16 v[108:111], v[168:171], v[212:215], v[108:111]
    ds_read_b64_tr_b16 v[186:187], v218 offset:2304
    v_mfma_f32_16x16x32_bf16 v[144:147], v[172:175], v[212:215], v[144:147]
    s_waitcnt lgkmcnt(9)
    v_mfma_f32_16x16x32_bf16 v[40:43], v[160:163], v[192:195], v[40:43]
    ds_read_b128 v[208:211], v225 offset:2048
    v_mfma_f32_16x16x32_bf16 v[76:79], v[164:167], v[192:195], v[76:79]
    ds_read_b128 v[188:191], v228
    v_mfma_f32_16x16x32_bf16 v[112:115], v[168:171], v[192:195], v[112:115]
    s_add_u32 s18, s18, 64
    s_cmp_eq_u32 s18, 1280
    s_cselect_b32 s18, 0, s18
    v_add_u32 v228, s18, v229
    v_mfma_f32_16x16x32_bf16 v[148:151], v[172:175], v[192:195], v[148:151]
    s_waitcnt lgkmcnt(10)
    v_mfma_f32_16x16x32_bf16 v[44:47], v[160:163], v[196:199], v[44:47]
    ds_read_b128 v[212:215], v225 offset:4096
    v_mfma_f32_16x16x32_bf16 v[80:83], v[164:167], v[196:199], v[80:83]
    v_mfma_f32_16x16x32_bf16 v[116:119], v[168:171], v[196:199], v[116:119]
    v_mfma_f32_16x16x32_bf16 v[152:155], v[172:175], v[196:199], v[152:155]
    s_waitcnt lgkmcnt(8)
    v_mfma_f32_16x16x32_bf16 v[48:51], v[160:163], v[200:203], v[48:51]
    ds_read_b128 v[192:195], v225 offset:6144
    v_mfma_f32_16x16x32_bf16 v[84:87], v[164:167], v[200:203], v[84:87]
    v_mfma_f32_16x16x32_bf16 v[120:123], v[168:171], v[200:203], v[120:123]
    v_mfma_f32_16x16x32_bf16 v[156:159], v[172:175], v[200:203], v[156:159]
    s_waitcnt lgkmcnt(6)
    v_mfma_f32_16x16x32_bf16 v[16:19], v[176:179], v[204:207], v[16:19]
    ds_read_b128 v[196:199], v225 offset:8192
    v_mfma_f32_16x16x32_bf16 v[52:55], v[180:183], v[204:207], v[52:55]
    s_waitcnt lgkmcnt(5)
    v_mfma_f32_16x16x32_bf16 v[88:91], v[184:187], v[204:207], v[88:91]
    s_waitcnt lgkmcnt(3)
    v_mfma_f32_16x16x32_bf16 v[124:127], v[188:191], v[204:207], v[124:127]
    v_mfma_f32_16x16x32_bf16 v[20:23], v[176:179], v[208:211], v[20:23]
    ds_read_b128 v[200:203], v225 offset:10240
    v_mfma_f32_16x16x32_bf16 v[56:59], v[180:183], v[208:211], v[56:59]
    v_mfma_f32_16x16x32_bf16 v[92:95], v[184:187], v[208:211], v[92:95]
    v_mfma_f32_16x16x32_bf16 v[128:131], v[188:191], v[208:211], v[128:131]
    s_waitcnt lgkmcnt(3)
    v_mfma_f32_16x16x32_bf16 v[24:27], v[176:179], v[212:215], v[24:27]
    ds_read_b128 v[204:207], v225 offset:12288
    v_mfma_f32_16x16x32_bf16 v[60:63], v[180:183], v[212:215], v[60:63]
    v_mfma_f32_16x16x32_bf16 v[96:99], v[184:187], v[212:215], v[96:99]
    v_mfma_f32_16x16x32_bf16 v[132:135], v[188:191], v[212:215], v[132:135]
    s_waitcnt lgkmcnt(3)
    v_mfma_f32_16x16x32_bf16 v[28:31], v[176:179], v[192:195], v[28:31]
    ds_read_b128 v[208:211], v225 offset:14336
    v_mfma_f32_16x16x32_bf16 v[64:67], v[180:183], v[192:195], v[64:67]
    v_mfma_f32_16x16x32_bf16 v[100:103], v[184:187], v[192:195], v[100:103]
    v_mfma_f32_16x16x32_bf16 v[136:139], v[188:191], v[192:195], v[136:139]
    s_waitcnt lgkmcnt(3)
    v_mfma_f32_16x16x32_bf16 v[32:35], v[176:179], v[196:199], v[32:35]
    ds_read_b128 v[212:215], v225 offset:16384
    v_mfma_f32_16x16x32_bf16 v[68:71], v[180:183], v[196:199], v[68:71]
    v_mfma_f32_16x16x32_bf16 v[104:107], v[184:187], v[196:199], v[104:107]
    v_mfma_f32_16x16x32_bf16 v[140:143], v[188:191], v[196:199], v[140:143]
    s_waitcnt lgkmcnt(3)
    v_mfma_f32_16x16x32_bf16 v[36:39], v[176:179], v[200:203], v[36:39]
    v_mfma_f32_16x16x32_bf16 v[72:75], v[180:183], v[200:203], v[72:75]
    v_mfma_f32_16x16x32_bf16 v[108:111], v[184:187], v[200:203], v[108:111]
    v_mfma_f32_16x16x32_bf16 v[144:147], v[188:191], v[200:203], v[144:147]
    s_waitcnt lgkmcnt(2)
    v_mfma_f32_16x16x32_bf16 v[40:43], v[176:179], v[204:207], v[40:43]
    v_mfma_f32_16x16x32_bf16 v[76:79], v[180:183], v[204:207], v[76:79]
    v_mfma_f32_16x16x32_bf16 v[112:115], v[184:187], v[204:207], v[112:115]
    v_mfma_f32_16x16x32_bf16 v[148:151], v[188:191], v[204:207], v[148:151]
    s_waitcnt lgkmcnt(1)
    v_mfma_f32_16x16x32_bf16 v[44:47], v[176:179], v[208:211], v[44:47]
    v_mfma_f32_16x16x32_bf16 v[80:83], v[180:183], v[208:211], v[80:83]
    v_mfma_f32_16x16x32_bf16 v[116:119], v[184:187], v[208:211], v[116:119]
    v_mfma_f32_16x16x32_bf16 v[152:155], v[188:191], v[208:211], v[152:155]
    s_waitcnt lgkmcnt(0)
    v_mfma_f32_16x16x32_bf16 v[48:51], v[176:179], v[212:215], v[48:51]
    v_mfma_f32_16x16x32_bf16 v[84:87], v[180:183], v[212:215], v[84:87]
    v_mfma_f32_16x16x32_bf16 v[120:123], v[184:187], v[212:215], v[120:123]
    v_mfma_f32_16x16x32_bf16 v[156:159], v[188:191], v[212:215], v[156:159]
    s_waitcnt vmcnt(0)
    v_readfirstlane_b32 s62, v15
    s_nop 1
    s_cmp_lg_u32 s62, 0
    s_cbranch_scc1 Lnok_168
    s_mov_b32 s28, s56
    s_mov_b32 s29, s57
    s_mov_b32 s30, 256
    s_mov_b32 s31, 0x00020000
    v_mov_b32 v14, 0
    s_mov_b32 s32, 0
Lnonce_169:
    buffer_load_dword v15, v14, s[28:31], 0 offen sc1
    s_waitcnt vmcnt(0)
    v_readfirstlane_b32 s62, v15
    s_add_u32 s32, s32, 1
    s_cmp_gt_u32 s32, 65536
    s_cbranch_scc1 Lnonce_o_170
    s_cmp_eq_u32 s62, 0
    s_cbranch_scc1 Lnonce_169
Lnonce_o_170:
Lnok_168:
    s_movk_i32 s19, 488
    v_mul_u32_u24 v3, s19, v1
    v_lshl_add_u32 v3, v2, 3, v3
    s_lshl_b32 s19, s3, 7
    v_add_u32 v3, s19, v3
    v_cvt_pk_bf16_f32 v160, v16, v17
    v_cvt_pk_bf16_f32 v161, v18, v19
    ds_write_b64 v3, v[160:161] offset:0
    v_cvt_pk_bf16_f32 v162, v20, v21
    v_cvt_pk_bf16_f32 v163, v22, v23
    ds_write_b64 v3, v[162:163] offset:7808
    v_cvt_pk_bf16_f32 v164, v24, v25
    v_cvt_pk_bf16_f32 v165, v26, v27
    ds_write_b64 v3, v[164:165] offset:15616
    v_cvt_pk_bf16_f32 v166, v28, v29
    v_cvt_pk_bf16_f32 v167, v30, v31
    ds_write_b64 v3, v[166:167] offset:23424
    v_cvt_pk_bf16_f32 v168, v32, v33
    v_cvt_pk_bf16_f32 v169, v34, v35
    ds_write_b64 v3, v[168:169] offset:31232
    v_cvt_pk_bf16_f32 v170, v36, v37
    v_cvt_pk_bf16_f32 v171, v38, v39
    ds_write_b64 v3, v[170:171] offset:39040
    v_cvt_pk_bf16_f32 v172, v40, v41
    v_cvt_pk_bf16_f32 v173, v42, v43
    ds_write_b64 v3, v[172:173] offset:46848
    v_cvt_pk_bf16_f32 v174, v44, v45
    v_cvt_pk_bf16_f32 v175, v46, v47
    ds_write_b64 v3, v[174:175] offset:54656
    v_cvt_pk_bf16_f32 v176, v48, v49
    v_cvt_pk_bf16_f32 v177, v50, v51
    ds_write_b64 v3, v[176:177] offset:62464
    v_cvt_pk_bf16_f32 v178, v52, v53
    v_cvt_pk_bf16_f32 v179, v54, v55
    ds_write_b64 v3, v[178:179] offset:32
    v_cvt_pk_bf16_f32 v180, v56, v57
    v_cvt_pk_bf16_f32 v181, v58, v59
    ds_write_b64 v3, v[180:181] offset:7840
    v_cvt_pk_bf16_f32 v182, v60, v61
    v_cvt_pk_bf16_f32 v183, v62, v63
    ds_write_b64 v3, v[182:183] offset:15648
    v_cvt_pk_bf16_f32 v160, v64, v65
    v_cvt_pk_bf16_f32 v161, v66, v67
    ds_write_b64 v3, v[160:161] offset:23456
    v_cvt_pk_bf16_f32 v162, v68, v69
    v_cvt_pk_bf16_f32 v163, v70, v71
    ds_write_b64 v3, v[162:163] offset:31264
    v_cvt_pk_bf16_f32 v164, v72, v73
    v_cvt_pk_bf16_f32 v165, v74, v75
    ds_write_b64 v3, v[164:165] offset:39072
    v_cvt_pk_bf16_f32 v166, v76, v77
    v_cvt_pk_bf16_f32 v167, v78, v79
    ds_write_b64 v3, v[166:167] offset:46880
    v_cvt_pk_bf16_f32 v168, v80, v81
    v_cvt_pk_bf16_f32 v169, v82, v83
    ds_write_b64 v3, v[168:169] offset:54688
    v_cvt_pk_bf16_f32 v170, v84, v85
    v_cvt_pk_bf16_f32 v171, v86, v87
    ds_write_b64 v3, v[170:171] offset:62496
    v_cvt_pk_bf16_f32 v172, v88, v89
    v_cvt_pk_bf16_f32 v173, v90, v91
    ds_write_b64 v3, v[172:173] offset:64
    v_cvt_pk_bf16_f32 v174, v92, v93
    v_cvt_pk_bf16_f32 v175, v94, v95
    ds_write_b64 v3, v[174:175] offset:7872
    v_cvt_pk_bf16_f32 v176, v96, v97
    v_cvt_pk_bf16_f32 v177, v98, v99
    ds_write_b64 v3, v[176:177] offset:15680
    v_cvt_pk_bf16_f32 v178, v100, v101
    v_cvt_pk_bf16_f32 v179, v102, v103
    ds_write_b64 v3, v[178:179] offset:23488
    v_cvt_pk_bf16_f32 v180, v104, v105
    v_cvt_pk_bf16_f32 v181, v106, v107
    ds_write_b64 v3, v[180:181] offset:31296
    v_cvt_pk_bf16_f32 v182, v108, v109
    v_cvt_pk_bf16_f32 v183, v110, v111
    ds_write_b64 v3, v[182:183] offset:39104
    v_cvt_pk_bf16_f32 v160, v112, v113
    v_cvt_pk_bf16_f32 v161, v114, v115
    ds_write_b64 v3, v[160:161] offset:46912
    v_cvt_pk_bf16_f32 v162, v116, v117
    v_cvt_pk_bf16_f32 v163, v118, v119
    ds_write_b64 v3, v[162:163] offset:54720
    v_cvt_pk_bf16_f32 v164, v120, v121
    v_cvt_pk_bf16_f32 v165, v122, v123
    ds_write_b64 v3, v[164:165] offset:62528
    s_cmp_lg_u32 s5, 0
    s_cbranch_scc1 Lg_171
    s_lshl_b32 s18, s4, 9
    s_add_u32 s8, s58, 5767168
    s_addc_u32 s9, s59, 0
    s_add_u32 s8, s8, s18
    s_addc_u32 s9, s9, 0
    s_mov_b32 s10, 512
    s_mov_b32 s11, 0x00020000
    v_lshlrev_b32 v4, 2, v1
    s_mov_b64 s[12:13], exec
    s_mov_b64 exec, 0xffff
    v_mul_f32 v128, 0xbfb8aa3b, v128
    v_exp_f32 v128, v128
    s_nop 0
    v_add_f32 v128, 1.0, v128
    v_rcp_f32 v128, v128
    buffer_store_dword v128, v4, s[8:11], 0 offen offset:0 sc1
    v_mul_f32 v132, 0xbfb8aa3b, v132
    v_exp_f32 v132, v132
    s_nop 0
    v_add_f32 v132, 1.0, v132
    v_rcp_f32 v132, v132
    buffer_store_dword v132, v4, s[8:11], 0 offen offset:64 sc1
    v_mul_f32 v136, 0xbfb8aa3b, v136
    v_exp_f32 v136, v136
    s_nop 0
    v_add_f32 v136, 1.0, v136
    v_rcp_f32 v136, v136
    buffer_store_dword v136, v4, s[8:11], 0 offen offset:128 sc1
    v_mul_f32 v140, 0xbfb8aa3b, v140
    v_exp_f32 v140, v140
    s_nop 0
    v_add_f32 v140, 1.0, v140
    v_rcp_f32 v140, v140
    buffer_store_dword v140, v4, s[8:11], 0 offen offset:192 sc1
    v_mul_f32 v144, 0xbfb8aa3b, v144
    v_exp_f32 v144, v144
    s_nop 0
    v_add_f32 v144, 1.0, v144
    v_rcp_f32 v144, v144
    buffer_store_dword v144, v4, s[8:11], 0 offen offset:256 sc1
    v_mul_f32 v148, 0xbfb8aa3b, v148
    v_exp_f32 v148, v148
    s_nop 0
    v_add_f32 v148, 1.0, v148
    v_rcp_f32 v148, v148
    buffer_store_dword v148, v4, s[8:11], 0 offen offset:320 sc1
    v_mul_f32 v152, 0xbfb8aa3b, v152
    v_exp_f32 v152, v152
    s_nop 0
    v_add_f32 v152, 1.0, v152
    v_rcp_f32 v152, v152
    buffer_store_dword v152, v4, s[8:11], 0 offen offset:384 sc1
    v_mul_f32 v156, 0xbfb8aa3b, v156
    v_exp_f32 v156, v156
    s_nop 0
    v_add_f32 v156, 1.0, v156
    v_rcp_f32 v156, v156
    buffer_store_dword v156, v4, s[8:11], 0 offen offset:448 sc1
    s_mov_b64 exec, s[12:13]
Lg_171:
    s_waitcnt lgkmcnt(0)
    s_barrier
    s_branch Lq_att_158
Lq_w_156:
    s_sub_u32 s16, s3, 4
    s_mov_b32 s8, s38
    s_mov_b32 s9, s39
    s_mov_b32 s10, 2457600
    s_mov_b32 s11, 0x00020000
    s_mul_i32 s17, s5, 160
    s_and_b32 s18, s5, 1
    s_lshl_b32 s18, s18, 5
    s_sub_u32 s17, s17, s18
    s_mul_i32 s18, s16, 6144
    s_lshl_b32 s21, s7, 1
    s_mul_i32 s20, s21, 122880
    s_add_u32 s21, s21, 1
    s_cmp_eq_u32 s21, 20
    s_cselect_b32 s21, 0, s21
    s_mul_i32 s23, s16, 384
    s_add_u32 s22, s23, 0
    v_add_u32 v12, s22, v0
    s_mov_b32 s19, 911
    v_mul_u32_u24 v13, s19, v12
    v_lshrrev_b32 v13, 15, v13
    v_mul_u32_u24 v14, 36, v13
    v_sub_u32 v14, v12, v14
    v_lshrrev_b32 v15, 2, v13
    v_and_b32 v15, 2, v15
    v_xor_b32 v14, v14, v15
    s_mov_b32 s19, 86
    v_mul_u32_u24 v15, s19, v14
    v_lshrrev_b32 v15, 10, v15
    v_mul_u32_u24 v16, 12, v15
    v_sub_u32 v16, v14, v16
    s_movk_i32 s19, 1280
    v_mul_u32_u24 v15, s19, v15
    v_lshl_add_u32 v15, v16, 4, v15
    s_movk_i32 s19, 3840
    v_mul_u32_u24 v13, s19, v13
    v_add3_u32 v2, v13, v15, s17
    s_add_u32 m0, s18, 0
    s_nop 0
    buffer_load_dwordx4 v2, s[8:11], s20 offen lds
    s_add_u32 s22, s23, 64
    v_add_u32 v12, s22, v0
    s_mov_b32 s19, 911
    v_mul_u32_u24 v13, s19, v12
    v_lshrrev_b32 v13, 15, v13
    v_mul_u32_u24 v14, 36, v13
    v_sub_u32 v14, v12, v14
    v_lshrrev_b32 v15, 2, v13
    v_and_b32 v15, 2, v15
    v_xor_b32 v14, v14, v15
    s_mov_b32 s19, 86
    v_mul_u32_u24 v15, s19, v14
    v_lshrrev_b32 v15, 10, v15
    v_mul_u32_u24 v16, 12, v15
    v_sub_u32 v16, v14, v16
    s_movk_i32 s19, 1280
    v_mul_u32_u24 v15, s19, v15
    v_lshl_add_u32 v15, v16, 4, v15
    s_movk_i32 s19, 3840
    v_mul_u32_u24 v13, s19, v13
    v_add3_u32 v3, v13, v15, s17
    s_add_u32 m0, s18, 1024
    s_nop 0
    buffer_load_dwordx4 v3, s[8:11], s20 offen lds
    s_add_u32 s22, s23, 128
    v_add_u32 v12, s22, v0
    s_mov_b32 s19, 911
    v_mul_u32_u24 v13, s19, v12
    v_lshrrev_b32 v13, 15, v13
    v_mul_u32_u24 v14, 36, v13
    v_sub_u32 v14, v12, v14
    v_lshrrev_b32 v15, 2, v13
    v_and_b32 v15, 2, v15
    v_xor_b32 v14, v14, v15
    s_mov_b32 s19, 86
    v_mul_u32_u24 v15, s19, v14
    v_lshrrev_b32 v15, 10, v15
    v_mul_u32_u24 v16, 12, v15
    v_sub_u32 v16, v14, v16
    s_movk_i32 s19, 1280
    v_mul_u32_u24 v15, s19, v15
    v_lshl_add_u32 v15, v16, 4, v15
    s_movk_i32 s19, 3840
    v_mul_u32_u24 v13, s19, v13
    v_add3_u32 v4, v13, v15, s17
    s_add_u32 m0, s18, 2048
    s_nop 0
    buffer_load_dwordx4 v4, s[8:11], s20 offen lds
    s_add_u32 s22, s23, 192
    v_add_u32 v12, s22, v0
    s_mov_b32 s19, 911
    v_mul_u32_u24 v13, s19, v12
    v_lshrrev_b32 v13, 15, v13
    v_mul_u32_u24 v14, 36, v13
    v_sub_u32 v14, v12, v14
    v_lshrrev_b32 v15, 2, v13
    v_and_b32 v15, 2, v15
    v_xor_b32 v14, v14, v15
    s_mov_b32 s19, 86
    v_mul_u32_u24 v15, s19, v14
    v_lshrrev_b32 v15, 10, v15
    v_mul_u32_u24 v16, 12, v15
    v_sub_u32 v16, v14, v16
    s_movk_i32 s19, 1280
    v_mul_u32_u24 v15, s19, v15
    v_lshl_add_u32 v15, v16, 4, v15
    s_movk_i32 s19, 3840
    v_mul_u32_u24 v13, s19, v13
    v_add3_u32 v5, v13, v15, s17
    s_add_u32 m0, s18, 3072
    s_nop 0
    buffer_load_dwordx4 v5, s[8:11], s20 offen lds
    s_add_u32 s22, s23, 256
    v_add_u32 v12, s22, v0
    s_mov_b32 s19, 911
    v_mul_u32_u24 v13, s19, v12
    v_lshrrev_b32 v13, 15, v13
    v_mul_u32_u24 v14, 36, v13
    v_sub_u32 v14, v12, v14
    v_lshrrev_b32 v15, 2, v13
    v_and_b32 v15, 2, v15
    v_xor_b32 v14, v14, v15
    s_mov_b32 s19, 86
    v_mul_u32_u24 v15, s19, v14
    v_lshrrev_b32 v15, 10, v15
    v_mul_u32_u24 v16, 12, v15
    v_sub_u32 v16, v14, v16
    s_movk_i32 s19, 1280
    v_mul_u32_u24 v15, s19, v15
    v_lshl_add_u32 v15, v16, 4, v15
    s_movk_i32 s19, 3840
    v_mul_u32_u24 v13, s19, v13
    v_add3_u32 v6, v13, v15, s17
    s_add_u32 m0, s18, 4096
    s_nop 0
    buffer_load_dwordx4 v6, s[8:11], s20 offen lds
    s_add_u32 s22, s23, 320
    v_add_u32 v12, s22, v0
    s_mov_b32 s19, 911
    v_mul_u32_u24 v13, s19, v12
    v_lshrrev_b32 v13, 15, v13
    v_mul_u32_u24 v14, 36, v13
    v_sub_u32 v14, v12, v14
    v_lshrrev_b32 v15, 2, v13
    v_and_b32 v15, 2, v15
    v_xor_b32 v14, v14, v15
    s_mov_b32 s19, 86
    v_mul_u32_u24 v15, s19, v14
    v_lshrrev_b32 v15, 10, v15
    v_mul_u32_u24 v16, 12, v15
    v_sub_u32 v16, v14, v16
    s_movk_i32 s19, 1280
    v_mul_u32_u24 v15, s19, v15
    v_lshl_add_u32 v15, v16, 4, v15
    s_movk_i32 s19, 3840
    v_mul_u32_u24 v13, s19, v13
    v_add3_u32 v7, v13, v15, s17
    s_add_u32 m0, s18, 5120
    s_nop 0
    buffer_load_dwordx4 v7, s[8:11], s20 offen lds
    s_mul_i32 s20, s21, 122880
    s_add_u32 s21, s21, 1
    s_cmp_eq_u32 s21, 20
    s_cselect_b32 s21, 0, s21
    s_add_u32 m0, s18, 18432
    s_nop 0
    buffer_load_dwordx4 v2, s[8:11], s20 offen lds
    s_add_u32 m0, s18, 19456
    s_nop 0
    buffer_load_dwordx4 v3, s[8:11], s20 offen lds
    s_add_u32 m0, s18, 20480
    s_nop 0
    buffer_load_dwordx4 v4, s[8:11], s20 offen lds
    s_add_u32 m0, s18, 21504
    s_nop 0
    buffer_load_dwordx4 v5, s[8:11], s20 offen lds
    s_add_u32 m0, s18, 22528
    s_nop 0
    buffer_load_dwordx4 v6, s[8:11], s20 offen lds
    s_add_u32 m0, s18, 23552
    s_nop 0
    buffer_load_dwordx4 v7, s[8:11], s20 offen lds
    s_sub_u32 s27, s3, 4
    s_lshl_b32 s27, s27, 8
    s_add_u32 s27, s27, s2
    s_cmp_ge_u32 s27, 352
    s_cbranch_scc1 Lpk_172
    s_and_b32 s32, s27, 7
    s_lshr_b32 s33, s27, 3
    s_cmp_lt_u32 s33, 20
    s_cselect_b32 s28, s40, s50
    s_cselect_b32 s29, s41, s51
    s_cselect_b32 s34, 0, 20
    s_mov_b32 s30, 983040
    s_cselect_b32 s30, 819200, s30
    s_mov_b32 s31, 0x00020000
    s_sub_u32 s34, s33, s34
    s_mul_i32 s34, s34, 40960
    s_mul_i32 s35, s32, 160
    s_and_b32 s32, s32, 1
    s_lshl_b32 s32, s32, 5
    s_sub_u32 s35, s35, s32
    s_add_u32 s34, s34, s35
    s_sub_u32 s35, s3, 4
    s_mul_i32 s35, s35, 6144
    s_add_u32 s35, s35, 149504
    v_add_u32 v17, 0, v0
    s_mov_b32 s32, 171
    v_mul_u32_u24 v18, s32, v17
    v_lshrrev_b32 v18, 11, v18
    v_mul_u32_u24 v19, 12, v18
    v_sub_u32 v19, v17, v19
    s_movk_i32 s32, 1280
    v_mul_u32_u24 v18, s32, v18
    v_lshl_add_u32 v18, v19, 4, v18
    s_add_u32 m0, s35, 0
    s_nop 0
    buffer_load_dwordx4 v18, s[28:31], s34 offen lds
    v_add_u32 v17, 64, v0
    s_mov_b32 s32, 171
    v_mul_u32_u24 v18, s32, v17
    v_lshrrev_b32 v18, 11, v18
    v_mul_u32_u24 v19, 12, v18
    v_sub_u32 v19, v17, v19
    s_movk_i32 s32, 1280
    v_mul_u32_u24 v18, s32, v18
    v_lshl_add_u32 v18, v19, 4, v18
    s_add_u32 m0, s35, 1024
    s_nop 0
    buffer_load_dwordx4 v18, s[28:31], s34 offen lds
    v_add_u32 v17, 128, v0
    s_mov_b32 s32, 171
    v_mul_u32_u24 v18, s32, v17
    v_lshrrev_b32 v18, 11, v18
    v_mul_u32_u24 v19, 12, v18
    v_sub_u32 v19, v17, v19
    s_movk_i32 s32, 1280
    v_mul_u32_u24 v18, s32, v18
    v_lshl_add_u32 v18, v19, 4, v18
    s_add_u32 m0, s35, 2048
    s_nop 0
    buffer_load_dwordx4 v18, s[28:31], s34 offen lds
    v_add_u32 v17, 192, v0
    s_mov_b32 s32, 171
    v_mul_u32_u24 v18, s32, v17
    v_lshrrev_b32 v18, 11, v18
    v_mul_u32_u24 v19, 12, v18
    v_sub_u32 v19, v17, v19
    s_movk_i32 s32, 1280
    v_mul_u32_u24 v18, s32, v18
    v_lshl_add_u32 v18, v19, 4, v18
    s_add_u32 m0, s35, 3072
    s_nop 0
    buffer_load_dwordx4 v18, s[28:31], s34 offen lds
    v_add_u32 v17, 256, v0
    s_mov_b32 s32, 171
    v_mul_u32_u24 v18, s32, v17
    v_lshrrev_b32 v18, 11, v18
    v_mul_u32_u24 v19, 12, v18
    v_sub_u32 v19, v17, v19
    s_movk_i32 s32, 1280
    v_mul_u32_u24 v18, s32, v18
    v_lshl_add_u32 v18, v19, 4, v18
    s_add_u32 m0, s35, 4096
    s_nop 0
    buffer_load_dwordx4 v18, s[28:31], s34 offen lds
    v_add_u32 v17, 320, v0
    s_mov_b32 s32, 171
    v_mul_u32_u24 v18, s32, v17
    v_lshrrev_b32 v18, 11, v18
    v_mul_u32_u24 v19, 12, v18
    v_sub_u32 v19, v17, v19
    s_movk_i32 s32, 1280
    v_mul_u32_u24 v18, s32, v18
    v_lshl_add_u32 v18, v19, 4, v18
    s_add_u32 m0, s35, 5120
    s_nop 0
    buffer_load_dwordx4 v18, s[28:31], s34 offen lds
Lpk_172:
    s_waitcnt vmcnt(6)
    s_barrier
    s_mul_i32 s20, s21, 122880
    s_add_u32 s21, s21, 1
    s_cmp_eq_u32 s21, 20
    s_cselect_b32 s21, 0, s21
    s_add_u32 m0, s18, 36864
    s_nop 0
    buffer_load_dwordx4 v2, s[8:11], s20 offen lds
    s_add_u32 m0, s18, 37888
    s_nop 0
    buffer_load_dwordx4 v3, s[8:11], s20 offen lds
    s_add_u32 m0, s18, 38912
    s_nop 0
    buffer_load_dwordx4 v4, s[8:11], s20 offen lds
    s_add_u32 m0, s18, 39936
    s_nop 0
    buffer_load_dwordx4 v5, s[8:11], s20 offen lds
    s_add_u32 m0, s18, 40960
    s_nop 0
    buffer_load_dwordx4 v6, s[8:11], s20 offen lds
    s_add_u32 m0, s18, 41984
    s_nop 0
    buffer_load_dwordx4 v7, s[8:11], s20 offen lds
    s_mul_i32 s20, s21, 122880
    s_add_u32 s21, s21, 1
    s_cmp_eq_u32 s21, 20
    s_cselect_b32 s21, 0, s21
    s_add_u32 m0, s18, 55296
    s_nop 0
    buffer_load_dwordx4 v2, s[8:11], s20 offen lds
    s_add_u32 m0, s18, 56320
    s_nop 0
    buffer_load_dwordx4 v3, s[8:11], s20 offen lds
    s_add_u32 m0, s18, 57344
    s_nop 0
    buffer_load_dwordx4 v4, s[8:11], s20 offen lds
    s_add_u32 m0, s18, 58368
    s_nop 0
    buffer_load_dwordx4 v5, s[8:11], s20 offen lds
    s_add_u32 m0, s18, 59392
    s_nop 0
    buffer_load_dwordx4 v6, s[8:11], s20 offen lds
    s_add_u32 m0, s18, 60416
    s_nop 0
    buffer_load_dwordx4 v7, s[8:11], s20 offen lds
    s_waitcnt vmcnt(12)
    s_barrier
    s_mul_i32 s20, s21, 122880
    s_add_u32 s21, s21, 1
    s_cmp_eq_u32 s21, 20
    s_cselect_b32 s21, 0, s21
    s_add_u32 m0, s18, 73728
    s_nop 0
    buffer_load_dwordx4 v2, s[8:11], s20 offen lds
    s_add_u32 m0, s18, 74752
    s_nop 0
    buffer_load_dwordx4 v3, s[8:11], s20 offen lds
    s_add_u32 m0, s18, 75776
    s_nop 0
    buffer_load_dwordx4 v4, s[8:11], s20 offen lds
    s_add_u32 m0, s18, 76800
    s_nop 0
    buffer_load_dwordx4 v5, s[8:11], s20 offen lds
    s_add_u32 m0, s18, 77824
    s_nop 0
    buffer_load_dwordx4 v6, s[8:11], s20 offen lds
    s_add_u32 m0, s18, 78848
    s_nop 0
    buffer_load_dwordx4 v7, s[8:11], s20 offen lds
    s_waitcnt vmcnt(12)
    s_barrier
    s_mul_i32 s20, s21, 122880
    s_add_u32 s21, s21, 1
    s_cmp_eq_u32 s21, 20
    s_cselect_b32 s21, 0, s21
    s_add_u32 m0, s18, 0
    s_nop 0
    buffer_load_dwordx4 v2, s[8:11], s20 offen lds
    s_add_u32 m0, s18, 1024
    s_nop 0
    buffer_load_dwordx4 v3, s[8:11], s20 offen lds
    s_add_u32 m0, s18, 2048
    s_nop 0
    buffer_load_dwordx4 v4, s[8:11], s20 offen lds
    s_add_u32 m0, s18, 3072
    s_nop 0
    buffer_load_dwordx4 v5, s[8:11], s20 offen lds
    s_add_u32 m0, s18, 4096
    s_nop 0
    buffer_load_dwordx4 v6, s[8:11], s20 offen lds
    s_add_u32 m0, s18, 5120
    s_nop 0
    buffer_load_dwordx4 v7, s[8:11], s20 offen lds
    s_waitcnt vmcnt(12)
    s_barrier
    s_mul_i32 s20, s21, 122880
    s_add_u32 s21, s21, 1
    s_cmp_eq_u32 s21, 20
    s_cselect_b32 s21, 0, s21
    s_add_u32 m0, s18, 18432
    s_nop 0
    buffer_load_dwordx4 v2, s[8:11], s20 offen lds
    s_add_u32 m0, s18, 19456
    s_nop 0
    buffer_load_dwordx4 v3, s[8:11], s20 offen lds
    s_add_u32 m0, s18, 20480
    s_nop 0
    buffer_load_dwordx4 v4, s[8:11], s20 offen lds
    s_add_u32 m0, s18, 21504
    s_nop 0
    buffer_load_dwordx4 v5, s[8:11], s20 offen lds
    s_add_u32 m0, s18, 22528
    s_nop 0
    buffer_load_dwordx4 v6, s[8:11], s20 offen lds
    s_add_u32 m0, s18, 23552
    s_nop 0
    buffer_load_dwordx4 v7, s[8:11], s20 offen lds
    s_waitcnt vmcnt(12)
    s_barrier
    s_mul_i32 s20, s21, 122880
    s_add_u32 s21, s21, 1
    s_cmp_eq_u32 s21, 20
    s_cselect_b32 s21, 0, s21
    s_add_u32 m0, s18, 36864
    s_nop 0
    buffer_load_dwordx4 v2, s[8:11], s20 offen lds
    s_add_u32 m0, s18, 37888
    s_nop 0
    buffer_load_dwordx4 v3, s[8:11], s20 offen lds
    s_add_u32 m0, s18, 38912
    s_nop 0
    buffer_load_dwordx4 v4, s[8:11], s20 offen lds
    s_add_u32 m0, s18, 39936
    s_nop 0
    buffer_load_dwordx4 v5, s[8:11], s20 offen lds
    s_add_u32 m0, s18, 40960
    s_nop 0
    buffer_load_dwordx4 v6, s[8:11], s20 offen lds
    s_add_u32 m0, s18, 41984
    s_nop 0
    buffer_load_dwordx4 v7, s[8:11], s20 offen lds
    s_waitcnt vmcnt(12)
    s_barrier
    s_mul_i32 s20, s21, 122880
    s_add_u32 s21, s21, 1
    s_cmp_eq_u32 s21, 20
    s_cselect_b32 s21, 0, s21
    s_add_u32 m0, s18, 55296
    s_nop 0
    buffer_load_dwordx4 v2, s[8:11], s20 offen lds
    s_add_u32 m0, s18, 56320
    s_nop 0
    buffer_load_dwordx4 v3, s[8:11], s20 offen lds
    s_add_u32 m0, s18, 57344
    s_nop 0
    buffer_load_dwordx4 v4, s[8:11], s20 offen lds
    s_add_u32 m0, s18, 58368
    s_nop 0
    buffer_load_dwordx4 v5, s[8:11], s20 offen lds
    s_add_u32 m0, s18, 59392
    s_nop 0
    buffer_load_dwordx4 v6, s[8:11], s20 offen lds
    s_add_u32 m0, s18, 60416
    s_nop 0
    buffer_load_dwordx4 v7, s[8:11], s20 offen lds
    s_waitcnt vmcnt(12)
    s_barrier
    s_mul_i32 s20, s21, 122880
    s_add_u32 s21, s21, 1
    s_cmp_eq_u32 s21, 20
    s_cselect_b32 s21, 0, s21
    s_add_u32 m0, s18, 73728
    s_nop 0
    buffer_load_dwordx4 v2, s[8:11], s20 offen lds
    s_add_u32 m0, s18, 74752
    s_nop 0
    buffer_load_dwordx4 v3, s[8:11], s20 offen lds
    s_add_u32 m0, s18, 75776
    s_nop 0
    buffer_load_dwordx4 v4, s[8:11], s20 offen lds
    s_add_u32 m0, s18, 76800
    s_nop 0
    buffer_load_dwordx4 v5, s[8:11], s20 offen lds
    s_add_u32 m0, s18, 77824
    s_nop 0
    buffer_load_dwordx4 v6, s[8:11], s20 offen lds
    s_add_u32 m0, s18, 78848
    s_nop 0
    buffer_load_dwordx4 v7, s[8:11], s20 offen lds
    s_mov_b32 s28, s56
    s_mov_b32 s29, s57
    s_mov_b32 s30, 256
    s_mov_b32 s31, 0x00020000
    v_mov_b32 v14, 0
    buffer_load_dword v15, v14, s[28:31], 0 offen sc1
    s_waitcnt vmcnt(13)
    s_barrier
    s_mul_i32 s20, s21, 122880
    s_add_u32 s21, s21, 1
    s_cmp_eq_u32 s21, 20
    s_cselect_b32 s21, 0, s21
    s_add_u32 m0, s18, 0
    s_nop 0
    buffer_load_dwordx4 v2, s[8:11], s20 offen lds
    s_add_u32 m0, s18, 1024
    s_nop 0
    buffer_load_dwordx4 v3, s[8:11], s20 offen lds
    s_add_u32 m0, s18, 2048
    s_nop 0
    buffer_load_dwordx4 v4, s[8:11], s20 offen lds
    s_add_u32 m0, s18, 3072
    s_nop 0
    buffer_load_dwordx4 v5, s[8:11], s20 offen lds
    s_add_u32 m0, s18, 4096
    s_nop 0
    buffer_load_dwordx4 v6, s[8:11], s20 offen lds
    s_add_u32 m0, s18, 5120
    s_nop 0
    buffer_load_dwordx4 v7, s[8:11], s20 offen lds
    s_waitcnt vmcnt(13)
    s_barrier
    s_mul_i32 s20, s21, 122880
    s_add_u32 s21, s21, 1
    s_cmp_eq_u32 s21, 20
    s_cselect_b32 s21, 0, s21
    s_add_u32 m0, s18, 18432
    s_nop 0
    buffer_load_dwordx4 v2, s[8:11], s20 offen lds
    s_add_u32 m0, s18, 19456
    s_nop 0
    buffer_load_dwordx4 v3, s[8:11], s20 offen lds
    s_add_u32 m0, s18, 20480
    s_nop 0
    buffer_load_dwordx4 v4, s[8:11], s20 offen lds
    s_add_u32 m0, s18, 21504
    s_nop 0
    buffer_load_dwordx4 v5, s[8:11], s20 offen lds
    s_add_u32 m0, s18, 22528
    s_nop 0
    buffer_load_dwordx4 v6, s[8:11], s20 offen lds
    s_add_u32 m0, s18, 23552
    s_nop 0
    buffer_load_dwordx4 v7, s[8:11], s20 offen lds
    s_waitcnt vmcnt(13)
    s_barrier
    s_mul_i32 s20, s21, 122880
    s_add_u32 s21, s21, 1
    s_cmp_eq_u32 s21, 20
    s_cselect_b32 s21, 0, s21
    s_add_u32 m0, s18, 36864
    s_nop 0
    buffer_load_dwordx4 v2, s[8:11], s20 offen lds
    s_add_u32 m0, s18, 37888
    s_nop 0
    buffer_load_dwordx4 v3, s[8:11], s20 offen lds
    s_add_u32 m0, s18, 38912
    s_nop 0
    buffer_load_dwordx4 v4, s[8:11], s20 offen lds
    s_add_u32 m0, s18, 39936
    s_nop 0
    buffer_load_dwordx4 v5, s[8:11], s20 offen lds
    s_add_u32 m0, s18, 40960
    s_nop 0
    buffer_load_dwordx4 v6, s[8:11], s20 offen lds
    s_add_u32 m0, s18, 41984
    s_nop 0
    buffer_load_dwordx4 v7, s[8:11], s20 offen lds
    s_waitcnt vmcnt(12)
    s_barrier
    s_mul_i32 s20, s21, 122880
    s_add_u32 s21, s21, 1
    s_cmp_eq_u32 s21, 20
    s_cselect_b32 s21, 0, s21
    s_add_u32 m0, s18, 55296
    s_nop 0
    buffer_load_dwordx4 v2, s[8:11], s20 offen lds
    s_add_u32 m0, s18, 56320
    s_nop 0
    buffer_load_dwordx4 v3, s[8:11], s20 offen lds
    s_add_u32 m0, s18, 57344
    s_nop 0
    buffer_load_dwordx4 v4, s[8:11], s20 offen lds
    s_add_u32 m0, s18, 58368
    s_nop 0
    buffer_load_dwordx4 v5, s[8:11], s20 offen lds
    s_add_u32 m0, s18, 59392
    s_nop 0
    buffer_load_dwordx4 v6, s[8:11], s20 offen lds
    s_add_u32 m0, s18, 60416
    s_nop 0
    buffer_load_dwordx4 v7, s[8:11], s20 offen lds
    s_waitcnt vmcnt(12)
    s_barrier
    s_mul_i32 s20, s21, 122880
    s_add_u32 s21, s21, 1
    s_cmp_eq_u32 s21, 20
    s_cselect_b32 s21, 0, s21
    s_add_u32 m0, s18, 73728
    s_nop 0
    buffer_load_dwordx4 v2, s[8:11], s20 offen lds
    s_add_u32 m0, s18, 74752
    s_nop 0
    buffer_load_dwordx4 v3, s[8:11], s20 offen lds
    s_add_u32 m0, s18, 75776
    s_nop 0
    buffer_load_dwordx4 v4, s[8:11], s20 offen lds
    s_add_u32 m0, s18, 76800
    s_nop 0
    buffer_load_dwordx4 v5, s[8:11], s20 offen lds
    s_add_u32 m0, s18, 77824
    s_nop 0
    buffer_load_dwordx4 v6, s[8:11], s20 offen lds
    s_add_u32 m0, s18, 78848
    s_nop 0
    buffer_load_dwordx4 v7, s[8:11], s20 offen lds
    s_waitcnt vmcnt(18)
    v_readfirstlane_b32 s62, v15
    s_nop 1
    s_cmp_lg_u32 s62, 0
    s_cbranch_scc1 Lnok_173
    s_mov_b32 s28, s56
    s_mov_b32 s29, s57
    s_mov_b32 s30, 256
    s_mov_b32 s31, 0x00020000
    v_mov_b32 v14, 0
    s_mov_b32 s32, 0
Lnonce_174:
    buffer_load_dword v15, v14, s[28:31], 0 offen sc1
    s_waitcnt vmcnt(0)
    v_readfirstlane_b32 s62, v15
    s_add_u32 s32, s32, 1
    s_cmp_gt_u32 s32, 65536
    s_cbranch_scc1 Lnonce_o_175
    s_cmp_eq_u32 s62, 0
    s_cbranch_scc1 Lnonce_174
Lnonce_o_175:
Lnok_173:
    s_waitcnt vmcnt(12)
    s_barrier
    s_mul_i32 s20, s21, 122880
    s_add_u32 s21, s21, 1
    s_cmp_eq_u32 s21, 20
    s_cselect_b32 s21, 0, s21
    s_add_u32 m0, s18, 0
    s_nop 0
    buffer_load_dwordx4 v2, s[8:11], s20 offen lds
    s_add_u32 m0, s18, 1024
    s_nop 0
    buffer_load_dwordx4 v3, s[8:11], s20 offen lds
    s_add_u32 m0, s18, 2048
    s_nop 0
    buffer_load_dwordx4 v4, s[8:11], s20 offen lds
    s_add_u32 m0, s18, 3072
    s_nop 0
    buffer_load_dwordx4 v5, s[8:11], s20 offen lds
    s_add_u32 m0, s18, 4096
    s_nop 0
    buffer_load_dwordx4 v6, s[8:11], s20 offen lds
    s_add_u32 m0, s18, 5120
    s_nop 0
    buffer_load_dwordx4 v7, s[8:11], s20 offen lds
    s_cmp_lg_u32 s3, 4
    s_cbranch_scc1 Lonly_176
    s_lshl_b32 s24, s61, 7
    s_add_u32 s24, s24, 0
    s_add_u32 s28, s58, 13107200
    s_addc_u32 s29, s59, 0
    s_mov_b32 s30, 16384
    s_mov_b32 s31, 0x00020000
    v_min_u32 v12, 15, v0
    v_lshlrev_b32 v12, 2, v12
    buffer_load_dword v16, v12, s[28:31], s24 offen sc1
Lonly_176:
    s_waitcnt vmcnt(12)
    s_barrier
    s_mul_i32 s20, s21, 122880
    s_add_u32 s21, s21, 1
    s_cmp_eq_u32 s21, 20
    s_cselect_b32 s21, 0, s21
    s_add_u32 m0, s18, 18432
    s_nop 0
    buffer_load_dwordx4 v2, s[8:11], s20 offen lds
    s_add_u32 m0, s18, 19456
    s_nop 0
    buffer_load_dwordx4 v3, s[8:11], s20 offen lds
    s_add_u32 m0, s18, 20480
    s_nop 0
    buffer_load_dwordx4 v4, s[8:11], s20 offen lds
    s_add_u32 m0, s18, 21504
    s_nop 0
    buffer_load_dwordx4 v5, s[8:11], s20 offen lds
    s_add_u32 m0, s18, 22528
    s_nop 0
    buffer_load_dwordx4 v6, s[8:11], s20 offen lds
    s_add_u32 m0, s18, 23552
    s_nop 0
    buffer_load_dwordx4 v7, s[8:11], s20 offen lds
    s_waitcnt vmcnt(12)
    s_barrier
    s_mul_i32 s20, s21, 122880
    s_add_u32 s21, s21, 1
    s_cmp_eq_u32 s21, 20
    s_cselect_b32 s21, 0, s21
    s_add_u32 m0, s18, 36864
    s_nop 0
    buffer_load_dwordx4 v2, s[8:11], s20 offen lds
    s_add_u32 m0, s18, 37888
    s_nop 0
    buffer_load_dwordx4 v3, s[8:11], s20 offen lds
    s_add_u32 m0, s18, 38912
    s_nop 0
    buffer_load_dwordx4 v4, s[8:11], s20 offen lds
    s_add_u32 m0, s18, 39936
    s_nop 0
    buffer_load_dwordx4 v5, s[8:11], s20 offen lds
    s_add_u32 m0, s18, 40960
    s_nop 0
    buffer_load_dwordx4 v6, s[8:11], s20 offen lds
    s_add_u32 m0, s18, 41984
    s_nop 0
    buffer_load_dwordx4 v7, s[8:11], s20 offen lds
    s_waitcnt vmcnt(12)
    s_barrier
    s_mul_i32 s20, s21, 122880
    s_add_u32 s21, s21, 1
    s_cmp_eq_u32 s21, 20
    s_cselect_b32 s21, 0, s21
    s_add_u32 m0, s18, 55296
    s_nop 0
    buffer_load_dwordx4 v2, s[8:11], s20 offen lds
    s_add_u32 m0, s18, 56320
    s_nop 0
    buffer_load_dwordx4 v3, s[8:11], s20 offen lds
    s_add_u32 m0, s18, 57344
    s_nop 0
    buffer_load_dwordx4 v4, s[8:11], s20 offen lds
    s_add_u32 m0, s18, 58368
    s_nop 0
    buffer_load_dwordx4 v5, s[8:11], s20 offen lds
    s_add_u32 m0, s18, 59392
    s_nop 0
    buffer_load_dwordx4 v6, s[8:11], s20 offen lds
    s_add_u32 m0, s18, 60416
    s_nop 0
    buffer_load_dwordx4 v7, s[8:11], s20 offen lds
    s_waitcnt vmcnt(12)
    s_barrier
    s_mul_i32 s20, s21, 122880
    s_add_u32 s21, s21, 1
    s_cmp_eq_u32 s21, 20
    s_cselect_b32 s21, 0, s21
    s_add_u32 m0, s18, 73728
    s_nop 0
    buffer_load_dwordx4 v2, s[8:11], s20 offen lds
    s_add_u32 m0, s18, 74752
    s_nop 0
    buffer_load_dwordx4 v3, s[8:11], s20 offen lds
    s_add_u32 m0, s18, 75776
    s_nop 0
    buffer_load_dwordx4 v4, s[8:11], s20 offen lds
    s_add_u32 m0, s18, 76800
    s_nop 0
    buffer_load_dwordx4 v5, s[8:11], s20 offen lds
    s_add_u32 m0, s18, 77824
    s_nop 0
    buffer_load_dwordx4 v6, s[8:11], s20 offen lds
    s_add_u32 m0, s18, 78848
    s_nop 0
    buffer_load_dwordx4 v7, s[8:11], s20 offen lds
    s_waitcnt vmcnt(12)
    s_barrier
    s_cmp_lg_u32 s3, 4
    s_cbranch_scc1 Lonly_177
    s_lshl_b32 s24, s61, 7
    s_add_u32 s24, s24, 0
    v_cmp_ne_u32 vcc, s62, v16
    s_nop 1
    s_cmp_eq_u64 vcc, 0
    s_cbranch_scc1 Lpok_178
    s_add_u32 s28, s58, 13107200
    s_addc_u32 s29, s59, 0
    s_mov_b32 s30, 16384
    s_mov_b32 s31, 0x00020000
    s_mov_b64 s[32:33], exec
    s_mov_b32 exec_lo, 0xffff
    s_mov_b32 exec_hi, 0x0
    v_lshlrev_b32 v12, 2, v0
    s_mov_b32 s34, 0
Lw_179:
    buffer_load_dword v13, v12, s[28:31], s24 offen sc1
    s_waitcnt vmcnt(0)
    v_cmp_ne_u32 vcc, s62, v13
    s_nop 1
    s_cmp_eq_u64 vcc, 0
    s_cbranch_scc1 Lwok_180
    s_add_u32 s34, s34, 1
    s_cmp_gt_u32 s34, 16384
    s_cbranch_scc1 Lwok_180
    s_sleep 1
    s_branch Lw_179
Lwok_180:
    s_mov_b64 exec, s[32:33]
Lpok_178:
Lonly_177:
    s_waitcnt vmcnt(6)
    s_barrier
    s_waitcnt vmcnt(0)
    s_barrier
    s_mov_b32 s28, s56
    s_mov_b32 s29, s57
    s_mov_b32 s30, 256
    s_mov_b32 s31, 0x00020000
    v_mov_b32 v14, 0
    buffer_load_dword v15, v14, s[28:31], 0 offen sc1
    s_waitcnt vmcnt(0)
    v_readfirstlane_b32 s62, v15
    s_nop 1
    s_cmp_lg_u32 s62, 0
    s_cbranch_scc1 Lnok_181
    s_mov_b32 s28, s56
    s_mov_b32 s29, s57
    s_mov_b32 s30, 256
    s_mov_b32 s31, 0x00020000
    v_mov_b32 v14, 0
    s_mov_b32 s32, 0
Lnonce_182:
    buffer_load_dword v15, v14, s[28:31], 0 offen sc1
    s_waitcnt vmcnt(0)
    v_readfirstlane_b32 s62, v15
    s_add_u32 s32, s32, 1
    s_cmp_gt_u32 s32, 65536
    s_cbranch_scc1 Lnonce_o_183
    s_cmp_eq_u32 s62, 0
    s_cbranch_scc1 Lnonce_182
Lnonce_o_183:
Lnok_181:
    s_cmp_ge_u32 s27, 352
    s_cbranch_scc1 Lpf_184
    s_and_b32 s32, s27, 7
    s_lshr_b32 s33, s27, 3
    v_and_b32 v17, 15, v0
    v_lshrrev_b32 v18, 4, v0
    v_lshrrev_b32 v19, 2, v17
    v_and_b32 v20, 3, v17
    s_cmp_lt_u32 s33, 20
    s_cselect_b32 s34, 3, 2
    s_cselect_b32 s35, 4, 16
    v_lshlrev_b32 v18, s34, v18
    v_add_u32 v18, v18, v19
    v_mul_u32_u24 v18, 192, v18
    v_lshl_add_u32 v18, v20, 3, v18
    s_and_b32 s32, s27, 1
    s_lshl_b32 s32, s32, 5
    s_sub_u32 s34, s3, 4
    s_mul_i32 s34, s34, 6144
    s_add_u32 s34, s34, 149504
    s_add_u32 s34, s34, s32
    v_add_u32 v18, s34, v18
    s_mul_i32 s35, s35, 192
    v_add_u32 v19, s35, v18
    ds_read_b64_tr_b16 v[24:25], v18 offset:0
    ds_read_b64_tr_b16 v[26:27], v19 offset:0
    ds_read_b64_tr_b16 v[28:29], v18 offset:32
    ds_read_b64_tr_b16 v[30:31], v19 offset:32
    ds_read_b64_tr_b16 v[32:33], v18 offset:64
    ds_read_b64_tr_b16 v[34:35], v19 offset:64
    ds_read_b64_tr_b16 v[36:37], v18 offset:96
    ds_read_b64_tr_b16 v[38:39], v19 offset:96
    ds_read_b64_tr_b16 v[40:41], v18 offset:128
    ds_read_b64_tr_b16 v[42:43], v19 offset:128
    s_and_b32 s32, s27, 7
    s_mul_i32 s32, s32, 44
    s_add_u32 s32, s32, s33
    s_mul_i32 s32, s32, 5120
    s_add_u32 s28, s58, 13631488
    s_addc_u32 s29, s59, 0
    s_mov_b32 s30, 1802240
    s_mov_b32 s31, 0x00020000
    v_lshlrev_b32 v20, 4, v0
    s_waitcnt lgkmcnt(0)
    s_add_u32 s33, s32, 0
    buffer_store_dwordx4 v[24:27], v20, s[28:31], s33 offen sc1
    s_add_u32 s33, s32, 1024
    buffer_store_dwordx4 v[28:31], v20, s[28:31], s33 offen sc1
    s_add_u32 s33, s32, 2048
    buffer_store_dwordx4 v[32:35], v20, s[28:31], s33 offen sc1
    s_add_u32 s33, s32, 3072
    buffer_store_dwordx4 v[36:39], v20, s[28:31], s33 offen sc1
    s_add_u32 s33, s32, 4096
    buffer_store_dwordx4 v[40:43], v20, s[28:31], s33 offen sc1
Lpf_184:
    s_branch Lq_ldj_159
Lq_x_157:
    s_mov_b32 s27, 999
    s_mov_b32 s8, s36
    s_mov_b32 s9, s37
    s_mov_b32 s10, 2621440
    s_mov_b32 s11, 0x00020000
    v_lshrrev_b32 v4, 3, v0
    v_and_b32 v5, 7, v0
    v_lshrrev_b32 v6, 1, v4
    v_xor_b32 v7, v5, v6
    s_movk_i32 s19, 1280
    v_mul_u32_u24 v8, s19, v4
    v_lshl_add_u32 v2, v7, 4, v8
    v_xor_b32 v7, 4, v7
    v_lshl_add_u32 v3, v7, 4, v8
    v_add_u32 v3, 10240, v3
    s_lshl_b32 s17, s4, 7
    s_sub_u32 s17, s17, 16
    v_add_u32 v11, s17, v4
    v_max_i32 v11, 0, v11
    v_mul_u32_u24 v11, s19, v11
    v_xor_b32 v7, v5, v6
    v_lshl_add_u32 v9, v7, 4, v11
    v_add_u32 v11, s17, v4
    v_add_u32 v11, 8, v11
    v_max_i32 v11, 0, v11
    v_mul_u32_u24 v11, s19, v11
    v_xor_b32 v7, 4, v7
    v_lshl_add_u32 v10, v7, 4, v11
    s_mul_i32 s17, s17, 1280
    s_mov_b32 s12, s52
    s_mov_b32 s13, s53
    s_mov_b32 s14, 1280
    s_mov_b32 s15, 0x00020000
    v_lshlrev_b32 v12, 4, v0
    s_mov_b32 m0, 147456
    s_nop 0
    buffer_load_dwordx4 v12, s[12:15], 0 offen lds
    buffer_load_dwordx4 v12, s[12:15], 0 offen offset:1024 lds
    s_mov_b32 s22, s7
    s_lshl_b32 s23, s22, 7
    s_add_u32 s22, s22, 1
    s_cmp_eq_u32 s22, 10
    s_cselect_b32 s22, 0, s22
    s_mov_b32 m0, 92160
    s_nop 0
    buffer_load_dwordx4 v9, s[8:11], s23 offen lds
    s_mov_b32 m0, 93184
    s_nop 0
    buffer_load_dwordx4 v10, s[8:11], s23 offen lds
    s_mov_b32 m0, 94208
    s_add_u32 s20, s17, 20480
    s_add_u32 s20, s20, s23
    buffer_load_dwordx4 v2, s[8:11], s20 offen lds
    s_mov_b32 m0, 95232
    s_add_u32 s20, s17, 20480
    s_add_u32 s20, s20, s23
    buffer_load_dwordx4 v3, s[8:11], s20 offen lds
    s_mov_b32 m0, 96256
    s_add_u32 s20, s17, 40960
    s_add_u32 s20, s20, s23
    buffer_load_dwordx4 v2, s[8:11], s20 offen lds
    s_mov_b32 m0, 97280
    s_add_u32 s20, s17, 40960
    s_add_u32 s20, s20, s23
    buffer_load_dwordx4 v3, s[8:11], s20 offen lds
    s_mov_b32 m0, 98304
    s_add_u32 s20, s17, 61440
    s_add_u32 s20, s20, s23
    buffer_load_dwordx4 v2, s[8:11], s20 offen lds
    s_mov_b32 m0, 99328
    s_add_u32 s20, s17, 61440
    s_add_u32 s20, s20, s23
    buffer_load_dwordx4 v3, s[8:11], s20 offen lds
    s_mov_b32 m0, 100352
    s_add_u32 s20, s17, 81920
    s_add_u32 s20, s20, s23
    buffer_load_dwordx4 v2, s[8:11], s20 offen lds
    s_mov_b32 m0, 101376
    s_add_u32 s20, s17, 81920
    s_add_u32 s20, s20, s23
    buffer_load_dwordx4 v3, s[8:11], s20 offen lds
    s_mov_b32 m0, 102400
    s_add_u32 s20, s17, 102400
    s_add_u32 s20, s20, s23
    buffer_load_dwordx4 v2, s[8:11], s20 offen lds
    s_mov_b32 m0, 103424
    s_add_u32 s20, s17, 102400
    s_add_u32 s20, s20, s23
    buffer_load_dwordx4 v3, s[8:11], s20 offen lds
    s_mov_b32 m0, 104448
    s_add_u32 s20, s17, 122880
    s_add_u32 s20, s20, s23
    buffer_load_dwordx4 v2, s[8:11], s20 offen lds
    s_mov_b32 m0, 105472
    s_add_u32 s20, s17, 122880
    s_add_u32 s20, s20, s23
    buffer_load_dwordx4 v3, s[8:11], s20 offen lds
    s_mov_b32 m0, 106496
    s_add_u32 s20, s17, 143360
    s_add_u32 s20, s20, s23
    buffer_load_dwordx4 v2, s[8:11], s20 offen lds
    s_mov_b32 m0, 107520
    s_add_u32 s20, s17, 143360
    s_add_u32 s20, s20, s23
    buffer_load_dwordx4 v3, s[8:11], s20 offen lds
    s_mov_b32 m0, 108544
    s_add_u32 s20, s17, 163840
    s_add_u32 s20, s20, s23
    buffer_load_dwordx4 v2, s[8:11], s20 offen lds
    s_mov_b32 m0, 109568
    s_add_u32 s20, s17, 163840
    s_add_u32 s20, s20, s23
    buffer_load_dwordx4 v3, s[8:11], s20 offen lds
    s_waitcnt vmcnt(0)
    s_barrier
    s_lshl_b32 s23, s22, 7
    s_add_u32 s22, s22, 1
    s_cmp_eq_u32 s22, 10
    s_cselect_b32 s22, 0, s22
    s_mov_b32 m0, 110592
    s_nop 0
    buffer_load_dwordx4 v9, s[8:11], s23 offen lds
    s_mov_b32 m0, 111616
    s_nop 0
    buffer_load_dwordx4 v10, s[8:11], s23 offen lds
    s_mov_b32 m0, 112640
    s_add_u32 s20, s17, 20480
    s_add_u32 s20, s20, s23
    buffer_load_dwordx4 v2, s[8:11], s20 offen lds
    s_mov_b32 m0, 113664
    s_add_u32 s20, s17, 20480
    s_add_u32 s20, s20, s23
    buffer_load_dwordx4 v3, s[8:11], s20 offen lds
    s_mov_b32 m0, 114688
    s_add_u32 s20, s17, 40960
    s_add_u32 s20, s20, s23
    buffer_load_dwordx4 v2, s[8:11], s20 offen lds
    s_mov_b32 m0, 115712
    s_add_u32 s20, s17, 40960
    s_add_u32 s20, s20, s23
    buffer_load_dwordx4 v3, s[8:11], s20 offen lds
    s_mov_b32 m0, 116736
    s_add_u32 s20, s17, 61440
    s_add_u32 s20, s20, s23
    buffer_load_dwordx4 v2, s[8:11], s20 offen lds
    s_mov_b32 m0, 117760
    s_add_u32 s20, s17, 61440
    s_add_u32 s20, s20, s23
    buffer_load_dwordx4 v3, s[8:11], s20 offen lds
    s_mov_b32 m0, 118784
    s_add_u32 s20, s17, 81920
    s_add_u32 s20, s20, s23
    buffer_load_dwordx4 v2, s[8:11], s20 offen lds
    s_mov_b32 m0, 119808
    s_add_u32 s20, s17, 81920
    s_add_u32 s20, s20, s23
    buffer_load_dwordx4 v3, s[8:11], s20 offen lds
    s_mov_b32 m0, 120832
    s_add_u32 s20, s17, 102400
    s_add_u32 s20, s20, s23
    buffer_load_dwordx4 v2, s[8:11], s20 offen lds
    s_mov_b32 m0, 121856
    s_add_u32 s20, s17, 102400
    s_add_u32 s20, s20, s23
    buffer_load_dwordx4 v3, s[8:11], s20 offen lds
    s_mov_b32 m0, 122880
    s_add_u32 s20, s17, 122880
    s_add_u32 s20, s20, s23
    buffer_load_dwordx4 v2, s[8:11], s20 offen lds
    s_mov_b32 m0, 123904
    s_add_u32 s20, s17, 122880
    s_add_u32 s20, s20, s23
    buffer_load_dwordx4 v3, s[8:11], s20 offen lds
    s_mov_b32 m0, 124928
    s_add_u32 s20, s17, 143360
    s_add_u32 s20, s20, s23
    buffer_load_dwordx4 v2, s[8:11], s20 offen lds
    s_mov_b32 m0, 125952
    s_add_u32 s20, s17, 143360
    s_add_u32 s20, s20, s23
    buffer_load_dwordx4 v3, s[8:11], s20 offen lds
    s_mov_b32 m0, 126976
    s_add_u32 s20, s17, 163840
    s_add_u32 s20, s20, s23
    buffer_load_dwordx4 v2, s[8:11], s20 offen lds
    s_mov_b32 m0, 128000
    s_add_u32 s20, s17, 163840
    s_add_u32 s20, s20, s23
    buffer_load_dwordx4 v3, s[8:11], s20 offen lds
    s_waitcnt vmcnt(18)
    s_barrier
    s_lshl_b32 s23, s22, 7
    s_add_u32 s22, s22, 1
    s_cmp_eq_u32 s22, 10
    s_cselect_b32 s22, 0, s22
    s_mov_b32 m0, 129024
    s_nop 0
    buffer_load_dwordx4 v9, s[8:11], s23 offen lds
    s_mov_b32 m0, 130048
    s_nop 0
    buffer_load_dwordx4 v10, s[8:11], s23 offen lds
    s_mov_b32 m0, 131072
    s_add_u32 s20, s17, 20480
    s_add_u32 s20, s20, s23
    buffer_load_dwordx4 v2, s[8:11], s20 offen lds
    s_mov_b32 m0, 132096
    s_add_u32 s20, s17, 20480
    s_add_u32 s20, s20, s23
    buffer_load_dwordx4 v3, s[8:11], s20 offen lds
    s_mov_b32 m0, 133120
    s_add_u32 s20, s17, 40960
    s_add_u32 s20, s20, s23
    buffer_load_dwordx4 v2, s[8:11], s20 offen lds
    s_mov_b32 m0, 134144
    s_add_u32 s20, s17, 40960
    s_add_u32 s20, s20, s23
    buffer_load_dwordx4 v3, s[8:11], s20 offen lds
    s_mov_b32 m0, 135168
    s_add_u32 s20, s17, 61440
    s_add_u32 s20, s20, s23
    buffer_load_dwordx4 v2, s[8:11], s20 offen lds
    s_mov_b32 m0, 136192
    s_add_u32 s20, s17, 61440
    s_add_u32 s20, s20, s23
    buffer_load_dwordx4 v3, s[8:11], s20 offen lds
    s_mov_b32 m0, 137216
    s_add_u32 s20, s17, 81920
    s_add_u32 s20, s20, s23
    buffer_load_dwordx4 v2, s[8:11], s20 offen lds
    s_mov_b32 m0, 138240
    s_add_u32 s20, s17, 81920
    s_add_u32 s20, s20, s23
    buffer_load_dwordx4 v3, s[8:11], s20 offen lds
    s_mov_b32 m0, 139264
    s_add_u32 s20, s17, 102400
    s_add_u32 s20, s20, s23
    buffer_load_dwordx4 v2, s[8:11], s20 offen lds
    s_mov_b32 m0, 140288
    s_add_u32 s20, s17, 102400
    s_add_u32 s20, s20, s23
    buffer_load_dwordx4 v3, s[8:11], s20 offen lds
    s_mov_b32 m0, 141312
    s_add_u32 s20, s17, 122880
    s_add_u32 s20, s20, s23
    buffer_load_dwordx4 v2, s[8:11], s20 offen lds
    s_mov_b32 m0, 142336
    s_add_u32 s20, s17, 122880
    s_add_u32 s20, s20, s23
    buffer_load_dwordx4 v3, s[8:11], s20 offen lds
    s_mov_b32 m0, 143360
    s_add_u32 s20, s17, 143360
    s_add_u32 s20, s20, s23
    buffer_load_dwordx4 v2, s[8:11], s20 offen lds
    s_mov_b32 m0, 144384
    s_add_u32 s20, s17, 143360
    s_add_u32 s20, s20, s23
    buffer_load_dwordx4 v3, s[8:11], s20 offen lds
    s_mov_b32 m0, 145408
    s_add_u32 s20, s17, 163840
    s_add_u32 s20, s20, s23
    buffer_load_dwordx4 v2, s[8:11], s20 offen lds
    s_mov_b32 m0, 146432
    s_add_u32 s20, s17, 163840
    s_add_u32 s20, s20, s23
    buffer_load_dwordx4 v3, s[8:11], s20 offen lds
    s_waitcnt vmcnt(18)
    s_barrier
    s_waitcnt vmcnt(18)
    s_barrier
    s_lshl_b32 s23, s22, 7
    s_add_u32 s22, s22, 1
    s_cmp_eq_u32 s22, 10
    s_cselect_b32 s22, 0, s22
    s_mov_b32 m0, 92160
    s_nop 0
    buffer_load_dwordx4 v9, s[8:11], s23 offen lds
    s_mov_b32 m0, 93184
    s_nop 0
    buffer_load_dwordx4 v10, s[8:11], s23 offen lds
    s_mov_b32 m0, 94208
    s_add_u32 s20, s17, 20480
    s_add_u32 s20, s20, s23
    buffer_load_dwordx4 v2, s[8:11], s20 offen lds
    s_mov_b32 m0, 95232
    s_add_u32 s20, s17, 20480
    s_add_u32 s20, s20, s23
    buffer_load_dwordx4 v3, s[8:11], s20 offen lds
    s_mov_b32 m0, 96256
    s_add_u32 s20, s17, 40960
    s_add_u32 s20, s20, s23
    buffer_load_dwordx4 v2, s[8:11], s20 offen lds
    s_mov_b32 m0, 97280
    s_add_u32 s20, s17, 40960
    s_add_u32 s20, s20, s23
    buffer_load_dwordx4 v3, s[8:11], s20 offen lds
    s_mov_b32 m0, 98304
    s_add_u32 s20, s17, 61440
    s_add_u32 s20, s20, s23
    buffer_load_dwordx4 v2, s[8:11], s20 offen lds
    s_mov_b32 m0, 99328
    s_add_u32 s20, s17, 61440
    s_add_u32 s20, s20, s23
    buffer_load_dwordx4 v3, s[8:11], s20 offen lds
    s_mov_b32 m0, 100352
    s_add_u32 s20, s17, 81920
    s_add_u32 s20, s20, s23
    buffer_load_dwordx4 v2, s[8:11], s20 offen lds
    s_waitcnt vmcnt(9)
    s_barrier
    s_mov_b32 m0, 101376
    s_add_u32 s20, s17, 81920
    s_add_u32 s20, s20, s23
    buffer_load_dwordx4 v3, s[8:11], s20 offen lds
    s_mov_b32 m0, 102400
    s_add_u32 s20, s17, 102400
    s_add_u32 s20, s20, s23
    buffer_load_dwordx4 v2, s[8:11], s20 offen lds
    s_mov_b32 m0, 103424
    s_add_u32 s20, s17, 102400
    s_add_u32 s20, s20, s23
    buffer_load_dwordx4 v3, s[8:11], s20 offen lds
    s_mov_b32 m0, 104448
    s_add_u32 s20, s17, 122880
    s_add_u32 s20, s20, s23
    buffer_load_dwordx4 v2, s[8:11], s20 offen lds
    s_mov_b32 m0, 105472
    s_add_u32 s20, s17, 122880
    s_add_u32 s20, s20, s23
    buffer_load_dwordx4 v3, s[8:11], s20 offen lds
    s_mov_b32 m0, 106496
    s_add_u32 s20, s17, 143360
    s_add_u32 s20, s20, s23
    buffer_load_dwordx4 v2, s[8:11], s20 offen lds
    s_mov_b32 m0, 107520
    s_add_u32 s20, s17, 143360
    s_add_u32 s20, s20, s23
    buffer_load_dwordx4 v3, s[8:11], s20 offen lds
    s_mov_b32 m0, 108544
    s_add_u32 s20, s17, 163840
    s_add_u32 s20, s20, s23
    buffer_load_dwordx4 v2, s[8:11], s20 offen lds
    s_mov_b32 m0, 109568
    s_add_u32 s20, s17, 163840
    s_add_u32 s20, s20, s23
    buffer_load_dwordx4 v3, s[8:11], s20 offen lds
    s_waitcnt vmcnt(18)
    s_barrier
    s_lshl_b32 s23, s22, 7
    s_add_u32 s22, s22, 1
    s_cmp_eq_u32 s22, 10
    s_cselect_b32 s22, 0, s22
    s_mov_b32 m0, 110592
    s_nop 0
    buffer_load_dwordx4 v9, s[8:11], s23 offen lds
    s_mov_b32 m0, 111616
    s_nop 0
    buffer_load_dwordx4 v10, s[8:11], s23 offen lds
    s_mov_b32 m0, 112640
    s_add_u32 s20, s17, 20480
    s_add_u32 s20, s20, s23
    buffer_load_dwordx4 v2, s[8:11], s20 offen lds
    s_mov_b32 m0, 113664
    s_add_u32 s20, s17, 20480
    s_add_u32 s20, s20, s23
    buffer_load_dwordx4 v3, s[8:11], s20 offen lds
    s_mov_b32 m0, 114688
    s_add_u32 s20, s17, 40960
    s_add_u32 s20, s20, s23
    buffer_load_dwordx4 v2, s[8:11], s20 offen lds
    s_mov_b32 m0, 115712
    s_add_u32 s20, s17, 40960
    s_add_u32 s20, s20, s23
    buffer_load_dwordx4 v3, s[8:11], s20 offen lds
    s_mov_b32 m0, 116736
    s_add_u32 s20, s17, 61440
    s_add_u32 s20, s20, s23
    buffer_load_dwordx4 v2, s[8:11], s20 offen lds
    s_mov_b32 m0, 117760
    s_add_u32 s20, s17, 61440
    s_add_u32 s20, s20, s23
    buffer_load_dwordx4 v3, s[8:11], s20 offen lds
    s_mov_b32 m0, 118784
    s_add_u32 s20, s17, 81920
    s_add_u32 s20, s20, s23
    buffer_load_dwordx4 v2, s[8:11], s20 offen lds
    s_waitcnt vmcnt(9)
    s_barrier
    s_mov_b32 m0, 119808
    s_add_u32 s20, s17, 81920
    s_add_u32 s20, s20, s23
    buffer_load_dwordx4 v3, s[8:11], s20 offen lds
    s_mov_b32 m0, 120832
    s_add_u32 s20, s17, 102400
    s_add_u32 s20, s20, s23
    buffer_load_dwordx4 v2, s[8:11], s20 offen lds
    s_mov_b32 m0, 121856
    s_add_u32 s20, s17, 102400
    s_add_u32 s20, s20, s23
    buffer_load_dwordx4 v3, s[8:11], s20 offen lds
    s_mov_b32 m0, 122880
    s_add_u32 s20, s17, 122880
    s_add_u32 s20, s20, s23
    buffer_load_dwordx4 v2, s[8:11], s20 offen lds
    s_mov_b32 m0, 123904
    s_add_u32 s20, s17, 122880
    s_add_u32 s20, s20, s23
    buffer_load_dwordx4 v3, s[8:11], s20 offen lds
    s_mov_b32 m0, 124928
    s_add_u32 s20, s17, 143360
    s_add_u32 s20, s20, s23
    buffer_load_dwordx4 v2, s[8:11], s20 offen lds
    s_mov_b32 m0, 125952
    s_add_u32 s20, s17, 143360
    s_add_u32 s20, s20, s23
    buffer_load_dwordx4 v3, s[8:11], s20 offen lds
    s_mov_b32 m0, 126976
    s_add_u32 s20, s17, 163840
    s_add_u32 s20, s20, s23
    buffer_load_dwordx4 v2, s[8:11], s20 offen lds
    s_mov_b32 m0, 128000
    s_add_u32 s20, s17, 163840
    s_add_u32 s20, s20, s23
    buffer_load_dwordx4 v3, s[8:11], s20 offen lds
    s_waitcnt vmcnt(18)
    s_barrier
    s_lshl_b32 s23, s22, 7
    s_add_u32 s22, s22, 1
    s_cmp_eq_u32 s22, 10
    s_cselect_b32 s22, 0, s22
    s_mov_b32 m0, 129024
    s_nop 0
    buffer_load_dwordx4 v9, s[8:11], s23 offen lds
    s_mov_b32 m0, 130048
    s_nop 0
    buffer_load_dwordx4 v10, s[8:11], s23 offen lds
    s_mov_b32 m0, 131072
    s_add_u32 s20, s17, 20480
    s_add_u32 s20, s20, s23
    buffer_load_dwordx4 v2, s[8:11], s20 offen lds
    s_mov_b32 m0, 132096
    s_add_u32 s20, s17, 20480
    s_add_u32 s20, s20, s23
    buffer_load_dwordx4 v3, s[8:11], s20 offen lds
    s_mov_b32 m0, 133120
    s_add_u32 s20, s17, 40960
    s_add_u32 s20, s20, s23
    buffer_load_dwordx4 v2, s[8:11], s20 offen lds
    s_mov_b32 m0, 134144
    s_add_u32 s20, s17, 40960
    s_add_u32 s20, s20, s23
    buffer_load_dwordx4 v3, s[8:11], s20 offen lds
    s_mov_b32 m0, 135168
    s_add_u32 s20, s17, 61440
    s_add_u32 s20, s20, s23
    buffer_load_dwordx4 v2, s[8:11], s20 offen lds
    s_mov_b32 m0, 136192
    s_add_u32 s20, s17, 61440
    s_add_u32 s20, s20, s23
    buffer_load_dwordx4 v3, s[8:11], s20 offen lds
    s_mov_b32 m0, 137216
    s_add_u32 s20, s17, 81920
    s_add_u32 s20, s20, s23
    buffer_load_dwordx4 v2, s[8:11], s20 offen lds
    s_waitcnt vmcnt(9)
    s_barrier
    s_mov_b32 m0, 138240
    s_add_u32 s20, s17, 81920
    s_add_u32 s20, s20, s23
    buffer_load_dwordx4 v3, s[8:11], s20 offen lds
    s_mov_b32 m0, 139264
    s_add_u32 s20, s17, 102400
    s_add_u32 s20, s20, s23
    buffer_load_dwordx4 v2, s[8:11], s20 offen lds
    s_mov_b32 m0, 140288
    s_add_u32 s20, s17, 102400
    s_add_u32 s20, s20, s23
    buffer_load_dwordx4 v3, s[8:11], s20 offen lds
    s_mov_b32 m0, 141312
    s_add_u32 s20, s17, 122880
    s_add_u32 s20, s20, s23
    buffer_load_dwordx4 v2, s[8:11], s20 offen lds
    s_mov_b32 m0, 142336
    s_add_u32 s20, s17, 122880
    s_add_u32 s20, s20, s23
    buffer_load_dwordx4 v3, s[8:11], s20 offen lds
    s_mov_b32 m0, 143360
    s_add_u32 s20, s17, 143360
    s_add_u32 s20, s20, s23
    buffer_load_dwordx4 v2, s[8:11], s20 offen lds
    s_mov_b32 m0, 144384
    s_add_u32 s20, s17, 143360
    s_add_u32 s20, s20, s23
    buffer_load_dwordx4 v3, s[8:11], s20 offen lds
    s_mov_b32 m0, 145408
    s_add_u32 s20, s17, 163840
    s_add_u32 s20, s20, s23
    buffer_load_dwordx4 v2, s[8:11], s20 offen lds
    s_mov_b32 m0, 146432
    s_add_u32 s20, s17, 163840
    s_add_u32 s20, s20, s23
    buffer_load_dwordx4 v3, s[8:11], s20 offen lds
    s_waitcnt vmcnt(18)
    s_barrier
    s_lshl_b32 s23, s22, 7
    s_add_u32 s22, s22, 1
    s_cmp_eq_u32 s22, 10
    s_cselect_b32 s22, 0, s22
    s_mov_b32 m0, 92160
    s_nop 0
    buffer_load_dwordx4 v9, s[8:11], s23 offen lds
    s_mov_b32 m0, 93184
    s_nop 0
    buffer_load_dwordx4 v10, s[8:11], s23 offen lds
    s_mov_b32 m0, 94208
    s_add_u32 s20, s17, 20480
    s_add_u32 s20, s20, s23
    buffer_load_dwordx4 v2, s[8:11], s20 offen lds
    s_mov_b32 m0, 95232
    s_add_u32 s20, s17, 20480
    s_add_u32 s20, s20, s23
    buffer_load_dwordx4 v3, s[8:11], s20 offen lds
    s_mov_b32 m0, 96256
    s_add_u32 s20, s17, 40960
    s_add_u32 s20, s20, s23
    buffer_load_dwordx4 v2, s[8:11], s20 offen lds
    s_mov_b32 m0, 97280
    s_add_u32 s20, s17, 40960
    s_add_u32 s20, s20, s23
    buffer_load_dwordx4 v3, s[8:11], s20 offen lds
    s_mov_b32 m0, 98304
    s_add_u32 s20, s17, 61440
    s_add_u32 s20, s20, s23
    buffer_load_dwordx4 v2, s[8:11], s20 offen lds
    s_mov_b32 m0, 99328
    s_add_u32 s20, s17, 61440
    s_add_u32 s20, s20, s23
    buffer_load_dwordx4 v3, s[8:11], s20 offen lds
    s_mov_b32 m0, 100352
    s_add_u32 s20, s17, 81920
    s_add_u32 s20, s20, s23
    buffer_load_dwordx4 v2, s[8:11], s20 offen lds
    s_waitcnt vmcnt(9)
    s_barrier
    s_mov_b32 m0, 101376
    s_add_u32 s20, s17, 81920
    s_add_u32 s20, s20, s23
    buffer_load_dwordx4 v3, s[8:11], s20 offen lds
    s_mov_b32 m0, 102400
    s_add_u32 s20, s17, 102400
    s_add_u32 s20, s20, s23
    buffer_load_dwordx4 v2, s[8:11], s20 offen lds
    s_mov_b32 m0, 103424
    s_add_u32 s20, s17, 102400
    s_add_u32 s20, s20, s23
    buffer_load_dwordx4 v3, s[8:11], s20 offen lds
    s_mov_b32 m0, 104448
    s_add_u32 s20, s17, 122880
    s_add_u32 s20, s20, s23
    buffer_load_dwordx4 v2, s[8:11], s20 offen lds
    s_mov_b32 m0, 105472
    s_add_u32 s20, s17, 122880
    s_add_u32 s20, s20, s23
    buffer_load_dwordx4 v3, s[8:11], s20 offen lds
    s_mov_b32 m0, 106496
    s_add_u32 s20, s17, 143360
    s_add_u32 s20, s20, s23
    buffer_load_dwordx4 v2, s[8:11], s20 offen lds
    s_mov_b32 m0, 107520
    s_add_u32 s20, s17, 143360
    s_add_u32 s20, s20, s23
    buffer_load_dwordx4 v3, s[8:11], s20 offen lds
    s_mov_b32 m0, 108544
    s_add_u32 s20, s17, 163840
    s_add_u32 s20, s20, s23
    buffer_load_dwordx4 v2, s[8:11], s20 offen lds
    s_mov_b32 m0, 109568
    s_add_u32 s20, s17, 163840
    s_add_u32 s20, s20, s23
    buffer_load_dwordx4 v3, s[8:11], s20 offen lds
    s_waitcnt vmcnt(18)
    s_barrier
    s_lshl_b32 s23, s22, 7
    s_add_u32 s22, s22, 1
    s_cmp_eq_u32 s22, 10
    s_cselect_b32 s22, 0, s22
    s_mov_b32 m0, 110592
    s_nop 0
    buffer_load_dwordx4 v9, s[8:11], s23 offen lds
    s_mov_b32 m0, 111616
    s_nop 0
    buffer_load_dwordx4 v10, s[8:11], s23 offen lds
    s_mov_b32 m0, 112640
    s_add_u32 s20, s17, 20480
    s_add_u32 s20, s20, s23
    buffer_load_dwordx4 v2, s[8:11], s20 offen lds
    s_mov_b32 m0, 113664
    s_add_u32 s20, s17, 20480
    s_add_u32 s20, s20, s23
    buffer_load_dwordx4 v3, s[8:11], s20 offen lds
    s_mov_b32 m0, 114688
    s_add_u32 s20, s17, 40960
    s_add_u32 s20, s20, s23
    buffer_load_dwordx4 v2, s[8:11], s20 offen lds
    s_mov_b32 m0, 115712
    s_add_u32 s20, s17, 40960
    s_add_u32 s20, s20, s23
    buffer_load_dwordx4 v3, s[8:11], s20 offen lds
    s_mov_b32 m0, 116736
    s_add_u32 s20, s17, 61440
    s_add_u32 s20, s20, s23
    buffer_load_dwordx4 v2, s[8:11], s20 offen lds
    s_mov_b32 m0, 117760
    s_add_u32 s20, s17, 61440
    s_add_u32 s20, s20, s23
    buffer_load_dwordx4 v3, s[8:11], s20 offen lds
    s_mov_b32 m0, 118784
    s_add_u32 s20, s17, 81920
    s_add_u32 s20, s20, s23
    buffer_load_dwordx4 v2, s[8:11], s20 offen lds
    s_waitcnt vmcnt(9)
    s_barrier
    s_mov_b32 m0, 119808
    s_add_u32 s20, s17, 81920
    s_add_u32 s20, s20, s23
    buffer_load_dwordx4 v3, s[8:11], s20 offen lds
    s_mov_b32 m0, 120832
    s_add_u32 s20, s17, 102400
    s_add_u32 s20, s20, s23
    buffer_load_dwordx4 v2, s[8:11], s20 offen lds
    s_mov_b32 m0, 121856
    s_add_u32 s20, s17, 102400
    s_add_u32 s20, s20, s23
    buffer_load_dwordx4 v3, s[8:11], s20 offen lds
    s_mov_b32 m0, 122880
    s_add_u32 s20, s17, 122880
    s_add_u32 s20, s20, s23
    buffer_load_dwordx4 v2, s[8:11], s20 offen lds
    s_mov_b32 m0, 123904
    s_add_u32 s20, s17, 122880
    s_add_u32 s20, s20, s23
    buffer_load_dwordx4 v3, s[8:11], s20 offen lds
    s_mov_b32 m0, 124928
    s_add_u32 s20, s17, 143360
    s_add_u32 s20, s20, s23
    buffer_load_dwordx4 v2, s[8:11], s20 offen lds
    s_mov_b32 m0, 125952
    s_add_u32 s20, s17, 143360
    s_add_u32 s20, s20, s23
    buffer_load_dwordx4 v3, s[8:11], s20 offen lds
    s_mov_b32 m0, 126976
    s_add_u32 s20, s17, 163840
    s_add_u32 s20, s20, s23
    buffer_load_dwordx4 v2, s[8:11], s20 offen lds
    s_mov_b32 m0, 128000
    s_add_u32 s20, s17, 163840
    s_add_u32 s20, s20, s23
    buffer_load_dwordx4 v3, s[8:11], s20 offen lds
    s_waitcnt vmcnt(18)
    s_barrier
    s_lshl_b32 s23, s22, 7
    s_add_u32 s22, s22, 1
    s_cmp_eq_u32 s22, 10
    s_cselect_b32 s22, 0, s22
    s_mov_b32 m0, 129024
    s_nop 0
    buffer_load_dwordx4 v9, s[8:11], s23 offen lds
    s_mov_b32 m0, 130048
    s_nop 0
    buffer_load_dwordx4 v10, s[8:11], s23 offen lds
    s_mov_b32 m0, 131072
    s_add_u32 s20, s17, 20480
    s_add_u32 s20, s20, s23
    buffer_load_dwordx4 v2, s[8:11], s20 offen lds
    s_mov_b32 m0, 132096
    s_add_u32 s20, s17, 20480
    s_add_u32 s20, s20, s23
    buffer_load_dwordx4 v3, s[8:11], s20 offen lds
    s_mov_b32 m0, 133120
    s_add_u32 s20, s17, 40960
    s_add_u32 s20, s20, s23
    buffer_load_dwordx4 v2, s[8:11], s20 offen lds
    s_mov_b32 m0, 134144
    s_add_u32 s20, s17, 40960
    s_add_u32 s20, s20, s23
    buffer_load_dwordx4 v3, s[8:11], s20 offen lds
    s_mov_b32 m0, 135168
    s_add_u32 s20, s17, 61440
    s_add_u32 s20, s20, s23
    buffer_load_dwordx4 v2, s[8:11], s20 offen lds
    s_mov_b32 m0, 136192
    s_add_u32 s20, s17, 61440
    s_add_u32 s20, s20, s23
    buffer_load_dwordx4 v3, s[8:11], s20 offen lds
    s_mov_b32 m0, 137216
    s_add_u32 s20, s17, 81920
    s_add_u32 s20, s20, s23
    buffer_load_dwordx4 v2, s[8:11], s20 offen lds
    s_waitcnt vmcnt(9)
    s_barrier
    s_mov_b32 m0, 138240
    s_add_u32 s20, s17, 81920
    s_add_u32 s20, s20, s23
    buffer_load_dwordx4 v3, s[8:11], s20 offen lds
    s_mov_b32 m0, 139264
    s_add_u32 s20, s17, 102400
    s_add_u32 s20, s20, s23
    buffer_load_dwordx4 v2, s[8:11], s20 offen lds
    s_mov_b32 m0, 140288
    s_add_u32 s20, s17, 102400
    s_add_u32 s20, s20, s23
    buffer_load_dwordx4 v3, s[8:11], s20 offen lds
    s_mov_b32 m0, 141312
    s_add_u32 s20, s17, 122880
    s_add_u32 s20, s20, s23
    buffer_load_dwordx4 v2, s[8:11], s20 offen lds
    s_mov_b32 m0, 142336
    s_add_u32 s20, s17, 122880
    s_add_u32 s20, s20, s23
    buffer_load_dwordx4 v3, s[8:11], s20 offen lds
    s_mov_b32 m0, 143360
    s_add_u32 s20, s17, 143360
    s_add_u32 s20, s20, s23
    buffer_load_dwordx4 v2, s[8:11], s20 offen lds
    s_mov_b32 m0, 144384
    s_add_u32 s20, s17, 143360
    s_add_u32 s20, s20, s23
    buffer_load_dwordx4 v3, s[8:11], s20 offen lds
    s_mov_b32 m0, 145408
    s_add_u32 s20, s17, 163840
    s_add_u32 s20, s20, s23
    buffer_load_dwordx4 v2, s[8:11], s20 offen lds
    s_mov_b32 m0, 146432
    s_add_u32 s20, s17, 163840
    s_add_u32 s20, s20, s23
    buffer_load_dwordx4 v3, s[8:11], s20 offen lds
    s_waitcnt vmcnt(18)
    s_barrier
    s_lshl_b32 s23, s22, 7
    s_add_u32 s22, s22, 1
    s_cmp_eq_u32 s22, 10
    s_cselect_b32 s22, 0, s22
    s_mov_b32 m0, 92160
    s_nop 0
    buffer_load_dwordx4 v9, s[8:11], s23 offen lds
    s_mov_b32 m0, 93184
    s_nop 0
    buffer_load_dwordx4 v10, s[8:11], s23 offen lds
    s_mov_b32 m0, 94208
    s_add_u32 s20, s17, 20480
    s_add_u32 s20, s20, s23
    buffer_load_dwordx4 v2, s[8:11], s20 offen lds
    s_mov_b32 m0, 95232
    s_add_u32 s20, s17, 20480
    s_add_u32 s20, s20, s23
    buffer_load_dwordx4 v3, s[8:11], s20 offen lds
    s_mov_b32 m0, 96256
    s_add_u32 s20, s17, 40960
    s_add_u32 s20, s20, s23
    buffer_load_dwordx4 v2, s[8:11], s20 offen lds
    s_mov_b32 m0, 97280
    s_add_u32 s20, s17, 40960
    s_add_u32 s20, s20, s23
    buffer_load_dwordx4 v3, s[8:11], s20 offen lds
    s_mov_b32 m0, 98304
    s_add_u32 s20, s17, 61440
    s_add_u32 s20, s20, s23
    buffer_load_dwordx4 v2, s[8:11], s20 offen lds
    s_mov_b32 m0, 99328
    s_add_u32 s20, s17, 61440
    s_add_u32 s20, s20, s23
    buffer_load_dwordx4 v3, s[8:11], s20 offen lds
    s_mov_b32 m0, 100352
    s_add_u32 s20, s17, 81920
    s_add_u32 s20, s20, s23
    buffer_load_dwordx4 v2, s[8:11], s20 offen lds
    s_waitcnt vmcnt(9)
    s_barrier
    s_mov_b32 m0, 101376
    s_add_u32 s20, s17, 81920
    s_add_u32 s20, s20, s23
    buffer_load_dwordx4 v3, s[8:11], s20 offen lds
    s_mov_b32 m0, 102400
    s_add_u32 s20, s17, 102400
    s_add_u32 s20, s20, s23
    buffer_load_dwordx4 v2, s[8:11], s20 offen lds
    s_mov_b32 m0, 103424
    s_add_u32 s20, s17, 102400
    s_add_u32 s20, s20, s23
    buffer_load_dwordx4 v3, s[8:11], s20 offen lds
    s_mov_b32 m0, 104448
    s_add_u32 s20, s17, 122880
    s_add_u32 s20, s20, s23
    buffer_load_dwordx4 v2, s[8:11], s20 offen lds
    s_mov_b32 m0, 105472
    s_add_u32 s20, s17, 122880
    s_add_u32 s20, s20, s23
    buffer_load_dwordx4 v3, s[8:11], s20 offen lds
    s_mov_b32 m0, 106496
    s_add_u32 s20, s17, 143360
    s_add_u32 s20, s20, s23
    buffer_load_dwordx4 v2, s[8:11], s20 offen lds
    s_mov_b32 m0, 107520
    s_add_u32 s20, s17, 143360
    s_add_u32 s20, s20, s23
    buffer_load_dwordx4 v3, s[8:11], s20 offen lds
    s_mov_b32 m0, 108544
    s_add_u32 s20, s17, 163840
    s_add_u32 s20, s20, s23
    buffer_load_dwordx4 v2, s[8:11], s20 offen lds
    s_mov_b32 m0, 109568
    s_add_u32 s20, s17, 163840
    s_add_u32 s20, s20, s23
    buffer_load_dwordx4 v3, s[8:11], s20 offen lds
    s_waitcnt vmcnt(18)
    s_barrier
    s_waitcnt vmcnt(0)
    s_barrier
    s_waitcnt vmcnt(0)
    s_barrier
    s_mov_b32 s28, s56
    s_mov_b32 s29, s57
    s_mov_b32 s30, 256
    s_mov_b32 s31, 0x00020000
    v_mov_b32 v14, 0
    buffer_load_dword v15, v14, s[28:31], 0 offen sc1
    s_waitcnt vmcnt(0)
    v_readfirstlane_b32 s62, v15
    s_nop 1
    s_cmp_lg_u32 s62, 0
    s_cbranch_scc1 Lnok_185
    s_mov_b32 s28, s56
    s_mov_b32 s29, s57
    s_mov_b32 s30, 256
    s_mov_b32 s31, 0x00020000
    v_mov_b32 v14, 0
    s_mov_b32 s32, 0
Lnonce_186:
    buffer_load_dword v15, v14, s[28:31], 0 offen sc1
    s_waitcnt vmcnt(0)
    v_readfirstlane_b32 s62, v15
    s_add_u32 s32, s32, 1
    s_cmp_gt_u32 s32, 65536
    s_cbranch_scc1 Lnonce_o_187
    s_cmp_eq_u32 s62, 0
    s_cbranch_scc1 Lnonce_186
Lnonce_o_187:
Lnok_185:
Lq_ldj_159:
    s_barrier
    s_sub_u32 s16, s3, 4
    s_lshl_b32 s17, s60, 18
    s_mov_b32 s8, s46
    s_mov_b32 s9, s47
    s_add_u32 s8, s8, s17
    s_addc_u32 s9, s9, 0
    s_mov_b32 s10, 262144
    s_mov_b32 s11, 0x00020000
    v_lshrrev_b32 v4, 5, v0
    s_lshl_b32 s17, s16, 2
    v_add_u32 v4, s17, v4
    v_and_b32 v5, 31, v0
    v_xor_b32 v6, v5, v4
    v_lshlrev_b32 v6, 4, v6
    v_lshl_add_u32 v2, v4, 12, v6
    v_add_u32 v4, 2, v4
    v_xor_b32 v6, v5, v4
    v_lshlrev_b32 v6, 4, v6
    v_lshl_add_u32 v3, v4, 12, v6
    s_lshl_b32 s18, s16, 11
    s_add_u32 s19, s100, 0
    s_and_b32 s19, s19, 3
    s_lshl_b32 s19, s19, 9
    s_add_u32 m0, s18, 98304
    s_add_u32 s20, s19, 0
    buffer_load_dwordx4 v2, s[8:11], s20 offen  lds
    s_add_u32 m0, s18, 99328
    s_add_u32 s20, s19, 0
    buffer_load_dwordx4 v3, s[8:11], s20 offen  lds
    s_add_u32 m0, s18, 106496
    s_add_u32 s20, s19, 65536
    buffer_load_dwordx4 v2, s[8:11], s20 offen  lds
    s_add_u32 m0, s18, 107520
    s_add_u32 s20, s19, 65536
    buffer_load_dwordx4 v3, s[8:11], s20 offen  lds
    s_add_u32 m0, s18, 114688
    s_add_u32 s20, s19, 131072
    buffer_load_dwordx4 v2, s[8:11], s20 offen  lds
    s_add_u32 m0, s18, 115712
    s_add_u32 s20, s19, 131072
    buffer_load_dwordx4 v3, s[8:11], s20 offen  lds
    s_add_u32 m0, s18, 122880
    s_add_u32 s20, s19, 196608
    buffer_load_dwordx4 v2, s[8:11], s20 offen  lds
    s_add_u32 m0, s18, 123904
    s_add_u32 s20, s19, 196608
    buffer_load_dwordx4 v3, s[8:11], s20 offen  lds
    s_add_u32 s19, s100, 0
    s_and_b32 s19, s19, 3
    s_lshl_b32 s19, s19, 9
    s_add_u32 s19, s19, 2048
    s_add_u32 m0, s18, 131072
    s_add_u32 s20, s19, 0
    buffer_load_dwordx4 v2, s[8:11], s20 offen  lds
    s_add_u32 m0, s18, 132096
    s_add_u32 s20, s19, 0
    buffer_load_dwordx4 v3, s[8:11], s20 offen  lds
    s_add_u32 m0, s18, 139264
    s_add_u32 s20, s19, 65536
    buffer_load_dwordx4 v2, s[8:11], s20 offen  lds
    s_add_u32 m0, s18, 140288
    s_add_u32 s20, s19, 65536
    buffer_load_dwordx4 v3, s[8:11], s20 offen  lds
    s_add_u32 m0, s18, 147456
    s_add_u32 s20, s19, 131072
    buffer_load_dwordx4 v2, s[8:11], s20 offen  lds
    s_add_u32 m0, s18, 148480
    s_add_u32 s20, s19, 131072
    buffer_load_dwordx4 v3, s[8:11], s20 offen  lds
    s_add_u32 m0, s18, 155648
    s_add_u32 s20, s19, 196608
    buffer_load_dwordx4 v2, s[8:11], s20 offen  lds
    s_add_u32 m0, s18, 156672
    s_add_u32 s20, s19, 196608
    buffer_load_dwordx4 v3, s[8:11], s20 offen  lds
Lq_att_158:
    v_and_b32 v10, 3, v0
    v_lshrrev_b32 v11, 2, v0
    v_and_b32 v12, 3, v11
    v_lshrrev_b32 v13, 4, v0
    v_and_b32 v14, 1, v13
    v_lshrrev_b32 v15, 1, v13
    s_lshl_b32 s16, s3, 4
    v_lshlrev_b32 v16, 3, v15
    v_add_u32 v16, v16, v14
    v_lshl_add_u32 v17, v10, 1, v16
    v_add_u32 v17, s16, v17
    s_movk_i32 s19, 488
    v_mul_u32_u24 v17, s19, v17
    v_mul_u32_u24 v18, 40, v12
    v_add_u32 v20, v17, v18
    v_lshl_add_u32 v17, v12, 1, v16
    v_add_u32 v17, s16, v17
    v_mul_u32_u24 v17, s19, v17
    v_mul_u32_u24 v18, 40, v10
    v_add3_u32 v21, v17, v18, 0
    ds_read_b64 v[24:25], v20 offset:7808
    ds_read_b64 v[26:27], v20 offset:7816
    ds_read_b64 v[28:29], v20 offset:7824
    ds_read_b64 v[30:31], v20 offset:7832
    ds_read_b64 v[32:33], v20 offset:7840
    ds_read_b64 v[34:35], v20 offset:160
    ds_read_b64 v[36:37], v20 offset:168
    ds_read_b64 v[38:39], v20 offset:176
    ds_read_b64 v[40:41], v20 offset:184
    ds_read_b64 v[42:43], v20 offset:192
    ds_read_b64 v[44:45], v20 offset:4064
    ds_read_b64 v[46:47], v20 offset:4072
    ds_read_b64 v[48:49], v20 offset:4080
    ds_read_b64 v[50:51], v20 offset:4088
    ds_read_b64 v[52:53], v20 offset:4096
    ds_read_b64 v[54:55], v20 offset:7968
    ds_read_b64 v[56:57], v20 offset:7976
    ds_read_b64 v[58:59], v20 offset:7984
    ds_read_b64 v[60:61], v20 offset:7992
    ds_read_b64 v[62:63], v20 offset:8000
    s_waitcnt lgkmcnt(0)
    v_mfma_f32_4x4x4_16b_bf16 v[64:67], v[34:35], v[24:25], 0
    v_mfma_f32_4x4x4_16b_bf16 v[68:71], v[44:45], v[24:25], 0
    v_mfma_f32_4x4x4_16b_bf16 v[72:75], v[54:55], v[24:25], 0
    v_mfma_f32_4x4x4_16b_bf16 v[64:67], v[36:37], v[26:27], v[64:67]
    v_mfma_f32_4x4x4_16b_bf16 v[68:71], v[46:47], v[26:27], v[68:71]
    v_mfma_f32_4x4x4_16b_bf16 v[72:75], v[56:57], v[26:27], v[72:75]
    v_mfma_f32_4x4x4_16b_bf16 v[64:67], v[38:39], v[28:29], v[64:67]
    v_mfma_f32_4x4x4_16b_bf16 v[68:71], v[48:49], v[28:29], v[68:71]
    v_mfma_f32_4x4x4_16b_bf16 v[72:75], v[58:59], v[28:29], v[72:75]
    v_mfma_f32_4x4x4_16b_bf16 v[64:67], v[40:41], v[30:31], v[64:67]
    v_mfma_f32_4x4x4_16b_bf16 v[68:71], v[50:51], v[30:31], v[68:71]
    v_mfma_f32_4x4x4_16b_bf16 v[72:75], v[60:61], v[30:31], v[72:75]
    v_mfma_f32_4x4x4_16b_bf16 v[64:67], v[42:43], v[32:33], v[64:67]
    v_mfma_f32_4x4x4_16b_bf16 v[68:71], v[52:53], v[32:33], v[68:71]
    v_mfma_f32_4x4x4_16b_bf16 v[72:75], v[62:63], v[32:33], v[72:75]
    ds_read_b64_tr_b16 v[34:35], v21 offset:320
    ds_read_b64_tr_b16 v[36:37], v21 offset:328
    ds_read_b64_tr_b16 v[38:39], v21 offset:336
    ds_read_b64_tr_b16 v[40:41], v21 offset:344
    ds_read_b64_tr_b16 v[42:43], v21 offset:352
    ds_read_b64_tr_b16 v[44:45], v21 offset:4224
    ds_read_b64_tr_b16 v[46:47], v21 offset:4232
    ds_read_b64_tr_b16 v[48:49], v21 offset:4240
    ds_read_b64_tr_b16 v[50:51], v21 offset:4248
    ds_read_b64_tr_b16 v[52:53], v21 offset:4256
    ds_read_b64_tr_b16 v[54:55], v21 offset:8128
    ds_read_b64_tr_b16 v[56:57], v21 offset:8136
    ds_read_b64_tr_b16 v[58:59], v21 offset:8144
    ds_read_b64_tr_b16 v[60:61], v21 offset:8152
    ds_read_b64_tr_b16 v[62:63], v21 offset:8160
    v_cmp_eq_u32 s[20:21], 0, v10
    v_cmp_ge_u32 s[22:23], 1, v10
    v_cmp_ge_u32 s[24:25], 2, v10
    v_cndmask_b32 v88, v73, v65, s[20:21]
    v_cndmask_b32 v89, v74, v66, s[22:23]
    v_cndmask_b32 v90, v75, v67, s[24:25]
    s_cmp_lg_u32 s4, 0
    s_cbranch_scc1 Lnm_188
    s_cmp_gt_u32 s3, 0
    s_cbranch_scc1 Lnm_188
    v_lshlrev_b32 v22, 2, v15
    v_sub_u32 v22, 8, v22
    v_mov_b32 v23, 0xff800000
    v_cmp_gt_u32 vcc, v22, 4
    s_nop 1
    v_cndmask_b32 v68, v68, v23, vcc
    v_cmp_gt_u32 vcc, v22, 5
    s_nop 1
    v_cndmask_b32 v69, v69, v23, vcc
    v_cmp_gt_u32 vcc, v22, 6
    s_nop 1
    v_cndmask_b32 v70, v70, v23, vcc
    v_cmp_gt_u32 vcc, v22, 7
    s_nop 1
    v_cndmask_b32 v71, v71, v23, vcc
    v_cmp_gt_u32 vcc, v22, 8
    s_nop 1
    v_cndmask_b32 v72, v72, v23, vcc
    v_cndmask_b32 v9, 9, 1, s[20:21]
    v_cmp_gt_u32 vcc, v22, v9
    s_nop 1
    v_cndmask_b32 v88, v88, v23, vcc
    v_cndmask_b32 v9, 10, 2, s[22:23]
    v_cmp_gt_u32 vcc, v22, v9
    s_nop 1
    v_cndmask_b32 v89, v89, v23, vcc
    v_cndmask_b32 v9, 11, 3, s[24:25]
    v_cmp_gt_u32 vcc, v22, v9
    s_nop 1
    v_cndmask_b32 v90, v90, v23, vcc
Lnm_188:
    v_max3_f32 v8, v68, v69, v70
    v_max3_f32 v8, v8, v71, v72
    v_max3_f32 v8, v8, v88, v89
    v_max_f32 v8, v8, v90
    s_mov_b32 s26, 0x3ea52b5c
    v_mul_f32 v8, s26, v8
    v_fma_f32 v68, v68, s26, -v8
    v_fma_f32 v69, v69, s26, -v8
    v_fma_f32 v70, v70, s26, -v8
    v_fma_f32 v71, v71, s26, -v8
    v_fma_f32 v72, v72, s26, -v8
    v_fma_f32 v88, v88, s26, -v8
    v_fma_f32 v89, v89, s26, -v8
    v_fma_f32 v90, v90, s26, -v8
    v_exp_f32 v68, v68
    v_exp_f32 v69, v69
    v_exp_f32 v70, v70
    v_exp_f32 v71, v71
    v_exp_f32 v72, v72
    v_exp_f32 v88, v88
    v_exp_f32 v89, v89
    v_exp_f32 v90, v90
    v_add_f32 v8, v68, v69
    v_add_f32 v9, v70, v71
    v_add_f32 v8, v8, v72
    v_add_f32 v9, v9, v88
    v_add_f32 v8, v8, v89
    v_add_f32 v9, v9, v90
    v_add_f32 v8, v8, v9
    v_rcp_f32 v8, v8
    s_nop 0
    v_mul_f32 v68, v68, v8
    v_mul_f32 v69, v69, v8
    v_mul_f32 v70, v70, v8
    v_mul_f32 v71, v71, v8
    v_mul_f32 v72, v72, v8
    v_mul_f32 v88, v88, v8
    v_mul_f32 v89, v89, v8
    v_mul_f32 v90, v90, v8
    v_mov_b32 v76, 0
    v_cndmask_b32 v77, 0, v88, s[20:21]
    v_cndmask_b32 v85, v88, 0, s[20:21]
    v_cndmask_b32 v78, 0, v89, s[22:23]
    v_cndmask_b32 v86, v89, 0, s[22:23]
    v_cndmask_b32 v79, 0, v90, s[24:25]
    v_cndmask_b32 v87, v90, 0, s[24:25]
    v_cvt_pk_bf16_f32 v24, v76, v77
    v_cvt_pk_bf16_f32 v25, v78, v79
    v_cvt_pk_bf16_f32 v26, v68, v69
    v_cvt_pk_bf16_f32 v27, v70, v71
    v_cvt_pk_bf16_f32 v28, v72, v85
    v_cvt_pk_bf16_f32 v29, v86, v87
    s_waitcnt lgkmcnt(0)
    v_mfma_f32_4x4x4_16b_bf16 v[64:67], v[34:35], v[24:25], 0
    v_mfma_f32_4x4x4_16b_bf16 v[68:71], v[36:37], v[24:25], 0
    v_mfma_f32_4x4x4_16b_bf16 v[72:75], v[38:39], v[24:25], 0
    v_mfma_f32_4x4x4_16b_bf16 v[76:79], v[40:41], v[24:25], 0
    v_mfma_f32_4x4x4_16b_bf16 v[80:83], v[42:43], v[24:25], 0
    v_mfma_f32_4x4x4_16b_bf16 v[64:67], v[44:45], v[26:27], v[64:67]
    v_mfma_f32_4x4x4_16b_bf16 v[68:71], v[46:47], v[26:27], v[68:71]
    v_mfma_f32_4x4x4_16b_bf16 v[72:75], v[48:49], v[26:27], v[72:75]
    v_mfma_f32_4x4x4_16b_bf16 v[76:79], v[50:51], v[26:27], v[76:79]
    v_mfma_f32_4x4x4_16b_bf16 v[80:83], v[52:53], v[26:27], v[80:83]
    v_mfma_f32_4x4x4_16b_bf16 v[64:67], v[54:55], v[28:29], v[64:67]
    v_mfma_f32_4x4x4_16b_bf16 v[68:71], v[56:57], v[28:29], v[68:71]
    v_mfma_f32_4x4x4_16b_bf16 v[72:75], v[58:59], v[28:29], v[72:75]
    v_mfma_f32_4x4x4_16b_bf16 v[76:79], v[60:61], v[28:29], v[76:79]
    v_mfma_f32_4x4x4_16b_bf16 v[80:83], v[62:63], v[28:29], v[80:83]
    v_lshl_add_u32 v17, v10, 1, v16
    v_mul_u32_u24 v17, 176, v17
    v_mul_u32_u24 v18, 40, v12
    s_mul_i32 s18, s3, 2816
    s_add_u32 s18, s18, 73728
    v_add3_u32 v17, v17, v18, s18
    v_cvt_pk_bf16_f32 v30, v64, v65
    v_cvt_pk_bf16_f32 v31, v66, v67
    ds_write_b64 v17, v[30:31] offset:0
    v_cvt_pk_bf16_f32 v30, v68, v69
    v_cvt_pk_bf16_f32 v31, v70, v71
    ds_write_b64 v17, v[30:31] offset:8
    v_cvt_pk_bf16_f32 v30, v72, v73
    v_cvt_pk_bf16_f32 v31, v74, v75
    ds_write_b64 v17, v[30:31] offset:16
    v_cvt_pk_bf16_f32 v30, v76, v77
    v_cvt_pk_bf16_f32 v31, v78, v79
    ds_write_b64 v17, v[30:31] offset:24
    v_cvt_pk_bf16_f32 v30, v80, v81
    v_cvt_pk_bf16_f32 v31, v82, v83
    ds_write_b64 v17, v[30:31] offset:32
    v_and_b32 v1, 15, v0
    v_lshrrev_b32 v2, 4, v0
    v_mul_u32_u24 v17, 176, v1
    v_add_u32 v17, s18, v17
    s_and_b32 s20, s5, 1
    s_lshl_b32 s21, s20, 1
    v_subrev_u32 v18, s21, v2
    s_lshl_b32 s22, s4, 3
    s_add_u32 s22, s22, s3
    s_mul_i32 s22, s22, 45056
    s_mul_i32 s23, s5, 10
    s_lshr_b32 s23, s23, 2
    s_lshl_b32 s23, s23, 10
    s_add_u32 s22, s22, s23
    s_mov_b32 s8, s58
    s_mov_b32 s9, s59
    s_mov_b32 s10, 5767168
    s_mov_b32 s11, 0x00020000
    v_lshlrev_b32 v19, 4, v0
    s_waitcnt lgkmcnt(0)
    s_mov_b64 s[12:13], exec
    v_add_u32 v22, 0, v18
    v_cmp_gt_u32 vcc, 10, v22
    v_lshl_add_u32 v23, v22, 4, v17
    s_nop 0
    s_and_b64 exec, s[12:13], vcc
    ds_read_b128 v[64:67], v23
    s_waitcnt lgkmcnt(0)
    buffer_store_dwordx4 v[64:67], v19, s[8:11], s22 offen offset:0 sc1
    s_mov_b64 exec, s[12:13]
    v_add_u32 v22, 4, v18
    v_cmp_gt_u32 vcc, 10, v22
    v_lshl_add_u32 v23, v22, 4, v17
    s_nop 0
    s_and_b64 exec, s[12:13], vcc
    ds_read_b128 v[68:71], v23
    s_waitcnt lgkmcnt(0)
    buffer_store_dwordx4 v[68:71], v19, s[8:11], s22 offen offset:1024 sc1
    s_mov_b64 exec, s[12:13]
    v_add_u32 v22, 8, v18
    v_cmp_gt_u32 vcc, 10, v22
    v_lshl_add_u32 v23, v22, 4, v17
    s_nop 0
    s_and_b64 exec, s[12:13], vcc
    ds_read_b128 v[72:75], v23
    s_waitcnt lgkmcnt(0)
    buffer_store_dwordx4 v[72:75], v19, s[8:11], s22 offen offset:2048 sc1
    s_mov_b64 exec, s[12:13]
    s_barrier
    s_lshl_b32 s16, s4, 7
    s_lshl_b32 s17, s5, 2
    s_add_u32 s16, s16, s17
    s_add_u32 s63, s16, 4096
    s_branch LP2_150
Lz_role_151:
    s_cmp_ge_u32 s3, 4
    s_cbranch_scc1 Lz_ld_189
    v_and_b32 v1, 15, v0
    v_lshrrev_b32 v2, 4, v0
    s_lshr_b32 s16, s3, 1
    s_and_b32 s17, s3, 1
    v_lshrrev_b32 v3, 1, v1
    v_xor_b32 v3, v3, v2
    v_lshlrev_b32 v3, 4, v3
    v_lshl_add_u32 v170, v1, 7, v3
    s_lshl_b32 s18, s16, 13
    v_add_u32 v170, s18, v170
    v_xor_b32 v171, 64, v170
    v_lshrrev_b32 v3, 2, v1
    v_lshl_add_u32 v3, v2, 3, v3
    v_mul_u32_u24 v3, 192, v3
    v_and_b32 v4, 3, v1
    v_lshl_add_u32 v3, v4, 3, v3
    s_mul_i32 s18, s17, 96
    s_add_u32 s18, s18, 16384
    v_add_u32 v3, s18, v3
    v_and_b32 v4, 1, v2
    v_lshlrev_b32 v4, 5, v4
    v_add_u32 v5, v3, v4
    v_sub_u32 v3, v3, v4
    s_cmp_eq_u32 s17, 0
    s_cselect_b64 vcc, -1, 0
    v_cndmask_b32 v174, v3, v5, vcc
    v_cndmask_b32 v175, v5, v3, vcc
    v_mov_b32 v16, 0
    v_mov_b32 v17, 0
    v_mov_b32 v18, 0
    v_mov_b32 v19, 0
    v_mov_b32 v20, 0
    v_mov_b32 v21, 0
    v_mov_b32 v22, 0
    v_mov_b32 v23, 0
    v_mov_b32 v24, 0
    v_mov_b32 v25, 0
    v_mov_b32 v26, 0
    v_mov_b32 v27, 0
    v_mov_b32 v28, 0
    v_mov_b32 v29, 0
    v_mov_b32 v30, 0
    v_mov_b32 v31, 0
    v_mov_b32 v32, 0
    v_mov_b32 v33, 0
    v_mov_b32 v34, 0
    v_mov_b32 v35, 0
    v_mov_b32 v36, 0
    v_mov_b32 v37, 0
    v_mov_b32 v38, 0
    v_mov_b32 v39, 0
    v_mov_b32 v40, 0
    v_mov_b32 v41, 0
    v_mov_b32 v42, 0
    v_mov_b32 v43, 0
    v_mov_b32 v44, 0
    v_mov_b32 v45, 0
    v_mov_b32 v46, 0
    v_mov_b32 v47, 0
    v_mov_b32 v48, 0
    v_mov_b32 v49, 0
    v_mov_b32 v50, 0
    v_mov_b32 v51, 0
    v_mov_b32 v52, 0
    v_mov_b32 v53, 0
    v_mov_b32 v54, 0
    v_mov_b32 v55, 0
    v_mov_b32 v56, 0
    v_mov_b32 v57, 0
    v_mov_b32 v58, 0
    v_mov_b32 v59, 0
    v_mov_b32 v60, 0
    v_mov_b32 v61, 0
    v_mov_b32 v62, 0
    v_mov_b32 v63, 0
    v_mov_b32 v64, 0
    v_mov_b32 v65, 0
    v_mov_b32 v66, 0
    v_mov_b32 v67, 0
    v_mov_b32 v68, 0
    v_mov_b32 v69, 0
    v_mov_b32 v70, 0
    v_mov_b32 v71, 0
    v_mov_b32 v72, 0
    v_mov_b32 v73, 0
    v_mov_b32 v74, 0
    v_mov_b32 v75, 0
    v_mov_b32 v76, 0
    v_mov_b32 v77, 0
    v_mov_b32 v78, 0
    v_mov_b32 v79, 0
    v_mov_b32 v80, 0
    v_mov_b32 v81, 0
    v_mov_b32 v82, 0
    v_mov_b32 v83, 0
    v_mov_b32 v84, 0
    v_mov_b32 v85, 0
    v_mov_b32 v86, 0
    v_mov_b32 v87, 0
    v_mov_b32 v88, 0
    v_mov_b32 v89, 0
    v_mov_b32 v90, 0
    v_mov_b32 v91, 0
    v_mov_b32 v92, 0
    v_mov_b32 v93, 0
    v_mov_b32 v94, 0
    v_mov_b32 v95, 0
    v_mov_b32 v96, 0
    v_mov_b32 v97, 0
    v_mov_b32 v98, 0
    v_mov_b32 v99, 0
    v_mov_b32 v100, 0
    v_mov_b32 v101, 0
    v_mov_b32 v102, 0
    v_mov_b32 v103, 0
    v_mov_b32 v104, 0
    v_mov_b32 v105, 0
    v_mov_b32 v106, 0
    v_mov_b32 v107, 0
    v_mov_b32 v108, 0
    v_mov_b32 v109, 0
    v_mov_b32 v110, 0
    v_mov_b32 v111, 0
    s_mov_b32 s22, 4096
    v_add_u32 v168, s22, v170
    v_add_u32 v169, s22, v171
    v_add_u32 v172, s22, v174
    v_add_u32 v173, s22, v175
    s_barrier
    ds_read_b128 v[136:139], v168 offset:0
    ds_read_b64_tr_b16 v[112:113], v172 offset:0
    ds_read_b64_tr_b16 v[114:115], v172 offset:768
    ds_read_b64_tr_b16 v[116:117], v173 offset:32
    ds_read_b64_tr_b16 v[118:119], v173 offset:800
    ds_read_b64_tr_b16 v[120:121], v172 offset:64
    ds_read_b64_tr_b16 v[122:123], v172 offset:832
    ds_read_b128 v[140:143], v168 offset:2048
    ds_read_b128 v[144:147], v168 offset:4096
    ds_read_b128 v[148:151], v168 offset:6144
    s_mov_b32 s24, 0
Lzp_190:
    s_cmp_lg_u32 s24, 3
    s_cbranch_scc1 Lmid_191
    s_lshl_b32 s26, s60, 18
    s_lshl_b32 s27, s61, 15
    s_add_u32 s26, s26, s27
    s_lshl_b32 s27, s3, 13
    s_add_u32 s26, s26, s27
    s_mov_b32 s28, s46
    s_mov_b32 s29, s47
    s_mov_b32 s30, 8388608
    s_mov_b32 s31, 0x00020000
    v_lshlrev_b32 v240, 7, v0
    buffer_load_dword v254, v240, s[28:31], s26 offen
    s_mov_b32 s28, s56
    s_mov_b32 s29, s57
    s_mov_b32 s30, 256
    s_mov_b32 s31, 0x00020000
    v_mov_b32 v243, 0
    buffer_load_dword v244, v243, s[28:31], 0 offen sc1
Lmid_191:
    s_waitcnt lgkmcnt(7)
    v_mfma_f32_16x16x32_bf16 v[16:19], v[136:139], v[112:115], v[16:19]
    ds_read_b128 v[152:155], v169 offset:0
    s_waitcnt lgkmcnt(6)
    v_mfma_f32_16x16x32_bf16 v[20:23], v[136:139], v[116:119], v[20:23]
    ds_read_b64_tr_b16 v[124:125], v172 offset:6144
    ds_read_b64_tr_b16 v[126:127], v172 offset:6912
    s_waitcnt lgkmcnt(6)
    v_mfma_f32_16x16x32_bf16 v[24:27], v[136:139], v[120:123], v[24:27]
    ds_read_b64_tr_b16 v[128:129], v173 offset:6176
    ds_read_b64_tr_b16 v[130:131], v173 offset:6944
    s_waitcnt lgkmcnt(7)
    v_mfma_f32_16x16x32_bf16 v[28:31], v[140:143], v[112:115], v[28:31]
    ds_read_b64_tr_b16 v[132:133], v172 offset:6208
    ds_read_b64_tr_b16 v[134:135], v172 offset:6976
    v_mfma_f32_16x16x32_bf16 v[32:35], v[140:143], v[116:119], v[32:35]
    ds_read_b128 v[156:159], v169 offset:2048
    v_mfma_f32_16x16x32_bf16 v[36:39], v[140:143], v[120:123], v[36:39]
    ds_read_b128 v[160:163], v169 offset:4096
    s_waitcnt lgkmcnt(10)
    v_mfma_f32_16x16x32_bf16 v[40:43], v[144:147], v[112:115], v[40:43]
    ds_read_b128 v[164:167], v169 offset:6144
    v_mfma_f32_16x16x32_bf16 v[44:47], v[144:147], v[116:119], v[44:47]
    v_mfma_f32_16x16x32_bf16 v[48:51], v[144:147], v[120:123], v[48:51]
    s_waitcnt lgkmcnt(10)
    v_mfma_f32_16x16x32_bf16 v[52:55], v[148:151], v[112:115], v[52:55]
    v_mfma_f32_16x16x32_bf16 v[56:59], v[148:151], v[116:119], v[56:59]
    v_mfma_f32_16x16x32_bf16 v[60:63], v[148:151], v[120:123], v[60:63]
    s_add_u32 s22, s22, 28672
    s_cmp_eq_u32 s22, 90112
    s_cselect_b32 s22, 4096, s22
    s_waitcnt lgkmcnt(7)
    v_mfma_f32_16x16x32_bf16 v[16:19], v[152:155], v[124:127], v[16:19]
    v_add_u32 v168, s22, v170
    v_add_u32 v169, s22, v171
    v_add_u32 v172, s22, v174
    v_add_u32 v173, s22, v175
    s_waitcnt lgkmcnt(0)
    s_barrier
    ds_read_b128 v[136:139], v168 offset:0
    v_mfma_f32_16x16x32_bf16 v[20:23], v[152:155], v[128:131], v[20:23]
    ds_read_b64_tr_b16 v[112:113], v172 offset:0
    ds_read_b64_tr_b16 v[114:115], v172 offset:768
    v_mfma_f32_16x16x32_bf16 v[24:27], v[152:155], v[132:135], v[24:27]
    ds_read_b64_tr_b16 v[116:117], v173 offset:32
    ds_read_b64_tr_b16 v[118:119], v173 offset:800
    v_mfma_f32_16x16x32_bf16 v[28:31], v[156:159], v[124:127], v[28:31]
    ds_read_b64_tr_b16 v[120:121], v172 offset:64
    ds_read_b64_tr_b16 v[122:123], v172 offset:832
    v_mfma_f32_16x16x32_bf16 v[32:35], v[156:159], v[128:131], v[32:35]
    ds_read_b128 v[140:143], v168 offset:2048
    v_mfma_f32_16x16x32_bf16 v[36:39], v[156:159], v[132:135], v[36:39]
    ds_read_b128 v[144:147], v168 offset:4096
    v_mfma_f32_16x16x32_bf16 v[40:43], v[160:163], v[124:127], v[40:43]
    ds_read_b128 v[148:151], v168 offset:6144
    v_mfma_f32_16x16x32_bf16 v[44:47], v[160:163], v[128:131], v[44:47]
    v_mfma_f32_16x16x32_bf16 v[48:51], v[160:163], v[132:135], v[48:51]
    v_mfma_f32_16x16x32_bf16 v[52:55], v[164:167], v[124:127], v[52:55]
    v_mfma_f32_16x16x32_bf16 v[56:59], v[164:167], v[128:131], v[56:59]
    v_mfma_f32_16x16x32_bf16 v[60:63], v[164:167], v[132:135], v[60:63]
    s_add_u32 s24, s24, 1
    s_cmp_lt_u32 s24, 9
    s_cbranch_scc1 Lzp_190
    s_waitcnt lgkmcnt(7)
    v_mfma_f32_16x16x32_bf16 v[16:19], v[136:139], v[112:115], v[16:19]
    ds_read_b128 v[152:155], v169 offset:0
    s_waitcnt lgkmcnt(6)
    v_mfma_f32_16x16x32_bf16 v[20:23], v[136:139], v[116:119], v[20:23]
    ds_read_b64_tr_b16 v[124:125], v172 offset:6144
    ds_read_b64_tr_b16 v[126:127], v172 offset:6912
    s_waitcnt lgkmcnt(6)
    v_mfma_f32_16x16x32_bf16 v[24:27], v[136:139], v[120:123], v[24:27]
    ds_read_b64_tr_b16 v[128:129], v173 offset:6176
    ds_read_b64_tr_b16 v[130:131], v173 offset:6944
    s_waitcnt lgkmcnt(7)
    v_mfma_f32_16x16x32_bf16 v[28:31], v[140:143], v[112:115], v[28:31]
    ds_read_b64_tr_b16 v[132:133], v172 offset:6208
    ds_read_b64_tr_b16 v[134:135], v172 offset:6976
    v_mfma_f32_16x16x32_bf16 v[32:35], v[140:143], v[116:119], v[32:35]
    ds_read_b128 v[156:159], v169 offset:2048
    v_mfma_f32_16x16x32_bf16 v[36:39], v[140:143], v[120:123], v[36:39]
    ds_read_b128 v[160:163], v169 offset:4096
    s_waitcnt lgkmcnt(10)
    v_mfma_f32_16x16x32_bf16 v[40:43], v[144:147], v[112:115], v[40:43]
    ds_read_b128 v[164:167], v169 offset:6144
    v_mfma_f32_16x16x32_bf16 v[44:47], v[144:147], v[116:119], v[44:47]
    v_mfma_f32_16x16x32_bf16 v[48:51], v[144:147], v[120:123], v[48:51]
    s_waitcnt lgkmcnt(10)
    v_mfma_f32_16x16x32_bf16 v[52:55], v[148:151], v[112:115], v[52:55]
    v_mfma_f32_16x16x32_bf16 v[56:59], v[148:151], v[116:119], v[56:59]
    v_mfma_f32_16x16x32_bf16 v[60:63], v[148:151], v[120:123], v[60:63]
    s_waitcnt lgkmcnt(7)
    v_mfma_f32_16x16x32_bf16 v[16:19], v[152:155], v[124:127], v[16:19]
    s_waitcnt lgkmcnt(5)
    v_mfma_f32_16x16x32_bf16 v[20:23], v[152:155], v[128:131], v[20:23]
    s_waitcnt lgkmcnt(3)
    v_mfma_f32_16x16x32_bf16 v[24:27], v[152:155], v[132:135], v[24:27]
    s_waitcnt lgkmcnt(2)
    v_mfma_f32_16x16x32_bf16 v[28:31], v[156:159], v[124:127], v[28:31]
    v_mfma_f32_16x16x32_bf16 v[32:35], v[156:159], v[128:131], v[32:35]
    v_mfma_f32_16x16x32_bf16 v[36:39], v[156:159], v[132:135], v[36:39]
    s_waitcnt lgkmcnt(1)
    v_mfma_f32_16x16x32_bf16 v[40:43], v[160:163], v[124:127], v[40:43]
    v_mfma_f32_16x16x32_bf16 v[44:47], v[160:163], v[128:131], v[44:47]
    v_mfma_f32_16x16x32_bf16 v[48:51], v[160:163], v[132:135], v[48:51]
    s_waitcnt lgkmcnt(0)
    v_mfma_f32_16x16x32_bf16 v[52:55], v[164:167], v[124:127], v[52:55]
    v_mfma_f32_16x16x32_bf16 v[56:59], v[164:167], v[128:131], v[56:59]
    v_mfma_f32_16x16x32_bf16 v[60:63], v[164:167], v[132:135], v[60:63]
    v_mov_b32 v176, 0xc0135761
    v_mov_b32 v177, 0xc0135761
    v_mov_b32 v178, 0xbdd2d3e8
    v_mov_b32 v179, 0xbdd2d3e8
    v_pk_mul_f32 v[180:181], v[16:17], v[16:17]
    v_pk_mul_f32 v[184:185], v[18:19], v[18:19]
    v_pk_fma_f32 v[180:181], v[180:181], v[178:179], v[176:177]
    v_pk_fma_f32 v[184:185], v[184:185], v[178:179], v[176:177]
    v_pk_mul_f32 v[180:181], v[180:181], v[16:17]
    v_pk_mul_f32 v[184:185], v[184:185], v[18:19]
    v_exp_f32 v180, v180
    v_exp_f32 v181, v181
    v_exp_f32 v184, v184
    v_exp_f32 v185, v185
    v_pk_add_f32 v[180:181], v[180:181], 1.0 op_sel_hi:[1,0]
    v_pk_add_f32 v[184:185], v[184:185], 1.0 op_sel_hi:[1,0]
    v_rcp_f32 v180, v180
    v_rcp_f32 v181, v181
    v_rcp_f32 v184, v184
    v_rcp_f32 v185, v185
    v_pk_mul_f32 v[16:17], v[16:17], v[180:181]
    v_pk_mul_f32 v[18:19], v[18:19], v[184:185]
    v_pk_mul_f32 v[180:181], v[20:21], v[20:21]
    v_pk_mul_f32 v[184:185], v[22:23], v[22:23]
    v_pk_fma_f32 v[180:181], v[180:181], v[178:179], v[176:177]
    v_pk_fma_f32 v[184:185], v[184:185], v[178:179], v[176:177]
    v_pk_mul_f32 v[180:181], v[180:181], v[20:21]
    v_pk_mul_f32 v[184:185], v[184:185], v[22:23]
    v_exp_f32 v180, v180
    v_exp_f32 v181, v181
    v_exp_f32 v184, v184
    v_exp_f32 v185, v185
    v_pk_add_f32 v[180:181], v[180:181], 1.0 op_sel_hi:[1,0]
    v_pk_add_f32 v[184:185], v[184:185], 1.0 op_sel_hi:[1,0]
    v_rcp_f32 v180, v180
    v_rcp_f32 v181, v181
    v_rcp_f32 v184, v184
    v_rcp_f32 v185, v185
    v_pk_mul_f32 v[20:21], v[20:21], v[180:181]
    v_pk_mul_f32 v[22:23], v[22:23], v[184:185]
    v_pk_mul_f32 v[180:181], v[24:25], v[24:25]
    v_pk_mul_f32 v[184:185], v[26:27], v[26:27]
    v_pk_fma_f32 v[180:181], v[180:181], v[178:179], v[176:177]
    v_pk_fma_f32 v[184:185], v[184:185], v[178:179], v[176:177]
    v_pk_mul_f32 v[180:181], v[180:181], v[24:25]
    v_pk_mul_f32 v[184:185], v[184:185], v[26:27]
    v_exp_f32 v180, v180
    v_exp_f32 v181, v181
    v_exp_f32 v184, v184
    v_exp_f32 v185, v185
    v_pk_add_f32 v[180:181], v[180:181], 1.0 op_sel_hi:[1,0]
    v_pk_add_f32 v[184:185], v[184:185], 1.0 op_sel_hi:[1,0]
    v_rcp_f32 v180, v180
    v_rcp_f32 v181, v181
    v_rcp_f32 v184, v184
    v_rcp_f32 v185, v185
    v_pk_mul_f32 v[24:25], v[24:25], v[180:181]
    v_pk_mul_f32 v[26:27], v[26:27], v[184:185]
    v_pk_mul_f32 v[180:181], v[28:29], v[28:29]
    v_pk_mul_f32 v[184:185], v[30:31], v[30:31]
    v_pk_fma_f32 v[180:181], v[180:181], v[178:179], v[176:177]
    v_pk_fma_f32 v[184:185], v[184:185], v[178:179], v[176:177]
    v_pk_mul_f32 v[180:181], v[180:181], v[28:29]
    v_pk_mul_f32 v[184:185], v[184:185], v[30:31]
    v_exp_f32 v180, v180
    v_exp_f32 v181, v181
    v_exp_f32 v184, v184
    v_exp_f32 v185, v185
    v_pk_add_f32 v[180:181], v[180:181], 1.0 op_sel_hi:[1,0]
    v_pk_add_f32 v[184:185], v[184:185], 1.0 op_sel_hi:[1,0]
    v_rcp_f32 v180, v180
    v_rcp_f32 v181, v181
    v_rcp_f32 v184, v184
    v_rcp_f32 v185, v185
    v_pk_mul_f32 v[28:29], v[28:29], v[180:181]
    v_pk_mul_f32 v[30:31], v[30:31], v[184:185]
    v_pk_mul_f32 v[180:181], v[32:33], v[32:33]
    v_pk_mul_f32 v[184:185], v[34:35], v[34:35]
    v_pk_fma_f32 v[180:181], v[180:181], v[178:179], v[176:177]
    v_pk_fma_f32 v[184:185], v[184:185], v[178:179], v[176:177]
    v_pk_mul_f32 v[180:181], v[180:181], v[32:33]
    v_pk_mul_f32 v[184:185], v[184:185], v[34:35]
    v_exp_f32 v180, v180
    v_exp_f32 v181, v181
    v_exp_f32 v184, v184
    v_exp_f32 v185, v185
    v_pk_add_f32 v[180:181], v[180:181], 1.0 op_sel_hi:[1,0]
    v_pk_add_f32 v[184:185], v[184:185], 1.0 op_sel_hi:[1,0]
    v_rcp_f32 v180, v180
    v_rcp_f32 v181, v181
    v_rcp_f32 v184, v184
    v_rcp_f32 v185, v185
    v_pk_mul_f32 v[32:33], v[32:33], v[180:181]
    v_pk_mul_f32 v[34:35], v[34:35], v[184:185]
    v_pk_mul_f32 v[180:181], v[36:37], v[36:37]
    v_pk_mul_f32 v[184:185], v[38:39], v[38:39]
    v_pk_fma_f32 v[180:181], v[180:181], v[178:179], v[176:177]
    v_pk_fma_f32 v[184:185], v[184:185], v[178:179], v[176:177]
    v_pk_mul_f32 v[180:181], v[180:181], v[36:37]
    v_pk_mul_f32 v[184:185], v[184:185], v[38:39]
    v_exp_f32 v180, v180
    v_exp_f32 v181, v181
    v_exp_f32 v184, v184
    v_exp_f32 v185, v185
    v_pk_add_f32 v[180:181], v[180:181], 1.0 op_sel_hi:[1,0]
    v_pk_add_f32 v[184:185], v[184:185], 1.0 op_sel_hi:[1,0]
    v_rcp_f32 v180, v180
    v_rcp_f32 v181, v181
    v_rcp_f32 v184, v184
    v_rcp_f32 v185, v185
    v_pk_mul_f32 v[36:37], v[36:37], v[180:181]
    v_pk_mul_f32 v[38:39], v[38:39], v[184:185]
    v_pk_mul_f32 v[180:181], v[40:41], v[40:41]
    v_pk_mul_f32 v[184:185], v[42:43], v[42:43]
    v_pk_fma_f32 v[180:181], v[180:181], v[178:179], v[176:177]
    v_pk_fma_f32 v[184:185], v[184:185], v[178:179], v[176:177]
    v_pk_mul_f32 v[180:181], v[180:181], v[40:41]
    v_pk_mul_f32 v[184:185], v[184:185], v[42:43]
    v_exp_f32 v180, v180
    v_exp_f32 v181, v181
    v_exp_f32 v184, v184
    v_exp_f32 v185, v185
    v_pk_add_f32 v[180:181], v[180:181], 1.0 op_sel_hi:[1,0]
    v_pk_add_f32 v[184:185], v[184:185], 1.0 op_sel_hi:[1,0]
    v_rcp_f32 v180, v180
    v_rcp_f32 v181, v181
    v_rcp_f32 v184, v184
    v_rcp_f32 v185, v185
    v_pk_mul_f32 v[40:41], v[40:41], v[180:181]
    v_pk_mul_f32 v[42:43], v[42:43], v[184:185]
    v_pk_mul_f32 v[180:181], v[44:45], v[44:45]
    v_pk_mul_f32 v[184:185], v[46:47], v[46:47]
    v_pk_fma_f32 v[180:181], v[180:181], v[178:179], v[176:177]
    v_pk_fma_f32 v[184:185], v[184:185], v[178:179], v[176:177]
    v_pk_mul_f32 v[180:181], v[180:181], v[44:45]
    v_pk_mul_f32 v[184:185], v[184:185], v[46:47]
    v_exp_f32 v180, v180
    v_exp_f32 v181, v181
    v_exp_f32 v184, v184
    v_exp_f32 v185, v185
    v_pk_add_f32 v[180:181], v[180:181], 1.0 op_sel_hi:[1,0]
    v_pk_add_f32 v[184:185], v[184:185], 1.0 op_sel_hi:[1,0]
    v_rcp_f32 v180, v180
    v_rcp_f32 v181, v181
    v_rcp_f32 v184, v184
    v_rcp_f32 v185, v185
    v_pk_mul_f32 v[44:45], v[44:45], v[180:181]
    v_pk_mul_f32 v[46:47], v[46:47], v[184:185]
    v_pk_mul_f32 v[180:181], v[48:49], v[48:49]
    v_pk_mul_f32 v[184:185], v[50:51], v[50:51]
    v_pk_fma_f32 v[180:181], v[180:181], v[178:179], v[176:177]
    v_pk_fma_f32 v[184:185], v[184:185], v[178:179], v[176:177]
    v_pk_mul_f32 v[180:181], v[180:181], v[48:49]
    v_pk_mul_f32 v[184:185], v[184:185], v[50:51]
    v_exp_f32 v180, v180
    v_exp_f32 v181, v181
    v_exp_f32 v184, v184
    v_exp_f32 v185, v185
    v_pk_add_f32 v[180:181], v[180:181], 1.0 op_sel_hi:[1,0]
    v_pk_add_f32 v[184:185], v[184:185], 1.0 op_sel_hi:[1,0]
    v_rcp_f32 v180, v180
    v_rcp_f32 v181, v181
    v_rcp_f32 v184, v184
    v_rcp_f32 v185, v185
    v_pk_mul_f32 v[48:49], v[48:49], v[180:181]
    v_pk_mul_f32 v[50:51], v[50:51], v[184:185]
    v_pk_mul_f32 v[180:181], v[52:53], v[52:53]
    v_pk_mul_f32 v[184:185], v[54:55], v[54:55]
    v_pk_fma_f32 v[180:181], v[180:181], v[178:179], v[176:177]
    v_pk_fma_f32 v[184:185], v[184:185], v[178:179], v[176:177]
    v_pk_mul_f32 v[180:181], v[180:181], v[52:53]
    v_pk_mul_f32 v[184:185], v[184:185], v[54:55]
    v_exp_f32 v180, v180
    v_exp_f32 v181, v181
    v_exp_f32 v184, v184
    v_exp_f32 v185, v185
    v_pk_add_f32 v[180:181], v[180:181], 1.0 op_sel_hi:[1,0]
    v_pk_add_f32 v[184:185], v[184:185], 1.0 op_sel_hi:[1,0]
    v_rcp_f32 v180, v180
    v_rcp_f32 v181, v181
    v_rcp_f32 v184, v184
    v_rcp_f32 v185, v185
    v_pk_mul_f32 v[52:53], v[52:53], v[180:181]
    v_pk_mul_f32 v[54:55], v[54:55], v[184:185]
    v_pk_mul_f32 v[180:181], v[56:57], v[56:57]
    v_pk_mul_f32 v[184:185], v[58:59], v[58:59]
    v_pk_fma_f32 v[180:181], v[180:181], v[178:179], v[176:177]
    v_pk_fma_f32 v[184:185], v[184:185], v[178:179], v[176:177]
    v_pk_mul_f32 v[180:181], v[180:181], v[56:57]
    v_pk_mul_f32 v[184:185], v[184:185], v[58:59]
    v_exp_f32 v180, v180
    v_exp_f32 v181, v181
    v_exp_f32 v184, v184
    v_exp_f32 v185, v185
    v_pk_add_f32 v[180:181], v[180:181], 1.0 op_sel_hi:[1,0]
    v_pk_add_f32 v[184:185], v[184:185], 1.0 op_sel_hi:[1,0]
    v_rcp_f32 v180, v180
    v_rcp_f32 v181, v181
    v_rcp_f32 v184, v184
    v_rcp_f32 v185, v185
    v_pk_mul_f32 v[56:57], v[56:57], v[180:181]
    v_pk_mul_f32 v[58:59], v[58:59], v[184:185]
    v_pk_mul_f32 v[180:181], v[60:61], v[60:61]
    v_pk_mul_f32 v[184:185], v[62:63], v[62:63]
    v_pk_fma_f32 v[180:181], v[180:181], v[178:179], v[176:177]
    v_pk_fma_f32 v[184:185], v[184:185], v[178:179], v[176:177]
    v_pk_mul_f32 v[180:181], v[180:181], v[60:61]
    v_pk_mul_f32 v[184:185], v[184:185], v[62:63]
    v_exp_f32 v180, v180
    v_exp_f32 v181, v181
    v_exp_f32 v184, v184
    v_exp_f32 v185, v185
    v_pk_add_f32 v[180:181], v[180:181], 1.0 op_sel_hi:[1,0]
    v_pk_add_f32 v[184:185], v[184:185], 1.0 op_sel_hi:[1,0]
    v_rcp_f32 v180, v180
    v_rcp_f32 v181, v181
    v_rcp_f32 v184, v184
    v_rcp_f32 v185, v185
    v_pk_mul_f32 v[60:61], v[60:61], v[180:181]
    v_pk_mul_f32 v[62:63], v[62:63], v[184:185]
    v_add_f32 v192, v16, v20
    v_mul_f32 v208, v16, v16
    v_add_f32 v192, v192, v24
    v_fmac_f32 v208, v20, v20
    v_fmac_f32 v208, v24, v24
    v_add_f32 v193, v17, v21
    v_mul_f32 v209, v17, v17
    v_add_f32 v193, v193, v25
    v_fmac_f32 v209, v21, v21
    v_fmac_f32 v209, v25, v25
    v_add_f32 v194, v18, v22
    v_mul_f32 v210, v18, v18
    v_add_f32 v194, v194, v26
    v_fmac_f32 v210, v22, v22
    v_fmac_f32 v210, v26, v26
    v_add_f32 v195, v19, v23
    v_mul_f32 v211, v19, v19
    v_add_f32 v195, v195, v27
    v_fmac_f32 v211, v23, v23
    v_fmac_f32 v211, v27, v27
    v_add_f32 v196, v28, v32
    v_mul_f32 v212, v28, v28
    v_add_f32 v196, v196, v36
    v_fmac_f32 v212, v32, v32
    v_fmac_f32 v212, v36, v36
    v_add_f32 v197, v29, v33
    v_mul_f32 v213, v29, v29
    v_add_f32 v197, v197, v37
    v_fmac_f32 v213, v33, v33
    v_fmac_f32 v213, v37, v37
    v_add_f32 v198, v30, v34
    v_mul_f32 v214, v30, v30
    v_add_f32 v198, v198, v38
    v_fmac_f32 v214, v34, v34
    v_fmac_f32 v214, v38, v38
    v_add_f32 v199, v31, v35
    v_mul_f32 v215, v31, v31
    v_add_f32 v199, v199, v39
    v_fmac_f32 v215, v35, v35
    v_fmac_f32 v215, v39, v39
    v_add_f32 v200, v40, v44
    v_mul_f32 v216, v40, v40
    v_add_f32 v200, v200, v48
    v_fmac_f32 v216, v44, v44
    v_fmac_f32 v216, v48, v48
    v_add_f32 v201, v41, v45
    v_mul_f32 v217, v41, v41
    v_add_f32 v201, v201, v49
    v_fmac_f32 v217, v45, v45
    v_fmac_f32 v217, v49, v49
    v_add_f32 v202, v42, v46
    v_mul_f32 v218, v42, v42
    v_add_f32 v202, v202, v50
    v_fmac_f32 v218, v46, v46
    v_fmac_f32 v218, v50, v50
    v_add_f32 v203, v43, v47
    v_mul_f32 v219, v43, v43
    v_add_f32 v203, v203, v51
    v_fmac_f32 v219, v47, v47
    v_fmac_f32 v219, v51, v51
    v_add_f32 v204, v52, v56
    v_mul_f32 v220, v52, v52
    v_add_f32 v204, v204, v60
    v_fmac_f32 v220, v56, v56
    v_fmac_f32 v220, v60, v60
    v_add_f32 v205, v53, v57
    v_mul_f32 v221, v53, v53
    v_add_f32 v205, v205, v61
    v_fmac_f32 v221, v57, v57
    v_fmac_f32 v221, v61, v61
    v_add_f32 v206, v54, v58
    v_mul_f32 v222, v54, v54
    v_add_f32 v206, v206, v62
    v_fmac_f32 v222, v58, v58
    v_fmac_f32 v222, v62, v62
    v_add_f32 v207, v55, v59
    v_mul_f32 v223, v55, v55
    v_add_f32 v207, v207, v63
    v_fmac_f32 v223, v59, v59
    v_fmac_f32 v223, v63, v63
    v_add_f32_dpp v192, v192, v192 row_ror:8 row_mask:0xf bank_mask:0x3
    v_add_f32_dpp v193, v193, v193 row_ror:8 row_mask:0xf bank_mask:0x3
    v_add_f32_dpp v194, v194, v194 row_ror:8 row_mask:0xf bank_mask:0x3
    v_add_f32_dpp v195, v195, v195 row_ror:8 row_mask:0xf bank_mask:0x3
    v_add_f32_dpp v196, v196, v196 row_ror:8 row_mask:0xf bank_mask:0x3
    v_add_f32_dpp v197, v197, v197 row_ror:8 row_mask:0xf bank_mask:0x3
    v_add_f32_dpp v198, v198, v198 row_ror:8 row_mask:0xf bank_mask:0x3
    v_add_f32_dpp v199, v199, v199 row_ror:8 row_mask:0xf bank_mask:0x3
    v_add_f32_dpp v208, v208, v208 row_ror:8 row_mask:0xf bank_mask:0x3
    v_add_f32_dpp v209, v209, v209 row_ror:8 row_mask:0xf bank_mask:0x3
    v_add_f32_dpp v210, v210, v210 row_ror:8 row_mask:0xf bank_mask:0x3
    v_add_f32_dpp v211, v211, v211 row_ror:8 row_mask:0xf bank_mask:0x3
    v_add_f32_dpp v212, v212, v212 row_ror:8 row_mask:0xf bank_mask:0x3
    v_add_f32_dpp v213, v213, v213 row_ror:8 row_mask:0xf bank_mask:0x3
    v_add_f32_dpp v214, v214, v214 row_ror:8 row_mask:0xf bank_mask:0x3
    v_add_f32_dpp v215, v215, v215 row_ror:8 row_mask:0xf bank_mask:0x3
    v_add_f32_dpp v192, v200, v200 row_ror:8 row_mask:0xf bank_mask:0xc
    v_add_f32_dpp v193, v201, v201 row_ror:8 row_mask:0xf bank_mask:0xc
    v_add_f32_dpp v194, v202, v202 row_ror:8 row_mask:0xf bank_mask:0xc
    v_add_f32_dpp v195, v203, v203 row_ror:8 row_mask:0xf bank_mask:0xc
    v_add_f32_dpp v196, v204, v204 row_ror:8 row_mask:0xf bank_mask:0xc
    v_add_f32_dpp v197, v205, v205 row_ror:8 row_mask:0xf bank_mask:0xc
    v_add_f32_dpp v198, v206, v206 row_ror:8 row_mask:0xf bank_mask:0xc
    v_add_f32_dpp v199, v207, v207 row_ror:8 row_mask:0xf bank_mask:0xc
    v_add_f32_dpp v208, v216, v216 row_ror:8 row_mask:0xf bank_mask:0xc
    v_add_f32_dpp v209, v217, v217 row_ror:8 row_mask:0xf bank_mask:0xc
    v_add_f32_dpp v210, v218, v218 row_ror:8 row_mask:0xf bank_mask:0xc
    v_add_f32_dpp v211, v219, v219 row_ror:8 row_mask:0xf bank_mask:0xc
    v_add_f32_dpp v212, v220, v220 row_ror:8 row_mask:0xf bank_mask:0xc
    v_add_f32_dpp v213, v221, v221 row_ror:8 row_mask:0xf bank_mask:0xc
    v_add_f32_dpp v214, v222, v222 row_ror:8 row_mask:0xf bank_mask:0xc
    v_add_f32_dpp v215, v223, v223 row_ror:8 row_mask:0xf bank_mask:0xc
    v_add_f32_dpp v192, v192, v192 row_half_mirror row_mask:0xf bank_mask:0x5
    v_add_f32_dpp v193, v193, v193 row_half_mirror row_mask:0xf bank_mask:0x5
    v_add_f32_dpp v194, v194, v194 row_half_mirror row_mask:0xf bank_mask:0x5
    v_add_f32_dpp v195, v195, v195 row_half_mirror row_mask:0xf bank_mask:0x5
    v_add_f32_dpp v208, v208, v208 row_half_mirror row_mask:0xf bank_mask:0x5
    v_add_f32_dpp v209, v209, v209 row_half_mirror row_mask:0xf bank_mask:0x5
    v_add_f32_dpp v210, v210, v210 row_half_mirror row_mask:0xf bank_mask:0x5
    v_add_f32_dpp v211, v211, v211 row_half_mirror row_mask:0xf bank_mask:0x5
    v_add_f32_dpp v192, v196, v196 row_half_mirror row_mask:0xf bank_mask:0xa
    v_add_f32_dpp v193, v197, v197 row_half_mirror row_mask:0xf bank_mask:0xa
    v_add_f32_dpp v194, v198, v198 row_half_mirror row_mask:0xf bank_mask:0xa
    v_add_f32_dpp v195, v199, v199 row_half_mirror row_mask:0xf bank_mask:0xa
    v_add_f32_dpp v208, v212, v212 row_half_mirror row_mask:0xf bank_mask:0xa
    v_add_f32_dpp v209, v213, v213 row_half_mirror row_mask:0xf bank_mask:0xa
    v_add_f32_dpp v210, v214, v214 row_half_mirror row_mask:0xf bank_mask:0xa
    v_add_f32_dpp v211, v215, v215 row_half_mirror row_mask:0xf bank_mask:0xa
    v_add_f32_dpp v192, v192, v192 quad_perm:[2,3,0,1] row_mask:0xf bank_mask:0xf
    v_add_f32_dpp v193, v193, v193 quad_perm:[2,3,0,1] row_mask:0xf bank_mask:0xf
    v_add_f32_dpp v194, v194, v194 quad_perm:[2,3,0,1] row_mask:0xf bank_mask:0xf
    v_add_f32_dpp v195, v195, v195 quad_perm:[2,3,0,1] row_mask:0xf bank_mask:0xf
    v_add_f32_dpp v208, v208, v208 quad_perm:[2,3,0,1] row_mask:0xf bank_mask:0xf
    v_add_f32_dpp v209, v209, v209 quad_perm:[2,3,0,1] row_mask:0xf bank_mask:0xf
    v_add_f32_dpp v210, v210, v210 quad_perm:[2,3,0,1] row_mask:0xf bank_mask:0xf
    v_add_f32_dpp v211, v211, v211 quad_perm:[2,3,0,1] row_mask:0xf bank_mask:0xf
    v_add_f32_dpp v192, v192, v192 quad_perm:[1,0,3,2] row_mask:0xf bank_mask:0xf
    v_add_f32_dpp v193, v193, v193 quad_perm:[1,0,3,2] row_mask:0xf bank_mask:0xf
    v_add_f32_dpp v194, v194, v194 quad_perm:[1,0,3,2] row_mask:0xf bank_mask:0xf
    v_add_f32_dpp v195, v195, v195 quad_perm:[1,0,3,2] row_mask:0xf bank_mask:0xf
    v_add_f32_dpp v208, v208, v208 quad_perm:[1,0,3,2] row_mask:0xf bank_mask:0xf
    v_add_f32_dpp v209, v209, v209 quad_perm:[1,0,3,2] row_mask:0xf bank_mask:0xf
    v_add_f32_dpp v210, v210, v210 quad_perm:[1,0,3,2] row_mask:0xf bank_mask:0xf
    v_add_f32_dpp v211, v211, v211 quad_perm:[1,0,3,2] row_mask:0xf bank_mask:0xf
    s_lshl_b32 s18, s17, 10
    s_lshl_b32 s19, s16, 9
    s_add_u32 s18, s18, s19
    s_add_u32 s18, s18, 0
    v_lshrrev_b32 v3, 2, v1
    v_lshlrev_b32 v3, 7, v3
    v_lshl_add_u32 v3, v2, 5, v3
    v_add_u32 v3, s18, v3
    s_mov_b64 s[12:13], exec
    s_mov_b32 s20, 0x11111111
    s_mov_b32 s21, 0x11111111
    s_mov_b64 exec, s[20:21]
    v_mov_b32 v180, v192
    v_mov_b32 v181, v208
    v_mov_b32 v182, v193
    v_mov_b32 v183, v209
    v_mov_b32 v184, v194
    v_mov_b32 v185, v210
    v_mov_b32 v186, v195
    v_mov_b32 v187, v211
    ds_write_b128 v3, v[180:183]
    ds_write_b128 v3, v[184:187] offset:16
    s_mov_b64 exec, s[12:13]
    s_waitcnt lgkmcnt(0)
    s_barrier
    s_add_u32 s22, s22, 28672
    s_cmp_eq_u32 s22, 90112
    s_cselect_b32 s22, 4096, s22
    v_add_u32 v168, s22, v170
    v_add_u32 v169, s22, v171
    v_add_u32 v172, s22, v174
    v_add_u32 v173, s22, v175
    s_barrier
    ds_read_b128 v[136:139], v168 offset:0
    ds_read_b64_tr_b16 v[112:113], v172 offset:0
    ds_read_b64_tr_b16 v[114:115], v172 offset:768
    ds_read_b64_tr_b16 v[116:117], v173 offset:32
    ds_read_b64_tr_b16 v[118:119], v173 offset:800
    ds_read_b64_tr_b16 v[120:121], v172 offset:64
    ds_read_b64_tr_b16 v[122:123], v172 offset:832
    ds_read_b128 v[140:143], v168 offset:2048
    ds_read_b128 v[144:147], v168 offset:4096
    ds_read_b128 v[148:151], v168 offset:6144
    s_mov_b32 s24, 0
Lzp_192:
    s_waitcnt lgkmcnt(7)
    v_mfma_f32_16x16x32_bf16 v[64:67], v[112:115], v[136:139], v[64:67]
    ds_read_b128 v[152:155], v169 offset:0
    s_waitcnt lgkmcnt(6)
    v_mfma_f32_16x16x32_bf16 v[80:83], v[116:119], v[136:139], v[80:83]
    ds_read_b64_tr_b16 v[124:125], v172 offset:6144
    ds_read_b64_tr_b16 v[126:127], v172 offset:6912
    s_waitcnt lgkmcnt(6)
    v_mfma_f32_16x16x32_bf16 v[96:99], v[120:123], v[136:139], v[96:99]
    ds_read_b64_tr_b16 v[128:129], v173 offset:6176
    ds_read_b64_tr_b16 v[130:131], v173 offset:6944
    s_waitcnt lgkmcnt(7)
    v_mfma_f32_16x16x32_bf16 v[68:71], v[112:115], v[140:143], v[68:71]
    ds_read_b64_tr_b16 v[132:133], v172 offset:6208
    ds_read_b64_tr_b16 v[134:135], v172 offset:6976
    v_mfma_f32_16x16x32_bf16 v[84:87], v[116:119], v[140:143], v[84:87]
    ds_read_b128 v[156:159], v169 offset:2048
    v_mfma_f32_16x16x32_bf16 v[100:103], v[120:123], v[140:143], v[100:103]
    ds_read_b128 v[160:163], v169 offset:4096
    s_waitcnt lgkmcnt(10)
    v_mfma_f32_16x16x32_bf16 v[72:75], v[112:115], v[144:147], v[72:75]
    ds_read_b128 v[164:167], v169 offset:6144
    v_mfma_f32_16x16x32_bf16 v[88:91], v[116:119], v[144:147], v[88:91]
    v_mfma_f32_16x16x32_bf16 v[104:107], v[120:123], v[144:147], v[104:107]
    s_waitcnt lgkmcnt(10)
    v_mfma_f32_16x16x32_bf16 v[76:79], v[112:115], v[148:151], v[76:79]
    v_mfma_f32_16x16x32_bf16 v[92:95], v[116:119], v[148:151], v[92:95]
    v_mfma_f32_16x16x32_bf16 v[108:111], v[120:123], v[148:151], v[108:111]
    s_add_u32 s22, s22, 28672
    s_cmp_eq_u32 s22, 90112
    s_cselect_b32 s22, 4096, s22
    s_waitcnt lgkmcnt(7)
    v_mfma_f32_16x16x32_bf16 v[64:67], v[124:127], v[152:155], v[64:67]
    v_add_u32 v168, s22, v170
    v_add_u32 v169, s22, v171
    v_add_u32 v172, s22, v174
    v_add_u32 v173, s22, v175
    s_waitcnt lgkmcnt(0)
    s_barrier
    ds_read_b128 v[136:139], v168 offset:0
    v_mfma_f32_16x16x32_bf16 v[80:83], v[128:131], v[152:155], v[80:83]
    ds_read_b64_tr_b16 v[112:113], v172 offset:0
    ds_read_b64_tr_b16 v[114:115], v172 offset:768
    v_mfma_f32_16x16x32_bf16 v[96:99], v[132:135], v[152:155], v[96:99]
    ds_read_b64_tr_b16 v[116:117], v173 offset:32
    ds_read_b64_tr_b16 v[118:119], v173 offset:800
    v_mfma_f32_16x16x32_bf16 v[68:71], v[124:127], v[156:159], v[68:71]
    ds_read_b64_tr_b16 v[120:121], v172 offset:64
    ds_read_b64_tr_b16 v[122:123], v172 offset:832
    v_mfma_f32_16x16x32_bf16 v[84:87], v[128:131], v[156:159], v[84:87]
    ds_read_b128 v[140:143], v168 offset:2048
    v_mfma_f32_16x16x32_bf16 v[100:103], v[132:135], v[156:159], v[100:103]
    ds_read_b128 v[144:147], v168 offset:4096
    v_mfma_f32_16x16x32_bf16 v[72:75], v[124:127], v[160:163], v[72:75]
    ds_read_b128 v[148:151], v168 offset:6144
    v_mfma_f32_16x16x32_bf16 v[88:91], v[128:131], v[160:163], v[88:91]
    v_mfma_f32_16x16x32_bf16 v[104:107], v[132:135], v[160:163], v[104:107]
    v_mfma_f32_16x16x32_bf16 v[76:79], v[124:127], v[164:167], v[76:79]
    v_mfma_f32_16x16x32_bf16 v[92:95], v[128:131], v[164:167], v[92:95]
    v_mfma_f32_16x16x32_bf16 v[108:111], v[132:135], v[164:167], v[108:111]
    s_add_u32 s24, s24, 1
    s_cmp_lt_u32 s24, 9
    s_cbranch_scc1 Lzp_192
    s_waitcnt lgkmcnt(7)
    v_mfma_f32_16x16x32_bf16 v[64:67], v[112:115], v[136:139], v[64:67]
    ds_read_b128 v[152:155], v169 offset:0
    s_waitcnt lgkmcnt(6)
    v_mfma_f32_16x16x32_bf16 v[80:83], v[116:119], v[136:139], v[80:83]
    ds_read_b64_tr_b16 v[124:125], v172 offset:6144
    ds_read_b64_tr_b16 v[126:127], v172 offset:6912
    s_waitcnt lgkmcnt(6)
    v_mfma_f32_16x16x32_bf16 v[96:99], v[120:123], v[136:139], v[96:99]
    ds_read_b64_tr_b16 v[128:129], v173 offset:6176
    ds_read_b64_tr_b16 v[130:131], v173 offset:6944
    s_waitcnt lgkmcnt(7)
    v_mfma_f32_16x16x32_bf16 v[68:71], v[112:115], v[140:143], v[68:71]
    ds_read_b64_tr_b16 v[132:133], v172 offset:6208
    ds_read_b64_tr_b16 v[134:135], v172 offset:6976
    v_mfma_f32_16x16x32_bf16 v[84:87], v[116:119], v[140:143], v[84:87]
    ds_read_b128 v[156:159], v169 offset:2048
    v_mfma_f32_16x16x32_bf16 v[100:103], v[120:123], v[140:143], v[100:103]
    ds_read_b128 v[160:163], v169 offset:4096
    s_waitcnt lgkmcnt(10)
    v_mfma_f32_16x16x32_bf16 v[72:75], v[112:115], v[144:147], v[72:75]
    ds_read_b128 v[164:167], v169 offset:6144
    v_mfma_f32_16x16x32_bf16 v[88:91], v[116:119], v[144:147], v[88:91]
    v_mfma_f32_16x16x32_bf16 v[104:107], v[120:123], v[144:147], v[104:107]
    s_waitcnt lgkmcnt(10)
    v_mfma_f32_16x16x32_bf16 v[76:79], v[112:115], v[148:151], v[76:79]
    v_mfma_f32_16x16x32_bf16 v[92:95], v[116:119], v[148:151], v[92:95]
    v_mfma_f32_16x16x32_bf16 v[108:111], v[120:123], v[148:151], v[108:111]
    s_waitcnt lgkmcnt(7)
    v_mfma_f32_16x16x32_bf16 v[64:67], v[124:127], v[152:155], v[64:67]
    s_waitcnt lgkmcnt(5)
    v_mfma_f32_16x16x32_bf16 v[80:83], v[128:131], v[152:155], v[80:83]
    s_waitcnt lgkmcnt(3)
    v_mfma_f32_16x16x32_bf16 v[96:99], v[132:135], v[152:155], v[96:99]
    s_waitcnt lgkmcnt(2)
    v_mfma_f32_16x16x32_bf16 v[68:71], v[124:127], v[156:159], v[68:71]
    v_mfma_f32_16x16x32_bf16 v[84:87], v[128:131], v[156:159], v[84:87]
    v_mfma_f32_16x16x32_bf16 v[100:103], v[132:135], v[156:159], v[100:103]
    s_waitcnt lgkmcnt(1)
    v_mfma_f32_16x16x32_bf16 v[72:75], v[124:127], v[160:163], v[72:75]
    v_mfma_f32_16x16x32_bf16 v[88:91], v[128:131], v[160:163], v[88:91]
    v_mfma_f32_16x16x32_bf16 v[104:107], v[132:135], v[160:163], v[104:107]
    s_waitcnt lgkmcnt(0)
    v_mfma_f32_16x16x32_bf16 v[76:79], v[124:127], v[164:167], v[76:79]
    v_mfma_f32_16x16x32_bf16 v[92:95], v[128:131], v[164:167], v[92:95]
    v_mfma_f32_16x16x32_bf16 v[108:111], v[132:135], v[164:167], v[108:111]
    s_waitcnt vmcnt(0)
    v_readfirstlane_b32 s62, v244
    s_nop 1
    s_cmp_lg_u32 s62, 0
    s_cbranch_scc1 Lnok_193
    s_mov_b32 s28, s56
    s_mov_b32 s29, s57
    s_mov_b32 s30, 256
    s_mov_b32 s31, 0x00020000
    v_mov_b32 v243, 0
    s_mov_b32 s32, 0
Lnonce_194:
    buffer_load_dword v244, v243, s[28:31], 0 offen sc1
    s_waitcnt vmcnt(0)
    v_readfirstlane_b32 s62, v244
    s_add_u32 s32, s32, 1
    s_cmp_gt_u32 s32, 65536
    s_cbranch_scc1 Lnonce_o_195
    s_cmp_eq_u32 s62, 0
    s_cbranch_scc1 Lnonce_194
Lnonce_o_195:
Lnok_193:
    s_barrier
    s_lshl_b32 s19, s16, 9
    s_add_u32 s19, s19, 2048
    v_lshlrev_b32 v3, 5, v2
    v_add_u32 v3, s19, v3
    ds_read_b128 v[112:115], v3 offset:0
    ds_read_b128 v[116:119], v3 offset:16
    ds_read_b128 v[120:123], v3 offset:128
    ds_read_b128 v[124:127], v3 offset:144
    ds_read_b128 v[128:131], v3 offset:256
    ds_read_b128 v[132:135], v3 offset:272
    ds_read_b128 v[136:139], v3 offset:384
    ds_read_b128 v[140:143], v3 offset:400
    s_mul_i32 s18, s5, 393216
    s_lshl_b32 s19, s4, 2
    s_lshl_b32 s20, s16, 1
    s_add_u32 s19, s19, s20
    s_mul_i32 s19, s19, 6144
    s_add_u32 s18, s18, s19
    s_mul_i32 s19, s17, 3072
    s_add_u32 s18, s18, s19
    s_add_u32 s8, s58, 9437184
    s_addc_u32 s9, s59, 0
    s_add_u32 s8, s8, s18
    s_addc_u32 s9, s9, 0
    s_mov_b32 s10, 9216
    s_mov_b32 s11, 0x00020000
    v_lshlrev_b32 v4, 4, v0
    s_waitcnt lgkmcnt(0)
    v_fma_f32 v16, v16, v112, v113
    v_fma_f32 v17, v17, v114, v115
    v_fma_f32 v18, v18, v116, v117
    v_fma_f32 v19, v19, v118, v119
    v_cvt_pk_bf16_f32 v144, v16, v17
    v_cvt_pk_bf16_f32 v145, v18, v19
    v_fma_f32 v28, v28, v120, v121
    v_fma_f32 v29, v29, v122, v123
    v_fma_f32 v30, v30, v124, v125
    v_fma_f32 v31, v31, v126, v127
    v_cvt_pk_bf16_f32 v146, v28, v29
    v_cvt_pk_bf16_f32 v147, v30, v31
    s_nop 0
    v_permlane32_swap_b32 v144, v146
    v_permlane32_swap_b32 v145, v147
    s_nop 0
    v_permlane16_swap_b32 v144, v146
    v_permlane16_swap_b32 v145, v147
    s_mov_b32 s19, 0
    buffer_store_dwordx4 v[144:147], v4, s[8:11], s19 offen sc1
    v_fma_f32 v20, v20, v112, v113
    v_fma_f32 v21, v21, v114, v115
    v_fma_f32 v22, v22, v116, v117
    v_fma_f32 v23, v23, v118, v119
    v_cvt_pk_bf16_f32 v148, v20, v21
    v_cvt_pk_bf16_f32 v149, v22, v23
    v_fma_f32 v32, v32, v120, v121
    v_fma_f32 v33, v33, v122, v123
    v_fma_f32 v34, v34, v124, v125
    v_fma_f32 v35, v35, v126, v127
    v_cvt_pk_bf16_f32 v150, v32, v33
    v_cvt_pk_bf16_f32 v151, v34, v35
    s_nop 0
    v_permlane32_swap_b32 v148, v150
    v_permlane32_swap_b32 v149, v151
    s_nop 0
    v_permlane16_swap_b32 v148, v150
    v_permlane16_swap_b32 v149, v151
    s_mov_b32 s19, 1024
    buffer_store_dwordx4 v[148:151], v4, s[8:11], s19 offen sc1
    v_fma_f32 v24, v24, v112, v113
    v_fma_f32 v25, v25, v114, v115
    v_fma_f32 v26, v26, v116, v117
    v_fma_f32 v27, v27, v118, v119
    v_cvt_pk_bf16_f32 v152, v24, v25
    v_cvt_pk_bf16_f32 v153, v26, v27
    v_fma_f32 v36, v36, v120, v121
    v_fma_f32 v37, v37, v122, v123
    v_fma_f32 v38, v38, v124, v125
    v_fma_f32 v39, v39, v126, v127
    v_cvt_pk_bf16_f32 v154, v36, v37
    v_cvt_pk_bf16_f32 v155, v38, v39
    s_nop 0
    v_permlane32_swap_b32 v152, v154
    v_permlane32_swap_b32 v153, v155
    s_nop 0
    v_permlane16_swap_b32 v152, v154
    v_permlane16_swap_b32 v153, v155
    s_mov_b32 s19, 2048
    buffer_store_dwordx4 v[152:155], v4, s[8:11], s19 offen sc1
    v_fma_f32 v40, v40, v128, v129
    v_fma_f32 v41, v41, v130, v131
    v_fma_f32 v42, v42, v132, v133
    v_fma_f32 v43, v43, v134, v135
    v_cvt_pk_bf16_f32 v156, v40, v41
    v_cvt_pk_bf16_f32 v157, v42, v43
    v_fma_f32 v52, v52, v136, v137
    v_fma_f32 v53, v53, v138, v139
    v_fma_f32 v54, v54, v140, v141
    v_fma_f32 v55, v55, v142, v143
    v_cvt_pk_bf16_f32 v158, v52, v53
    v_cvt_pk_bf16_f32 v159, v54, v55
    s_nop 0
    v_permlane32_swap_b32 v156, v158
    v_permlane32_swap_b32 v157, v159
    s_nop 0
    v_permlane16_swap_b32 v156, v158
    v_permlane16_swap_b32 v157, v159
    s_mov_b32 s19, 6144
    buffer_store_dwordx4 v[156:159], v4, s[8:11], s19 offen sc1
    v_fma_f32 v44, v44, v128, v129
    v_fma_f32 v45, v45, v130, v131
    v_fma_f32 v46, v46, v132, v133
    v_fma_f32 v47, v47, v134, v135
    v_cvt_pk_bf16_f32 v160, v44, v45
    v_cvt_pk_bf16_f32 v161, v46, v47
    v_fma_f32 v56, v56, v136, v137
    v_fma_f32 v57, v57, v138, v139
    v_fma_f32 v58, v58, v140, v141
    v_fma_f32 v59, v59, v142, v143
    v_cvt_pk_bf16_f32 v162, v56, v57
    v_cvt_pk_bf16_f32 v163, v58, v59
    s_nop 0
    v_permlane32_swap_b32 v160, v162
    v_permlane32_swap_b32 v161, v163
    s_nop 0
    v_permlane16_swap_b32 v160, v162
    v_permlane16_swap_b32 v161, v163
    s_mov_b32 s19, 7168
    buffer_store_dwordx4 v[160:163], v4, s[8:11], s19 offen sc1
    v_fma_f32 v48, v48, v128, v129
    v_fma_f32 v49, v49, v130, v131
    v_fma_f32 v50, v50, v132, v133
    v_fma_f32 v51, v51, v134, v135
    v_cvt_pk_bf16_f32 v164, v48, v49
    v_cvt_pk_bf16_f32 v165, v50, v51
    v_fma_f32 v60, v60, v136, v137
    v_fma_f32 v61, v61, v138, v139
    v_fma_f32 v62, v62, v140, v141
    v_fma_f32 v63, v63, v142, v143
    v_cvt_pk_bf16_f32 v166, v60, v61
    v_cvt_pk_bf16_f32 v167, v62, v63
    s_nop 0
    v_permlane32_swap_b32 v164, v166
    v_permlane32_swap_b32 v165, v167
    s_nop 0
    v_permlane16_swap_b32 v164, v166
    v_permlane16_swap_b32 v165, v167
    s_mov_b32 s19, 8192
    buffer_store_dwordx4 v[164:167], v4, s[8:11], s19 offen sc1
    s_barrier
    v_pk_mul_f32 v[180:181], v[64:65], v[64:65]
    v_pk_mul_f32 v[184:185], v[66:67], v[66:67]
    v_pk_fma_f32 v[180:181], v[180:181], v[178:179], v[176:177]
    v_pk_fma_f32 v[184:185], v[184:185], v[178:179], v[176:177]
    v_pk_mul_f32 v[180:181], v[180:181], v[64:65]
    v_pk_mul_f32 v[184:185], v[184:185], v[66:67]
    v_exp_f32 v180, v180
    v_exp_f32 v181, v181
    v_exp_f32 v184, v184
    v_exp_f32 v185, v185
    v_pk_add_f32 v[180:181], v[180:181], 1.0 op_sel_hi:[1,0]
    v_pk_add_f32 v[184:185], v[184:185], 1.0 op_sel_hi:[1,0]
    v_rcp_f32 v180, v180
    v_rcp_f32 v181, v181
    v_rcp_f32 v184, v184
    v_rcp_f32 v185, v185
    v_pk_mul_f32 v[64:65], v[64:65], v[180:181]
    v_pk_mul_f32 v[66:67], v[66:67], v[184:185]
    v_pk_mul_f32 v[180:181], v[68:69], v[68:69]
    v_pk_mul_f32 v[184:185], v[70:71], v[70:71]
    v_pk_fma_f32 v[180:181], v[180:181], v[178:179], v[176:177]
    v_pk_fma_f32 v[184:185], v[184:185], v[178:179], v[176:177]
    v_pk_mul_f32 v[180:181], v[180:181], v[68:69]
    v_pk_mul_f32 v[184:185], v[184:185], v[70:71]
    v_exp_f32 v180, v180
    v_exp_f32 v181, v181
    v_exp_f32 v184, v184
    v_exp_f32 v185, v185
    v_pk_add_f32 v[180:181], v[180:181], 1.0 op_sel_hi:[1,0]
    v_pk_add_f32 v[184:185], v[184:185], 1.0 op_sel_hi:[1,0]
    v_rcp_f32 v180, v180
    v_rcp_f32 v181, v181
    v_rcp_f32 v184, v184
    v_rcp_f32 v185, v185
    v_pk_mul_f32 v[68:69], v[68:69], v[180:181]
    v_pk_mul_f32 v[70:71], v[70:71], v[184:185]
    v_pk_mul_f32 v[180:181], v[72:73], v[72:73]
    v_pk_mul_f32 v[184:185], v[74:75], v[74:75]
    v_pk_fma_f32 v[180:181], v[180:181], v[178:179], v[176:177]
    v_pk_fma_f32 v[184:185], v[184:185], v[178:179], v[176:177]
    v_pk_mul_f32 v[180:181], v[180:181], v[72:73]
    v_pk_mul_f32 v[184:185], v[184:185], v[74:75]
    v_exp_f32 v180, v180
    v_exp_f32 v181, v181
    v_exp_f32 v184, v184
    v_exp_f32 v185, v185
    v_pk_add_f32 v[180:181], v[180:181], 1.0 op_sel_hi:[1,0]
    v_pk_add_f32 v[184:185], v[184:185], 1.0 op_sel_hi:[1,0]
    v_rcp_f32 v180, v180
    v_rcp_f32 v181, v181
    v_rcp_f32 v184, v184
    v_rcp_f32 v185, v185
    v_pk_mul_f32 v[72:73], v[72:73], v[180:181]
    v_pk_mul_f32 v[74:75], v[74:75], v[184:185]
    v_pk_mul_f32 v[180:181], v[76:77], v[76:77]
    v_pk_mul_f32 v[184:185], v[78:79], v[78:79]
    v_pk_fma_f32 v[180:181], v[180:181], v[178:179], v[176:177]
    v_pk_fma_f32 v[184:185], v[184:185], v[178:179], v[176:177]
    v_pk_mul_f32 v[180:181], v[180:181], v[76:77]
    v_pk_mul_f32 v[184:185], v[184:185], v[78:79]
    v_exp_f32 v180, v180
    v_exp_f32 v181, v181
    v_exp_f32 v184, v184
    v_exp_f32 v185, v185
    v_pk_add_f32 v[180:181], v[180:181], 1.0 op_sel_hi:[1,0]
    v_pk_add_f32 v[184:185], v[184:185], 1.0 op_sel_hi:[1,0]
    v_rcp_f32 v180, v180
    v_rcp_f32 v181, v181
    v_rcp_f32 v184, v184
    v_rcp_f32 v185, v185
    v_pk_mul_f32 v[76:77], v[76:77], v[180:181]
    v_pk_mul_f32 v[78:79], v[78:79], v[184:185]
    v_pk_mul_f32 v[180:181], v[80:81], v[80:81]
    v_pk_mul_f32 v[184:185], v[82:83], v[82:83]
    v_pk_fma_f32 v[180:181], v[180:181], v[178:179], v[176:177]
    v_pk_fma_f32 v[184:185], v[184:185], v[178:179], v[176:177]
    v_pk_mul_f32 v[180:181], v[180:181], v[80:81]
    v_pk_mul_f32 v[184:185], v[184:185], v[82:83]
    v_exp_f32 v180, v180
    v_exp_f32 v181, v181
    v_exp_f32 v184, v184
    v_exp_f32 v185, v185
    v_pk_add_f32 v[180:181], v[180:181], 1.0 op_sel_hi:[1,0]
    v_pk_add_f32 v[184:185], v[184:185], 1.0 op_sel_hi:[1,0]
    v_rcp_f32 v180, v180
    v_rcp_f32 v181, v181
    v_rcp_f32 v184, v184
    v_rcp_f32 v185, v185
    v_pk_mul_f32 v[80:81], v[80:81], v[180:181]
    v_pk_mul_f32 v[82:83], v[82:83], v[184:185]
    v_pk_mul_f32 v[180:181], v[84:85], v[84:85]
    v_pk_mul_f32 v[184:185], v[86:87], v[86:87]
    v_pk_fma_f32 v[180:181], v[180:181], v[178:179], v[176:177]
    v_pk_fma_f32 v[184:185], v[184:185], v[178:179], v[176:177]
    v_pk_mul_f32 v[180:181], v[180:181], v[84:85]
    v_pk_mul_f32 v[184:185], v[184:185], v[86:87]
    v_exp_f32 v180, v180
    v_exp_f32 v181, v181
    v_exp_f32 v184, v184
    v_exp_f32 v185, v185
    v_pk_add_f32 v[180:181], v[180:181], 1.0 op_sel_hi:[1,0]
    v_pk_add_f32 v[184:185], v[184:185], 1.0 op_sel_hi:[1,0]
    v_rcp_f32 v180, v180
    v_rcp_f32 v181, v181
    v_rcp_f32 v184, v184
    v_rcp_f32 v185, v185
    v_pk_mul_f32 v[84:85], v[84:85], v[180:181]
    v_pk_mul_f32 v[86:87], v[86:87], v[184:185]
    v_pk_mul_f32 v[180:181], v[88:89], v[88:89]
    v_pk_mul_f32 v[184:185], v[90:91], v[90:91]
    v_pk_fma_f32 v[180:181], v[180:181], v[178:179], v[176:177]
    v_pk_fma_f32 v[184:185], v[184:185], v[178:179], v[176:177]
    v_pk_mul_f32 v[180:181], v[180:181], v[88:89]
    v_pk_mul_f32 v[184:185], v[184:185], v[90:91]
    v_exp_f32 v180, v180
    v_exp_f32 v181, v181
    v_exp_f32 v184, v184
    v_exp_f32 v185, v185
    v_pk_add_f32 v[180:181], v[180:181], 1.0 op_sel_hi:[1,0]
    v_pk_add_f32 v[184:185], v[184:185], 1.0 op_sel_hi:[1,0]
    v_rcp_f32 v180, v180
    v_rcp_f32 v181, v181
    v_rcp_f32 v184, v184
    v_rcp_f32 v185, v185
    v_pk_mul_f32 v[88:89], v[88:89], v[180:181]
    v_pk_mul_f32 v[90:91], v[90:91], v[184:185]
    v_pk_mul_f32 v[180:181], v[92:93], v[92:93]
    v_pk_mul_f32 v[184:185], v[94:95], v[94:95]
    v_pk_fma_f32 v[180:181], v[180:181], v[178:179], v[176:177]
    v_pk_fma_f32 v[184:185], v[184:185], v[178:179], v[176:177]
    v_pk_mul_f32 v[180:181], v[180:181], v[92:93]
    v_pk_mul_f32 v[184:185], v[184:185], v[94:95]
    v_exp_f32 v180, v180
    v_exp_f32 v181, v181
    v_exp_f32 v184, v184
    v_exp_f32 v185, v185
    v_pk_add_f32 v[180:181], v[180:181], 1.0 op_sel_hi:[1,0]
    v_pk_add_f32 v[184:185], v[184:185], 1.0 op_sel_hi:[1,0]
    v_rcp_f32 v180, v180
    v_rcp_f32 v181, v181
    v_rcp_f32 v184, v184
    v_rcp_f32 v185, v185
    v_pk_mul_f32 v[92:93], v[92:93], v[180:181]
    v_pk_mul_f32 v[94:95], v[94:95], v[184:185]
    v_pk_mul_f32 v[180:181], v[96:97], v[96:97]
    v_pk_mul_f32 v[184:185], v[98:99], v[98:99]
    v_pk_fma_f32 v[180:181], v[180:181], v[178:179], v[176:177]
    v_pk_fma_f32 v[184:185], v[184:185], v[178:179], v[176:177]
    v_pk_mul_f32 v[180:181], v[180:181], v[96:97]
    v_pk_mul_f32 v[184:185], v[184:185], v[98:99]
    v_exp_f32 v180, v180
    v_exp_f32 v181, v181
    v_exp_f32 v184, v184
    v_exp_f32 v185, v185
    v_pk_add_f32 v[180:181], v[180:181], 1.0 op_sel_hi:[1,0]
    v_pk_add_f32 v[184:185], v[184:185], 1.0 op_sel_hi:[1,0]
    v_rcp_f32 v180, v180
    v_rcp_f32 v181, v181
    v_rcp_f32 v184, v184
    v_rcp_f32 v185, v185
    v_pk_mul_f32 v[96:97], v[96:97], v[180:181]
    v_pk_mul_f32 v[98:99], v[98:99], v[184:185]
    v_pk_mul_f32 v[180:181], v[100:101], v[100:101]
    v_pk_mul_f32 v[184:185], v[102:103], v[102:103]
    v_pk_fma_f32 v[180:181], v[180:181], v[178:179], v[176:177]
    v_pk_fma_f32 v[184:185], v[184:185], v[178:179], v[176:177]
    v_pk_mul_f32 v[180:181], v[180:181], v[100:101]
    v_pk_mul_f32 v[184:185], v[184:185], v[102:103]
    v_exp_f32 v180, v180
    v_exp_f32 v181, v181
    v_exp_f32 v184, v184
    v_exp_f32 v185, v185
    v_pk_add_f32 v[180:181], v[180:181], 1.0 op_sel_hi:[1,0]
    v_pk_add_f32 v[184:185], v[184:185], 1.0 op_sel_hi:[1,0]
    v_rcp_f32 v180, v180
    v_rcp_f32 v181, v181
    v_rcp_f32 v184, v184
    v_rcp_f32 v185, v185
    v_pk_mul_f32 v[100:101], v[100:101], v[180:181]
    v_pk_mul_f32 v[102:103], v[102:103], v[184:185]
    v_pk_mul_f32 v[180:181], v[104:105], v[104:105]
    v_pk_mul_f32 v[184:185], v[106:107], v[106:107]
    v_pk_fma_f32 v[180:181], v[180:181], v[178:179], v[176:177]
    v_pk_fma_f32 v[184:185], v[184:185], v[178:179], v[176:177]
    v_pk_mul_f32 v[180:181], v[180:181], v[104:105]
    v_pk_mul_f32 v[184:185], v[184:185], v[106:107]
    v_exp_f32 v180, v180
    v_exp_f32 v181, v181
    v_exp_f32 v184, v184
    v_exp_f32 v185, v185
    v_pk_add_f32 v[180:181], v[180:181], 1.0 op_sel_hi:[1,0]
    v_pk_add_f32 v[184:185], v[184:185], 1.0 op_sel_hi:[1,0]
    v_rcp_f32 v180, v180
    v_rcp_f32 v181, v181
    v_rcp_f32 v184, v184
    v_rcp_f32 v185, v185
    v_pk_mul_f32 v[104:105], v[104:105], v[180:181]
    v_pk_mul_f32 v[106:107], v[106:107], v[184:185]
    v_pk_mul_f32 v[180:181], v[108:109], v[108:109]
    v_pk_mul_f32 v[184:185], v[110:111], v[110:111]
    v_pk_fma_f32 v[180:181], v[180:181], v[178:179], v[176:177]
    v_pk_fma_f32 v[184:185], v[184:185], v[178:179], v[176:177]
    v_pk_mul_f32 v[180:181], v[180:181], v[108:109]
    v_pk_mul_f32 v[184:185], v[184:185], v[110:111]
    v_exp_f32 v180, v180
    v_exp_f32 v181, v181
    v_exp_f32 v184, v184
    v_exp_f32 v185, v185
    v_pk_add_f32 v[180:181], v[180:181], 1.0 op_sel_hi:[1,0]
    v_pk_add_f32 v[184:185], v[184:185], 1.0 op_sel_hi:[1,0]
    v_rcp_f32 v180, v180
    v_rcp_f32 v181, v181
    v_rcp_f32 v184, v184
    v_rcp_f32 v185, v185
    v_pk_mul_f32 v[108:109], v[108:109], v[180:181]
    v_pk_mul_f32 v[110:111], v[110:111], v[184:185]
    s_lshl_b32 s18, s4, 1
    s_add_u32 s18, s18, s16
    s_lshl_b32 s18, s18, 3
    s_add_u32 s18, s18, s5
    s_lshl_b32 s18, s18, 2
    s_lshl_b32 s19, s17, 1
    s_add_u32 s18, s18, s19
    s_mul_i32 s18, s18, 3072
    s_add_u32 s8, s58, 6291456
    s_addc_u32 s9, s59, 0
    s_add_u32 s8, s8, s18
    s_addc_u32 s9, s9, 0
    s_mov_b32 s10, 6144
    s_mov_b32 s11, 0x00020000
    v_lshlrev_b32 v4, 4, v0
    v_cvt_pk_bf16_f32 v192, v64, v65
    v_cvt_pk_bf16_f32 v193, v66, v67
    v_cvt_pk_bf16_f32 v194, v68, v69
    v_cvt_pk_bf16_f32 v195, v70, v71
    s_mov_b32 s19, 0
    buffer_store_dwordx4 v[192:195], v4, s[8:11], s19 offen sc1
    v_cvt_pk_bf16_f32 v196, v80, v81
    v_cvt_pk_bf16_f32 v197, v82, v83
    v_cvt_pk_bf16_f32 v198, v84, v85
    v_cvt_pk_bf16_f32 v199, v86, v87
    s_mov_b32 s19, 1024
    buffer_store_dwordx4 v[196:199], v4, s[8:11], s19 offen sc1
    v_cvt_pk_bf16_f32 v200, v96, v97
    v_cvt_pk_bf16_f32 v201, v98, v99
    v_cvt_pk_bf16_f32 v202, v100, v101
    v_cvt_pk_bf16_f32 v203, v102, v103
    s_mov_b32 s19, 2048
    buffer_store_dwordx4 v[200:203], v4, s[8:11], s19 offen sc1
    v_cvt_pk_bf16_f32 v204, v72, v73
    v_cvt_pk_bf16_f32 v205, v74, v75
    v_cvt_pk_bf16_f32 v206, v76, v77
    v_cvt_pk_bf16_f32 v207, v78, v79
    s_mov_b32 s19, 3072
    buffer_store_dwordx4 v[204:207], v4, s[8:11], s19 offen sc1
    v_cvt_pk_bf16_f32 v208, v88, v89
    v_cvt_pk_bf16_f32 v209, v90, v91
    v_cvt_pk_bf16_f32 v210, v92, v93
    v_cvt_pk_bf16_f32 v211, v94, v95
    s_mov_b32 s19, 4096
    buffer_store_dwordx4 v[208:211], v4, s[8:11], s19 offen sc1
    v_cvt_pk_bf16_f32 v212, v104, v105
    v_cvt_pk_bf16_f32 v213, v106, v107
    v_cvt_pk_bf16_f32 v214, v108, v109
    v_cvt_pk_bf16_f32 v215, v110, v111
    s_mov_b32 s19, 5120
    buffer_store_dwordx4 v[212:215], v4, s[8:11], s19 offen sc1
    s_branch LP2_150
Lz_ld_189:
    s_mov_b32 s27, 999
    s_cmp_ge_u32 s3, 6
    s_cbranch_scc1 Lzl_x_197
    s_mov_b32 s8, s44
    s_mov_b32 s9, s45
    s_mov_b32 s10, 1966080
    s_mov_b32 s11, 0x00020000
    s_sub_u32 s16, s3, 4
    s_mul_i32 s17, s5, 192
    s_mul_i32 s18, s16, 6144
    s_mul_i32 s20, s7, 196608
    s_add_u32 s20, s20, 1536
    s_add_u32 s22, s7, 1
    s_cmp_eq_u32 s22, 10
    s_cselect_b32 s22, 0, s22
    s_mul_i32 s23, s16, 384
    s_add_u32 s21, s23, 0
    v_add_u32 v12, s21, v0
    s_mov_b32 s19, 683
    v_mul_u32_u24 v13, s19, v12
    v_lshrrev_b32 v13, 13, v13
    v_mul_u32_u24 v14, 12, v13
    v_sub_u32 v14, v12, v14
    v_lshrrev_b32 v15, 2, v13
    v_and_b32 v15, 2, v15
    v_xor_b32 v14, v14, v15
    s_movk_i32 s19, 3072
    v_mul_u32_u24 v13, s19, v13
    v_lshl_add_u32 v13, v14, 4, v13
    v_add_u32 v2, s17, v13
    s_add_u32 m0, s18, 20480
    s_nop 0
    buffer_load_dwordx4 v2, s[8:11], s20 offen lds
    s_add_u32 s21, s23, 64
    v_add_u32 v12, s21, v0
    s_mov_b32 s19, 683
    v_mul_u32_u24 v13, s19, v12
    v_lshrrev_b32 v13, 13, v13
    v_mul_u32_u24 v14, 12, v13
    v_sub_u32 v14, v12, v14
    v_lshrrev_b32 v15, 2, v13
    v_and_b32 v15, 2, v15
    v_xor_b32 v14, v14, v15
    s_movk_i32 s19, 3072
    v_mul_u32_u24 v13, s19, v13
    v_lshl_add_u32 v13, v14, 4, v13
    v_add_u32 v3, s17, v13
    s_add_u32 m0, s18, 21504
    s_nop 0
    buffer_load_dwordx4 v3, s[8:11], s20 offen lds
    s_add_u32 s21, s23, 128
    v_add_u32 v12, s21, v0
    s_mov_b32 s19, 683
    v_mul_u32_u24 v13, s19, v12
    v_lshrrev_b32 v13, 13, v13
    v_mul_u32_u24 v14, 12, v13
    v_sub_u32 v14, v12, v14
    v_lshrrev_b32 v15, 2, v13
    v_and_b32 v15, 2, v15
    v_xor_b32 v14, v14, v15
    s_movk_i32 s19, 3072
    v_mul_u32_u24 v13, s19, v13
    v_lshl_add_u32 v13, v14, 4, v13
    v_add_u32 v4, s17, v13
    s_add_u32 m0, s18, 22528
    s_nop 0
    buffer_load_dwordx4 v4, s[8:11], s20 offen lds
    s_add_u32 s21, s23, 192
    v_add_u32 v12, s21, v0
    s_mov_b32 s19, 683
    v_mul_u32_u24 v13, s19, v12
    v_lshrrev_b32 v13, 13, v13
    v_mul_u32_u24 v14, 12, v13
    v_sub_u32 v14, v12, v14
    v_lshrrev_b32 v15, 2, v13
    v_and_b32 v15, 2, v15
    v_xor_b32 v14, v14, v15
    s_movk_i32 s19, 3072
    v_mul_u32_u24 v13, s19, v13
    v_lshl_add_u32 v13, v14, 4, v13
    v_add_u32 v5, s17, v13
    s_add_u32 m0, s18, 23552
    s_nop 0
    buffer_load_dwordx4 v5, s[8:11], s20 offen lds
    s_add_u32 s21, s23, 256
    v_add_u32 v12, s21, v0
    s_mov_b32 s19, 683
    v_mul_u32_u24 v13, s19, v12
    v_lshrrev_b32 v13, 13, v13
    v_mul_u32_u24 v14, 12, v13
    v_sub_u32 v14, v12, v14
    v_lshrrev_b32 v15, 2, v13
    v_and_b32 v15, 2, v15
    v_xor_b32 v14, v14, v15
    s_movk_i32 s19, 3072
    v_mul_u32_u24 v13, s19, v13
    v_lshl_add_u32 v13, v14, 4, v13
    v_add_u32 v6, s17, v13
    s_add_u32 m0, s18, 24576
    s_nop 0
    buffer_load_dwordx4 v6, s[8:11], s20 offen lds
    s_add_u32 s21, s23, 320
    v_add_u32 v12, s21, v0
    s_mov_b32 s19, 683
    v_mul_u32_u24 v13, s19, v12
    v_lshrrev_b32 v13, 13, v13
    v_mul_u32_u24 v14, 12, v13
    v_sub_u32 v14, v12, v14
    v_lshrrev_b32 v15, 2, v13
    v_and_b32 v15, 2, v15
    v_xor_b32 v14, v14, v15
    s_movk_i32 s19, 3072
    v_mul_u32_u24 v13, s19, v13
    v_lshl_add_u32 v13, v14, 4, v13
    v_add_u32 v7, s17, v13
    s_add_u32 m0, s18, 25600
    s_nop 0
    buffer_load_dwordx4 v7, s[8:11], s20 offen lds
    s_mul_i32 s20, s22, 196608
    s_add_u32 s20, s20, 1536
    s_add_u32 s22, s22, 1
    s_cmp_eq_u32 s22, 10
    s_cselect_b32 s22, 0, s22
    s_add_u32 m0, s18, 49152
    s_nop 0
    buffer_load_dwordx4 v2, s[8:11], s20 offen lds
    s_add_u32 m0, s18, 50176
    s_nop 0
    buffer_load_dwordx4 v3, s[8:11], s20 offen lds
    s_add_u32 m0, s18, 51200
    s_nop 0
    buffer_load_dwordx4 v4, s[8:11], s20 offen lds
    s_add_u32 m0, s18, 52224
    s_nop 0
    buffer_load_dwordx4 v5, s[8:11], s20 offen lds
    s_add_u32 m0, s18, 53248
    s_nop 0
    buffer_load_dwordx4 v6, s[8:11], s20 offen lds
    s_add_u32 m0, s18, 54272
    s_nop 0
    buffer_load_dwordx4 v7, s[8:11], s20 offen lds
    s_sub_u32 s27, s3, 4
    s_lshl_b32 s27, s27, 8
    s_add_u32 s27, s27, s2
    s_cmp_ge_u32 s27, 352
    s_cbranch_scc1 Lpk_199
    s_and_b32 s32, s27, 7
    s_lshr_b32 s33, s27, 3
    s_cmp_lt_u32 s33, 20
    s_cselect_b32 s28, s40, s50
    s_cselect_b32 s29, s41, s51
    s_cselect_b32 s34, 0, 20
    s_mov_b32 s30, 983040
    s_cselect_b32 s30, 819200, s30
    s_mov_b32 s31, 0x00020000
    s_sub_u32 s34, s33, s34
    s_mul_i32 s34, s34, 40960
    s_mul_i32 s35, s32, 160
    s_and_b32 s32, s32, 1
    s_lshl_b32 s32, s32, 5
    s_sub_u32 s35, s35, s32
    s_add_u32 s34, s34, s35
    s_sub_u32 s35, s3, 4
    s_mul_i32 s35, s35, 6144
    s_add_u32 s35, s35, 149504
    v_add_u32 v17, 0, v0
    s_mov_b32 s32, 171
    v_mul_u32_u24 v18, s32, v17
    v_lshrrev_b32 v18, 11, v18
    v_mul_u32_u24 v19, 12, v18
    v_sub_u32 v19, v17, v19
    s_movk_i32 s32, 1280
    v_mul_u32_u24 v18, s32, v18
    v_lshl_add_u32 v18, v19, 4, v18
    s_add_u32 m0, s35, 0
    s_nop 0
    buffer_load_dwordx4 v18, s[28:31], s34 offen lds
    v_add_u32 v17, 64, v0
    s_mov_b32 s32, 171
    v_mul_u32_u24 v18, s32, v17
    v_lshrrev_b32 v18, 11, v18
    v_mul_u32_u24 v19, 12, v18
    v_sub_u32 v19, v17, v19
    s_movk_i32 s32, 1280
    v_mul_u32_u24 v18, s32, v18
    v_lshl_add_u32 v18, v19, 4, v18
    s_add_u32 m0, s35, 1024
    s_nop 0
    buffer_load_dwordx4 v18, s[28:31], s34 offen lds
    v_add_u32 v17, 128, v0
    s_mov_b32 s32, 171
    v_mul_u32_u24 v18, s32, v17
    v_lshrrev_b32 v18, 11, v18
    v_mul_u32_u24 v19, 12, v18
    v_sub_u32 v19, v17, v19
    s_movk_i32 s32, 1280
    v_mul_u32_u24 v18, s32, v18
    v_lshl_add_u32 v18, v19, 4, v18
    s_add_u32 m0, s35, 2048
    s_nop 0
    buffer_load_dwordx4 v18, s[28:31], s34 offen lds
    v_add_u32 v17, 192, v0
    s_mov_b32 s32, 171
    v_mul_u32_u24 v18, s32, v17
    v_lshrrev_b32 v18, 11, v18
    v_mul_u32_u24 v19, 12, v18
    v_sub_u32 v19, v17, v19
    s_movk_i32 s32, 1280
    v_mul_u32_u24 v18, s32, v18
    v_lshl_add_u32 v18, v19, 4, v18
    s_add_u32 m0, s35, 3072
    s_nop 0
    buffer_load_dwordx4 v18, s[28:31], s34 offen lds
    v_add_u32 v17, 256, v0
    s_mov_b32 s32, 171
    v_mul_u32_u24 v18, s32, v17
    v_lshrrev_b32 v18, 11, v18
    v_mul_u32_u24 v19, 12, v18
    v_sub_u32 v19, v17, v19
    s_movk_i32 s32, 1280
    v_mul_u32_u24 v18, s32, v18
    v_lshl_add_u32 v18, v19, 4, v18
    s_add_u32 m0, s35, 4096
    s_nop 0
    buffer_load_dwordx4 v18, s[28:31], s34 offen lds
    v_add_u32 v17, 320, v0
    s_mov_b32 s32, 171
    v_mul_u32_u24 v18, s32, v17
    v_lshrrev_b32 v18, 11, v18
    v_mul_u32_u24 v19, 12, v18
    v_sub_u32 v19, v17, v19
    s_movk_i32 s32, 1280
    v_mul_u32_u24 v18, s32, v18
    v_lshl_add_u32 v18, v19, 4, v18
    s_add_u32 m0, s35, 5120
    s_nop 0
    buffer_load_dwordx4 v18, s[28:31], s34 offen lds
Lpk_199:
    s_waitcnt vmcnt(6)
    s_barrier
    s_mul_i32 s20, s22, 196608
    s_add_u32 s20, s20, 1536
    s_add_u32 s22, s22, 1
    s_cmp_eq_u32 s22, 10
    s_cselect_b32 s22, 0, s22
    s_add_u32 m0, s18, 77824
    s_nop 0
    buffer_load_dwordx4 v2, s[8:11], s20 offen lds
    s_add_u32 m0, s18, 78848
    s_nop 0
    buffer_load_dwordx4 v3, s[8:11], s20 offen lds
    s_add_u32 m0, s18, 79872
    s_nop 0
    buffer_load_dwordx4 v4, s[8:11], s20 offen lds
    s_add_u32 m0, s18, 80896
    s_nop 0
    buffer_load_dwordx4 v5, s[8:11], s20 offen lds
    s_add_u32 m0, s18, 81920
    s_nop 0
    buffer_load_dwordx4 v6, s[8:11], s20 offen lds
    s_add_u32 m0, s18, 82944
    s_nop 0
    buffer_load_dwordx4 v7, s[8:11], s20 offen lds
    s_waitcnt vmcnt(6)
    s_barrier
    s_mul_i32 s20, s22, 196608
    s_add_u32 s20, s20, 1536
    s_add_u32 s22, s22, 1
    s_cmp_eq_u32 s22, 10
    s_cselect_b32 s22, 0, s22
    s_add_u32 m0, s18, 20480
    s_nop 0
    buffer_load_dwordx4 v2, s[8:11], s20 offen lds
    s_add_u32 m0, s18, 21504
    s_nop 0
    buffer_load_dwordx4 v3, s[8:11], s20 offen lds
    s_add_u32 m0, s18, 22528
    s_nop 0
    buffer_load_dwordx4 v4, s[8:11], s20 offen lds
    s_add_u32 m0, s18, 23552
    s_nop 0
    buffer_load_dwordx4 v5, s[8:11], s20 offen lds
    s_add_u32 m0, s18, 24576
    s_nop 0
    buffer_load_dwordx4 v6, s[8:11], s20 offen lds
    s_add_u32 m0, s18, 25600
    s_nop 0
    buffer_load_dwordx4 v7, s[8:11], s20 offen lds
    s_waitcnt vmcnt(6)
    s_barrier
    s_mul_i32 s20, s22, 196608
    s_add_u32 s20, s20, 1536
    s_add_u32 s22, s22, 1
    s_cmp_eq_u32 s22, 10
    s_cselect_b32 s22, 0, s22
    s_add_u32 m0, s18, 49152
    s_nop 0
    buffer_load_dwordx4 v2, s[8:11], s20 offen lds
    s_add_u32 m0, s18, 50176
    s_nop 0
    buffer_load_dwordx4 v3, s[8:11], s20 offen lds
    s_add_u32 m0, s18, 51200
    s_nop 0
    buffer_load_dwordx4 v4, s[8:11], s20 offen lds
    s_add_u32 m0, s18, 52224
    s_nop 0
    buffer_load_dwordx4 v5, s[8:11], s20 offen lds
    s_add_u32 m0, s18, 53248
    s_nop 0
    buffer_load_dwordx4 v6, s[8:11], s20 offen lds
    s_add_u32 m0, s18, 54272
    s_nop 0
    buffer_load_dwordx4 v7, s[8:11], s20 offen lds
    s_waitcnt vmcnt(6)
    s_barrier
    s_mul_i32 s20, s22, 196608
    s_add_u32 s20, s20, 1536
    s_add_u32 s22, s22, 1
    s_cmp_eq_u32 s22, 10
    s_cselect_b32 s22, 0, s22
    s_add_u32 m0, s18, 77824
    s_nop 0
    buffer_load_dwordx4 v2, s[8:11], s20 offen lds
    s_add_u32 m0, s18, 78848
    s_nop 0
    buffer_load_dwordx4 v3, s[8:11], s20 offen lds
    s_add_u32 m0, s18, 79872
    s_nop 0
    buffer_load_dwordx4 v4, s[8:11], s20 offen lds
    s_add_u32 m0, s18, 80896
    s_nop 0
    buffer_load_dwordx4 v5, s[8:11], s20 offen lds
    s_add_u32 m0, s18, 81920
    s_nop 0
    buffer_load_dwordx4 v6, s[8:11], s20 offen lds
    s_add_u32 m0, s18, 82944
    s_nop 0
    buffer_load_dwordx4 v7, s[8:11], s20 offen lds
    s_waitcnt vmcnt(6)
    s_barrier
    s_mul_i32 s20, s22, 196608
    s_add_u32 s20, s20, 1536
    s_add_u32 s22, s22, 1
    s_cmp_eq_u32 s22, 10
    s_cselect_b32 s22, 0, s22
    s_add_u32 m0, s18, 20480
    s_nop 0
    buffer_load_dwordx4 v2, s[8:11], s20 offen lds
    s_add_u32 m0, s18, 21504
    s_nop 0
    buffer_load_dwordx4 v3, s[8:11], s20 offen lds
    s_add_u32 m0, s18, 22528
    s_nop 0
    buffer_load_dwordx4 v4, s[8:11], s20 offen lds
    s_add_u32 m0, s18, 23552
    s_nop 0
    buffer_load_dwordx4 v5, s[8:11], s20 offen lds
    s_add_u32 m0, s18, 24576
    s_nop 0
    buffer_load_dwordx4 v6, s[8:11], s20 offen lds
    s_add_u32 m0, s18, 25600
    s_nop 0
    buffer_load_dwordx4 v7, s[8:11], s20 offen lds
    s_mov_b32 s28, s56
    s_mov_b32 s29, s57
    s_mov_b32 s30, 256
    s_mov_b32 s31, 0x00020000
    v_mov_b32 v14, 0
    buffer_load_dword v15, v14, s[28:31], 0 offen sc1
    s_waitcnt vmcnt(7)
    s_barrier
    s_mul_i32 s20, s22, 196608
    s_add_u32 s20, s20, 1536
    s_add_u32 s22, s22, 1
    s_cmp_eq_u32 s22, 10
    s_cselect_b32 s22, 0, s22
    s_add_u32 m0, s18, 49152
    s_nop 0
    buffer_load_dwordx4 v2, s[8:11], s20 offen lds
    s_add_u32 m0, s18, 50176
    s_nop 0
    buffer_load_dwordx4 v3, s[8:11], s20 offen lds
    s_add_u32 m0, s18, 51200
    s_nop 0
    buffer_load_dwordx4 v4, s[8:11], s20 offen lds
    s_add_u32 m0, s18, 52224
    s_nop 0
    buffer_load_dwordx4 v5, s[8:11], s20 offen lds
    s_add_u32 m0, s18, 53248
    s_nop 0
    buffer_load_dwordx4 v6, s[8:11], s20 offen lds
    s_add_u32 m0, s18, 54272
    s_nop 0
    buffer_load_dwordx4 v7, s[8:11], s20 offen lds
    s_waitcnt vmcnt(7)
    s_barrier
    s_mul_i32 s20, s22, 196608
    s_add_u32 s20, s20, 1536
    s_add_u32 s22, s22, 1
    s_cmp_eq_u32 s22, 10
    s_cselect_b32 s22, 0, s22
    s_add_u32 m0, s18, 77824
    s_nop 0
    buffer_load_dwordx4 v2, s[8:11], s20 offen lds
    s_add_u32 m0, s18, 78848
    s_nop 0
    buffer_load_dwordx4 v3, s[8:11], s20 offen lds
    s_add_u32 m0, s18, 79872
    s_nop 0
    buffer_load_dwordx4 v4, s[8:11], s20 offen lds
    s_add_u32 m0, s18, 80896
    s_nop 0
    buffer_load_dwordx4 v5, s[8:11], s20 offen lds
    s_add_u32 m0, s18, 81920
    s_nop 0
    buffer_load_dwordx4 v6, s[8:11], s20 offen lds
    s_add_u32 m0, s18, 82944
    s_nop 0
    buffer_load_dwordx4 v7, s[8:11], s20 offen lds
    s_waitcnt vmcnt(6)
    s_barrier
    s_mul_i32 s20, s22, 196608
    s_add_u32 s20, s20, 1536
    s_add_u32 s22, s22, 1
    s_cmp_eq_u32 s22, 10
    s_cselect_b32 s22, 0, s22
    s_add_u32 m0, s18, 20480
    s_nop 0
    buffer_load_dwordx4 v2, s[8:11], s20 offen lds
    s_add_u32 m0, s18, 21504
    s_nop 0
    buffer_load_dwordx4 v3, s[8:11], s20 offen lds
    s_add_u32 m0, s18, 22528
    s_nop 0
    buffer_load_dwordx4 v4, s[8:11], s20 offen lds
    s_add_u32 m0, s18, 23552
    s_nop 0
    buffer_load_dwordx4 v5, s[8:11], s20 offen lds
    s_add_u32 m0, s18, 24576
    s_nop 0
    buffer_load_dwordx4 v6, s[8:11], s20 offen lds
    s_add_u32 m0, s18, 25600
    s_nop 0
    buffer_load_dwordx4 v7, s[8:11], s20 offen lds
    s_waitcnt vmcnt(6)
    s_barrier
    s_mul_i32 s20, s22, 196608
    s_add_u32 s20, s20, 0
    s_add_u32 s22, s22, 1
    s_cmp_eq_u32 s22, 10
    s_cselect_b32 s22, 0, s22
    s_add_u32 m0, s18, 49152
    s_nop 0
    buffer_load_dwordx4 v2, s[8:11], s20 offen lds
    s_add_u32 m0, s18, 50176
    s_nop 0
    buffer_load_dwordx4 v3, s[8:11], s20 offen lds
    s_add_u32 m0, s18, 51200
    s_nop 0
    buffer_load_dwordx4 v4, s[8:11], s20 offen lds
    s_add_u32 m0, s18, 52224
    s_nop 0
    buffer_load_dwordx4 v5, s[8:11], s20 offen lds
    s_add_u32 m0, s18, 53248
    s_nop 0
    buffer_load_dwordx4 v6, s[8:11], s20 offen lds
    s_add_u32 m0, s18, 54272
    s_nop 0
    buffer_load_dwordx4 v7, s[8:11], s20 offen lds
    s_waitcnt vmcnt(6)
    s_barrier
    s_mul_i32 s20, s22, 196608
    s_add_u32 s20, s20, 0
    s_add_u32 s22, s22, 1
    s_cmp_eq_u32 s22, 10
    s_cselect_b32 s22, 0, s22
    s_add_u32 m0, s18, 77824
    s_nop 0
    buffer_load_dwordx4 v2, s[8:11], s20 offen lds
    s_add_u32 m0, s18, 78848
    s_nop 0
    buffer_load_dwordx4 v3, s[8:11], s20 offen lds
    s_add_u32 m0, s18, 79872
    s_nop 0
    buffer_load_dwordx4 v4, s[8:11], s20 offen lds
    s_add_u32 m0, s18, 80896
    s_nop 0
    buffer_load_dwordx4 v5, s[8:11], s20 offen lds
    s_add_u32 m0, s18, 81920
    s_nop 0
    buffer_load_dwordx4 v6, s[8:11], s20 offen lds
    s_add_u32 m0, s18, 82944
    s_nop 0
    buffer_load_dwordx4 v7, s[8:11], s20 offen lds
    s_barrier
    s_waitcnt vmcnt(12)
    v_readfirstlane_b32 s62, v15
    s_nop 1
    s_cmp_lg_u32 s62, 0
    s_cbranch_scc1 Lnok_200
    s_mov_b32 s28, s56
    s_mov_b32 s29, s57
    s_mov_b32 s30, 256
    s_mov_b32 s31, 0x00020000
    v_mov_b32 v14, 0
    s_mov_b32 s32, 0
Lnonce_201:
    buffer_load_dword v15, v14, s[28:31], 0 offen sc1
    s_waitcnt vmcnt(0)
    v_readfirstlane_b32 s62, v15
    s_add_u32 s32, s32, 1
    s_cmp_gt_u32 s32, 65536
    s_cbranch_scc1 Lnonce_o_202
    s_cmp_eq_u32 s62, 0
    s_cbranch_scc1 Lnonce_201
Lnonce_o_202:
Lnok_200:
    s_sub_u32 s21, s3, 4
    s_lshl_b32 s21, s21, 9
    v_lshlrev_b32 v20, 3, v0
    v_add_u32 v20, s21, v20
    v_add_u32 v88, 0, v20
    ds_read_b64 v[22:23], v88
    ds_read_b64 v[24:25], v88 offset:1024
    s_waitcnt lgkmcnt(0)
    v_add_f32 v28, v22, v24
    v_add_f32 v30, v23, v25
    v_mov_b32 v29, s62
    v_mov_b32 v31, s62
    s_lshl_b32 s21, s4, 14
    s_add_u32 s92, s58, 12582912
    s_addc_u32 s93, s59, 0
    s_add_u32 s92, s92, s21
    s_addc_u32 s93, s93, 0
    s_mov_b32 s94, 16384
    s_mov_b32 s95, 0x00020000
    v_lshlrev_b32 v89, 1, v20
    s_lshl_b32 s21, s5, 11
    buffer_store_dwordx4 v[28:31], v89, s[92:95], s21 offen sc1
    s_cmp_ge_u32 s27, 352
    s_cbranch_scc1 Lpf_203
    s_and_b32 s32, s27, 7
    s_lshr_b32 s33, s27, 3
    v_and_b32 v17, 15, v0
    v_lshrrev_b32 v18, 4, v0
    v_lshrrev_b32 v19, 2, v17
    v_and_b32 v20, 3, v17
    s_cmp_lt_u32 s33, 20
    s_cselect_b32 s34, 3, 2
    s_cselect_b32 s35, 4, 16
    v_lshlrev_b32 v18, s34, v18
    v_add_u32 v18, v18, v19
    v_mul_u32_u24 v18, 192, v18
    v_lshl_add_u32 v18, v20, 3, v18
    s_and_b32 s32, s27, 1
    s_lshl_b32 s32, s32, 5
    s_sub_u32 s34, s3, 4
    s_mul_i32 s34, s34, 6144
    s_add_u32 s34, s34, 149504
    s_add_u32 s34, s34, s32
    v_add_u32 v18, s34, v18
    s_mul_i32 s35, s35, 192
    v_add_u32 v19, s35, v18
    ds_read_b64_tr_b16 v[24:25], v18 offset:0
    ds_read_b64_tr_b16 v[26:27], v19 offset:0
    ds_read_b64_tr_b16 v[28:29], v18 offset:32
    ds_read_b64_tr_b16 v[30:31], v19 offset:32
    ds_read_b64_tr_b16 v[32:33], v18 offset:64
    ds_read_b64_tr_b16 v[34:35], v19 offset:64
    ds_read_b64_tr_b16 v[36:37], v18 offset:96
    ds_read_b64_tr_b16 v[38:39], v19 offset:96
    ds_read_b64_tr_b16 v[40:41], v18 offset:128
    ds_read_b64_tr_b16 v[42:43], v19 offset:128
    s_and_b32 s32, s27, 7
    s_mul_i32 s32, s32, 44
    s_add_u32 s32, s32, s33
    s_mul_i32 s32, s32, 5120
    s_add_u32 s28, s58, 13631488
    s_addc_u32 s29, s59, 0
    s_mov_b32 s30, 1802240
    s_mov_b32 s31, 0x00020000
    v_lshlrev_b32 v20, 4, v0
    s_waitcnt lgkmcnt(0)
    s_add_u32 s33, s32, 0
    buffer_store_dwordx4 v[24:27], v20, s[28:31], s33 offen sc1
    s_add_u32 s33, s32, 1024
    buffer_store_dwordx4 v[28:31], v20, s[28:31], s33 offen sc1
    s_add_u32 s33, s32, 2048
    buffer_store_dwordx4 v[32:35], v20, s[28:31], s33 offen sc1
    s_add_u32 s33, s32, 3072
    buffer_store_dwordx4 v[36:39], v20, s[28:31], s33 offen sc1
    s_add_u32 s33, s32, 4096
    buffer_store_dwordx4 v[40:43], v20, s[28:31], s33 offen sc1
Lpf_203:
    s_waitcnt vmcnt(7)
    s_barrier
    s_mul_i32 s20, s22, 196608
    s_add_u32 s20, s20, 0
    s_add_u32 s22, s22, 1
    s_cmp_eq_u32 s22, 10
    s_cselect_b32 s22, 0, s22
    s_add_u32 m0, s18, 20480
    s_nop 0
    buffer_load_dwordx4 v2, s[8:11], s20 offen lds
    s_add_u32 m0, s18, 21504
    s_nop 0
    buffer_load_dwordx4 v3, s[8:11], s20 offen lds
    s_add_u32 m0, s18, 22528
    s_nop 0
    buffer_load_dwordx4 v4, s[8:11], s20 offen lds
    s_add_u32 m0, s18, 23552
    s_nop 0
    buffer_load_dwordx4 v5, s[8:11], s20 offen lds
    s_add_u32 m0, s18, 24576
    s_nop 0
    buffer_load_dwordx4 v6, s[8:11], s20 offen lds
    s_add_u32 m0, s18, 25600
    s_nop 0
    buffer_load_dwordx4 v7, s[8:11], s20 offen lds
    s_waitcnt vmcnt(7)
    s_barrier
    s_mul_i32 s20, s22, 196608
    s_add_u32 s20, s20, 0
    s_add_u32 s22, s22, 1
    s_cmp_eq_u32 s22, 10
    s_cselect_b32 s22, 0, s22
    s_add_u32 m0, s18, 49152
    s_nop 0
    buffer_load_dwordx4 v2, s[8:11], s20 offen lds
    s_add_u32 m0, s18, 50176
    s_nop 0
    buffer_load_dwordx4 v3, s[8:11], s20 offen lds
    s_add_u32 m0, s18, 51200
    s_nop 0
    buffer_load_dwordx4 v4, s[8:11], s20 offen lds
    s_add_u32 m0, s18, 52224
    s_nop 0
    buffer_load_dwordx4 v5, s[8:11], s20 offen lds
    s_add_u32 m0, s18, 53248
    s_nop 0
    buffer_load_dwordx4 v6, s[8:11], s20 offen lds
    s_add_u32 m0, s18, 54272
    s_nop 0
    buffer_load_dwordx4 v7, s[8:11], s20 offen lds
    s_waitcnt vmcnt(6)
    s_barrier
    s_mul_i32 s20, s22, 196608
    s_add_u32 s20, s20, 0
    s_add_u32 s22, s22, 1
    s_cmp_eq_u32 s22, 10
    s_cselect_b32 s22, 0, s22
    s_add_u32 m0, s18, 77824
    s_nop 0
    buffer_load_dwordx4 v2, s[8:11], s20 offen lds
    s_add_u32 m0, s18, 78848
    s_nop 0
    buffer_load_dwordx4 v3, s[8:11], s20 offen lds
    s_add_u32 m0, s18, 79872
    s_nop 0
    buffer_load_dwordx4 v4, s[8:11], s20 offen lds
    s_add_u32 m0, s18, 80896
    s_nop 0
    buffer_load_dwordx4 v5, s[8:11], s20 offen lds
    s_add_u32 m0, s18, 81920
    s_nop 0
    buffer_load_dwordx4 v6, s[8:11], s20 offen lds
    s_add_u32 m0, s18, 82944
    s_nop 0
    buffer_load_dwordx4 v7, s[8:11], s20 offen lds
    s_cmp_lg_u32 s3, 4
    s_cbranch_scc1 Lonly_204
    s_lshl_b32 s24, s61, 7
    s_add_u32 s24, s24, 0
    s_add_u32 s28, s58, 13107200
    s_addc_u32 s29, s59, 0
    s_mov_b32 s30, 16384
    s_mov_b32 s31, 0x00020000
    v_min_u32 v12, 15, v0
    v_lshlrev_b32 v12, 2, v12
    buffer_load_dword v16, v12, s[28:31], s24 offen sc1
Lonly_204:
    s_waitcnt vmcnt(6)
    s_barrier
    s_mul_i32 s20, s22, 196608
    s_add_u32 s20, s20, 0
    s_add_u32 s22, s22, 1
    s_cmp_eq_u32 s22, 10
    s_cselect_b32 s22, 0, s22
    s_add_u32 m0, s18, 20480
    s_nop 0
    buffer_load_dwordx4 v2, s[8:11], s20 offen lds
    s_add_u32 m0, s18, 21504
    s_nop 0
    buffer_load_dwordx4 v3, s[8:11], s20 offen lds
    s_add_u32 m0, s18, 22528
    s_nop 0
    buffer_load_dwordx4 v4, s[8:11], s20 offen lds
    s_add_u32 m0, s18, 23552
    s_nop 0
    buffer_load_dwordx4 v5, s[8:11], s20 offen lds
    s_add_u32 m0, s18, 24576
    s_nop 0
    buffer_load_dwordx4 v6, s[8:11], s20 offen lds
    s_add_u32 m0, s18, 25600
    s_nop 0
    buffer_load_dwordx4 v7, s[8:11], s20 offen lds
    s_lshl_b32 s24, s60, 18
    s_mov_b32 s40, s46
    s_mov_b32 s41, s47
    s_add_u32 s40, s40, s24
    s_addc_u32 s41, s41, 0
    s_mov_b32 s42, 262144
    s_mov_b32 s43, 0x00020000
    v_lshrrev_b32 v90, 5, v0
    s_sub_u32 s24, s3, 4
    s_lshl_b32 s24, s24, 2
    v_add_u32 v90, s24, v90
    v_and_b32 v91, 31, v0
    v_xor_b32 v92, v91, v90
    v_lshlrev_b32 v92, 4, v92
    v_lshl_add_u32 v92, v90, 12, v92
    v_add_u32 v90, 2, v90
    v_xor_b32 v93, v91, v90
    v_lshlrev_b32 v93, 4, v93
    v_lshl_add_u32 v93, v90, 12, v93
    s_sub_u32 s25, s3, 4
    s_lshl_b32 s25, s25, 11
    s_add_u32 s26, s100, 0
    s_and_b32 s26, s26, 3
    s_lshl_b32 s26, s26, 9
    s_add_u32 m0, s25, 98304
    s_add_u32 s24, s26, 0
    buffer_load_dwordx4 v92, s[40:43], s24 offen lds
    s_add_u32 m0, s25, 99328
    s_add_u32 s24, s26, 0
    buffer_load_dwordx4 v93, s[40:43], s24 offen lds
    s_add_u32 m0, s25, 106496
    s_add_u32 s24, s26, 65536
    buffer_load_dwordx4 v92, s[40:43], s24 offen lds
    s_add_u32 m0, s25, 107520
    s_add_u32 s24, s26, 65536
    buffer_load_dwordx4 v93, s[40:43], s24 offen lds
    s_add_u32 m0, s25, 114688
    s_add_u32 s24, s26, 131072
    buffer_load_dwordx4 v92, s[40:43], s24 offen lds
    s_add_u32 m0, s25, 115712
    s_add_u32 s24, s26, 131072
    buffer_load_dwordx4 v93, s[40:43], s24 offen lds
    s_add_u32 m0, s25, 122880
    s_add_u32 s24, s26, 196608
    buffer_load_dwordx4 v92, s[40:43], s24 offen lds
    s_add_u32 m0, s25, 123904
    s_add_u32 s24, s26, 196608
    buffer_load_dwordx4 v93, s[40:43], s24 offen lds
    s_add_u32 s26, s100, 0
    s_and_b32 s26, s26, 3
    s_lshl_b32 s26, s26, 9
    s_add_u32 s26, s26, 2048
    s_add_u32 m0, s25, 131072
    s_add_u32 s24, s26, 0
    buffer_load_dwordx4 v92, s[40:43], s24 offen lds
    s_add_u32 m0, s25, 132096
    s_add_u32 s24, s26, 0
    buffer_load_dwordx4 v93, s[40:43], s24 offen lds
    s_add_u32 m0, s25, 139264
    s_add_u32 s24, s26, 65536
    buffer_load_dwordx4 v92, s[40:43], s24 offen lds
    s_add_u32 m0, s25, 140288
    s_add_u32 s24, s26, 65536
    buffer_load_dwordx4 v93, s[40:43], s24 offen lds
    s_add_u32 m0, s25, 147456
    s_add_u32 s24, s26, 131072
    buffer_load_dwordx4 v92, s[40:43], s24 offen lds
    s_add_u32 m0, s25, 148480
    s_add_u32 s24, s26, 131072
    buffer_load_dwordx4 v93, s[40:43], s24 offen lds
    s_add_u32 m0, s25, 155648
    s_add_u32 s24, s26, 196608
    buffer_load_dwordx4 v92, s[40:43], s24 offen lds
    s_add_u32 m0, s25, 156672
    s_add_u32 s24, s26, 196608
    buffer_load_dwordx4 v93, s[40:43], s24 offen lds
    s_waitcnt vmcnt(22)
    s_barrier
    s_mul_i32 s20, s22, 196608
    s_add_u32 s20, s20, 0
    s_add_u32 s22, s22, 1
    s_cmp_eq_u32 s22, 10
    s_cselect_b32 s22, 0, s22
    s_add_u32 m0, s18, 49152
    s_nop 0
    buffer_load_dwordx4 v2, s[8:11], s20 offen lds
    s_add_u32 m0, s18, 50176
    s_nop 0
    buffer_load_dwordx4 v3, s[8:11], s20 offen lds
    s_add_u32 m0, s18, 51200
    s_nop 0
    buffer_load_dwordx4 v4, s[8:11], s20 offen lds
    s_add_u32 m0, s18, 52224
    s_nop 0
    buffer_load_dwordx4 v5, s[8:11], s20 offen lds
    s_add_u32 m0, s18, 53248
    s_nop 0
    buffer_load_dwordx4 v6, s[8:11], s20 offen lds
    s_add_u32 m0, s18, 54272
    s_nop 0
    buffer_load_dwordx4 v7, s[8:11], s20 offen lds
    s_waitcnt vmcnt(22)
    s_barrier
    s_mul_i32 s20, s22, 196608
    s_add_u32 s20, s20, 0
    s_add_u32 s22, s22, 1
    s_cmp_eq_u32 s22, 10
    s_cselect_b32 s22, 0, s22
    s_add_u32 m0, s18, 77824
    s_nop 0
    buffer_load_dwordx4 v2, s[8:11], s20 offen lds
    s_add_u32 m0, s18, 78848
    s_nop 0
    buffer_load_dwordx4 v3, s[8:11], s20 offen lds
    s_add_u32 m0, s18, 79872
    s_nop 0
    buffer_load_dwordx4 v4, s[8:11], s20 offen lds
    s_add_u32 m0, s18, 80896
    s_nop 0
    buffer_load_dwordx4 v5, s[8:11], s20 offen lds
    s_add_u32 m0, s18, 81920
    s_nop 0
    buffer_load_dwordx4 v6, s[8:11], s20 offen lds
    s_add_u32 m0, s18, 82944
    s_nop 0
    buffer_load_dwordx4 v7, s[8:11], s20 offen lds
    s_waitcnt vmcnt(6)
    s_barrier
    s_mul_i32 s20, s22, 196608
    s_add_u32 s20, s20, 0
    s_add_u32 s22, s22, 1
    s_cmp_eq_u32 s22, 10
    s_cselect_b32 s22, 0, s22
    s_add_u32 m0, s18, 20480
    s_nop 0
    buffer_load_dwordx4 v2, s[8:11], s20 offen lds
    s_add_u32 m0, s18, 21504
    s_nop 0
    buffer_load_dwordx4 v3, s[8:11], s20 offen lds
    s_add_u32 m0, s18, 22528
    s_nop 0
    buffer_load_dwordx4 v4, s[8:11], s20 offen lds
    s_add_u32 m0, s18, 23552
    s_nop 0
    buffer_load_dwordx4 v5, s[8:11], s20 offen lds
    s_add_u32 m0, s18, 24576
    s_nop 0
    buffer_load_dwordx4 v6, s[8:11], s20 offen lds
    s_add_u32 m0, s18, 25600
    s_nop 0
    buffer_load_dwordx4 v7, s[8:11], s20 offen lds
    s_waitcnt vmcnt(6)
    s_barrier
    s_mul_i32 s20, s22, 196608
    s_add_u32 s20, s20, 0
    s_add_u32 s22, s22, 1
    s_cmp_eq_u32 s22, 10
    s_cselect_b32 s22, 0, s22
    s_add_u32 m0, s18, 49152
    s_nop 0
    buffer_load_dwordx4 v2, s[8:11], s20 offen lds
    s_add_u32 m0, s18, 50176
    s_nop 0
    buffer_load_dwordx4 v3, s[8:11], s20 offen lds
    s_add_u32 m0, s18, 51200
    s_nop 0
    buffer_load_dwordx4 v4, s[8:11], s20 offen lds
    s_add_u32 m0, s18, 52224
    s_nop 0
    buffer_load_dwordx4 v5, s[8:11], s20 offen lds
    s_add_u32 m0, s18, 53248
    s_nop 0
    buffer_load_dwordx4 v6, s[8:11], s20 offen lds
    s_add_u32 m0, s18, 54272
    s_nop 0
    buffer_load_dwordx4 v7, s[8:11], s20 offen lds
    s_cmp_lg_u32 s3, 4
    s_cbranch_scc1 Lonly_205
    s_lshl_b32 s24, s61, 7
    s_add_u32 s24, s24, 0
    v_cmp_ne_u32 vcc, s62, v16
    s_nop 1
    s_cmp_eq_u64 vcc, 0
    s_cbranch_scc1 Lpok_206
    s_add_u32 s28, s58, 13107200
    s_addc_u32 s29, s59, 0
    s_mov_b32 s30, 16384
    s_mov_b32 s31, 0x00020000
    s_mov_b64 s[32:33], exec
    s_mov_b32 exec_lo, 0xffff
    s_mov_b32 exec_hi, 0x0
    v_lshlrev_b32 v12, 2, v0
    s_mov_b32 s34, 0
Lw_207:
    buffer_load_dword v13, v12, s[28:31], s24 offen sc1
    s_waitcnt vmcnt(0)
    v_cmp_ne_u32 vcc, s62, v13
    s_nop 1
    s_cmp_eq_u64 vcc, 0
    s_cbranch_scc1 Lwok_208
    s_add_u32 s34, s34, 1
    s_cmp_gt_u32 s34, 16384
    s_cbranch_scc1 Lwok_208
    s_sleep 1
    s_branch Lw_207
Lwok_208:
    s_mov_b64 exec, s[32:33]
Lpok_206:
Lonly_205:
    s_waitcnt vmcnt(6)
    s_barrier
    s_mov_b32 s21, 0
    buffer_load_dwordx4 v[56:59], v89, s[92:95], s21 offen sc1
    s_mov_b32 s21, 2048
    buffer_load_dwordx4 v[60:63], v89, s[92:95], s21 offen sc1
    s_mov_b32 s21, 4096
    buffer_load_dwordx4 v[64:67], v89, s[92:95], s21 offen sc1
    s_mov_b32 s21, 6144
    buffer_load_dwordx4 v[68:71], v89, s[92:95], s21 offen sc1
    s_mov_b32 s21, 8192
    buffer_load_dwordx4 v[72:75], v89, s[92:95], s21 offen sc1
    s_mov_b32 s21, 10240
    buffer_load_dwordx4 v[76:79], v89, s[92:95], s21 offen sc1
    s_mov_b32 s21, 12288
    buffer_load_dwordx4 v[80:83], v89, s[92:95], s21 offen sc1
    s_mov_b32 s21, 14336
    buffer_load_dwordx4 v[84:87], v89, s[92:95], s21 offen sc1
    s_waitcnt vmcnt(8)
    s_barrier
    s_branch Lzl_j_198
Lzl_x_197:
    s_mov_b32 s8, s36
    s_mov_b32 s9, s37
    s_mov_b32 s10, 2621440
    s_mov_b32 s11, 0x00020000
    s_sub_u32 s16, s3, 6
    v_lshrrev_b32 v4, 3, v0
    v_and_b32 v5, 7, v0
    v_lshrrev_b32 v6, 1, v4
    v_xor_b32 v7, v5, v6
    s_movk_i32 s19, 1280
    v_mul_u32_u24 v8, s19, v4
    v_lshl_add_u32 v2, v7, 4, v8
    v_xor_b32 v7, 4, v7
    v_lshl_add_u32 v3, v7, 4, v8
    v_add_u32 v3, 10240, v3
    s_lshl_b32 s17, s4, 7
    s_lshl_b32 s18, s16, 6
    s_add_u32 s17, s17, s18
    s_mul_i32 s17, s17, 1280
    s_lshl_b32 s18, s16, 13
    s_mov_b32 s22, s7
    s_lshl_b32 s23, s22, 7
    s_add_u32 s23, s23, s17
    s_add_u32 s22, s22, 1
    s_cmp_eq_u32 s22, 10
    s_cselect_b32 s22, 0, s22
    s_add_u32 m0, s18, 4096
    s_add_u32 s20, s23, 0
    buffer_load_dwordx4 v2, s[8:11], s20 offen lds
    s_add_u32 m0, s18, 5120
    s_add_u32 s20, s23, 0
    buffer_load_dwordx4 v3, s[8:11], s20 offen lds
    s_add_u32 m0, s18, 6144
    s_add_u32 s20, s23, 20480
    buffer_load_dwordx4 v2, s[8:11], s20 offen lds
    s_add_u32 m0, s18, 7168
    s_add_u32 s20, s23, 20480
    buffer_load_dwordx4 v3, s[8:11], s20 offen lds
    s_add_u32 m0, s18, 8192
    s_add_u32 s20, s23, 40960
    buffer_load_dwordx4 v2, s[8:11], s20 offen lds
    s_add_u32 m0, s18, 9216
    s_add_u32 s20, s23, 40960
    buffer_load_dwordx4 v3, s[8:11], s20 offen lds
    s_add_u32 m0, s18, 10240
    s_add_u32 s20, s23, 61440
    buffer_load_dwordx4 v2, s[8:11], s20 offen lds
    s_add_u32 m0, s18, 11264
    s_add_u32 s20, s23, 61440
    buffer_load_dwordx4 v3, s[8:11], s20 offen lds
    s_lshl_b32 s23, s22, 7
    s_add_u32 s23, s23, s17
    s_add_u32 s22, s22, 1
    s_cmp_eq_u32 s22, 10
    s_cselect_b32 s22, 0, s22
    s_add_u32 m0, s18, 32768
    s_add_u32 s20, s23, 0
    buffer_load_dwordx4 v2, s[8:11], s20 offen lds
    s_add_u32 m0, s18, 33792
    s_add_u32 s20, s23, 0
    buffer_load_dwordx4 v3, s[8:11], s20 offen lds
    s_add_u32 m0, s18, 34816
    s_add_u32 s20, s23, 20480
    buffer_load_dwordx4 v2, s[8:11], s20 offen lds
    s_add_u32 m0, s18, 35840
    s_add_u32 s20, s23, 20480
    buffer_load_dwordx4 v3, s[8:11], s20 offen lds
    s_add_u32 m0, s18, 36864
    s_add_u32 s20, s23, 40960
    buffer_load_dwordx4 v2, s[8:11], s20 offen lds
    s_add_u32 m0, s18, 37888
    s_add_u32 s20, s23, 40960
    buffer_load_dwordx4 v3, s[8:11], s20 offen lds
    s_add_u32 m0, s18, 38912
    s_add_u32 s20, s23, 61440
    buffer_load_dwordx4 v2, s[8:11], s20 offen lds
    s_add_u32 m0, s18, 39936
    s_add_u32 s20, s23, 61440
    buffer_load_dwordx4 v3, s[8:11], s20 offen lds
    s_waitcnt vmcnt(8)
    s_barrier
    s_lshl_b32 s23, s22, 7
    s_add_u32 s23, s23, s17
    s_add_u32 s22, s22, 1
    s_cmp_eq_u32 s22, 10
    s_cselect_b32 s22, 0, s22
    s_add_u32 m0, s18, 61440
    s_add_u32 s20, s23, 0
    buffer_load_dwordx4 v2, s[8:11], s20 offen lds
    s_add_u32 m0, s18, 62464
    s_add_u32 s20, s23, 0
    buffer_load_dwordx4 v3, s[8:11], s20 offen lds
    s_add_u32 m0, s18, 63488
    s_add_u32 s20, s23, 20480
    buffer_load_dwordx4 v2, s[8:11], s20 offen lds
    s_add_u32 m0, s18, 64512
    s_add_u32 s20, s23, 20480
    buffer_load_dwordx4 v3, s[8:11], s20 offen lds
    s_add_u32 m0, s18, 65536
    s_add_u32 s20, s23, 40960
    buffer_load_dwordx4 v2, s[8:11], s20 offen lds
    s_add_u32 m0, s18, 66560
    s_add_u32 s20, s23, 40960
    buffer_load_dwordx4 v3, s[8:11], s20 offen lds
    s_add_u32 m0, s18, 67584
    s_add_u32 s20, s23, 61440
    buffer_load_dwordx4 v2, s[8:11], s20 offen lds
    s_add_u32 m0, s18, 68608
    s_add_u32 s20, s23, 61440
    buffer_load_dwordx4 v3, s[8:11], s20 offen lds
    s_waitcnt vmcnt(8)
    s_barrier
    s_lshl_b32 s23, s22, 7
    s_add_u32 s23, s23, s17
    s_add_u32 s22, s22, 1
    s_cmp_eq_u32 s22, 10
    s_cselect_b32 s22, 0, s22
    s_add_u32 m0, s18, 4096
    s_add_u32 s20, s23, 0
    buffer_load_dwordx4 v2, s[8:11], s20 offen lds
    s_add_u32 m0, s18, 5120
    s_add_u32 s20, s23, 0
    buffer_load_dwordx4 v3, s[8:11], s20 offen lds
    s_add_u32 m0, s18, 6144
    s_add_u32 s20, s23, 20480
    buffer_load_dwordx4 v2, s[8:11], s20 offen lds
    s_add_u32 m0, s18, 7168
    s_add_u32 s20, s23, 20480
    buffer_load_dwordx4 v3, s[8:11], s20 offen lds
    s_add_u32 m0, s18, 8192
    s_add_u32 s20, s23, 40960
    buffer_load_dwordx4 v2, s[8:11], s20 offen lds
    s_add_u32 m0, s18, 9216
    s_add_u32 s20, s23, 40960
    buffer_load_dwordx4 v3, s[8:11], s20 offen lds
    s_add_u32 m0, s18, 10240
    s_add_u32 s20, s23, 61440
    buffer_load_dwordx4 v2, s[8:11], s20 offen lds
    s_add_u32 m0, s18, 11264
    s_add_u32 s20, s23, 61440
    buffer_load_dwordx4 v3, s[8:11], s20 offen lds
    s_waitcnt vmcnt(8)
    s_barrier
    s_lshl_b32 s23, s22, 7
    s_add_u32 s23, s23, s17
    s_add_u32 s22, s22, 1
    s_cmp_eq_u32 s22, 10
    s_cselect_b32 s22, 0, s22
    s_add_u32 m0, s18, 32768
    s_add_u32 s20, s23, 0
    buffer_load_dwordx4 v2, s[8:11], s20 offen lds
    s_add_u32 m0, s18, 33792
    s_add_u32 s20, s23, 0
    buffer_load_dwordx4 v3, s[8:11], s20 offen lds
    s_add_u32 m0, s18, 34816
    s_add_u32 s20, s23, 20480
    buffer_load_dwordx4 v2, s[8:11], s20 offen lds
    s_add_u32 m0, s18, 35840
    s_add_u32 s20, s23, 20480
    buffer_load_dwordx4 v3, s[8:11], s20 offen lds
    s_add_u32 m0, s18, 36864
    s_add_u32 s20, s23, 40960
    buffer_load_dwordx4 v2, s[8:11], s20 offen lds
    s_add_u32 m0, s18, 37888
    s_add_u32 s20, s23, 40960
    buffer_load_dwordx4 v3, s[8:11], s20 offen lds
    s_add_u32 m0, s18, 38912
    s_add_u32 s20, s23, 61440
    buffer_load_dwordx4 v2, s[8:11], s20 offen lds
    s_add_u32 m0, s18, 39936
    s_add_u32 s20, s23, 61440
    buffer_load_dwordx4 v3, s[8:11], s20 offen lds
    s_mul_i32 s26, s5, 393216
    s_lshl_b32 s25, s4, 2
    s_sub_u32 s24, s3, 6
    s_lshl_b32 s24, s24, 1
    s_add_u32 s25, s25, s24
    s_mul_i32 s25, s25, 6144
    s_add_u32 s26, s26, s25
    s_add_u32 s28, s58, 9437184
    s_addc_u32 s29, s59, 0
    s_mov_b32 s30, 3145728
    s_mov_b32 s31, 0x00020000
    v_mov_b32 v44, -1
    v_mov_b32 v45, -1
    v_mov_b32 v46, -1
    v_mov_b32 v47, -1
    v_lshlrev_b32 v43, 4, v0
    buffer_store_dwordx4 v[44:47], v43, s[28:31], s26 offen offset:0 sc1
    buffer_store_dwordx4 v[44:47], v43, s[28:31], s26 offen offset:1024 sc1
    buffer_store_dwordx4 v[44:47], v43, s[28:31], s26 offen offset:2048 sc1
    buffer_store_dwordx4 v[44:47], v43, s[28:31], s26 offen offset:3072 sc1
    s_add_u32 s26, s26, 4096
    buffer_store_dwordx4 v[44:47], v43, s[28:31], s26 offen offset:0 sc1
    buffer_store_dwordx4 v[44:47], v43, s[28:31], s26 offen offset:1024 sc1
    buffer_store_dwordx4 v[44:47], v43, s[28:31], s26 offen offset:2048 sc1
    buffer_store_dwordx4 v[44:47], v43, s[28:31], s26 offen offset:3072 sc1
    s_add_u32 s26, s26, 4096
    buffer_store_dwordx4 v[44:47], v43, s[28:31], s26 offen offset:0 sc1
    buffer_store_dwordx4 v[44:47], v43, s[28:31], s26 offen offset:1024 sc1
    buffer_store_dwordx4 v[44:47], v43, s[28:31], s26 offen offset:2048 sc1
    buffer_store_dwordx4 v[44:47], v43, s[28:31], s26 offen offset:3072 sc1
    s_add_u32 s26, s26, 4096
    s_waitcnt vmcnt(20)
    s_barrier
    s_lshl_b32 s23, s22, 7
    s_add_u32 s23, s23, s17
    s_add_u32 s22, s22, 1
    s_cmp_eq_u32 s22, 10
    s_cselect_b32 s22, 0, s22
    s_add_u32 m0, s18, 61440
    s_add_u32 s20, s23, 0
    buffer_load_dwordx4 v2, s[8:11], s20 offen lds
    s_add_u32 m0, s18, 62464
    s_add_u32 s20, s23, 0
    buffer_load_dwordx4 v3, s[8:11], s20 offen lds
    s_add_u32 m0, s18, 63488
    s_add_u32 s20, s23, 20480
    buffer_load_dwordx4 v2, s[8:11], s20 offen lds
    s_add_u32 m0, s18, 64512
    s_add_u32 s20, s23, 20480
    buffer_load_dwordx4 v3, s[8:11], s20 offen lds
    s_add_u32 m0, s18, 65536
    s_add_u32 s20, s23, 40960
    buffer_load_dwordx4 v2, s[8:11], s20 offen lds
    s_add_u32 m0, s18, 66560
    s_add_u32 s20, s23, 40960
    buffer_load_dwordx4 v3, s[8:11], s20 offen lds
    s_add_u32 m0, s18, 67584
    s_add_u32 s20, s23, 61440
    buffer_load_dwordx4 v2, s[8:11], s20 offen lds
    s_add_u32 m0, s18, 68608
    s_add_u32 s20, s23, 61440
    buffer_load_dwordx4 v3, s[8:11], s20 offen lds
    s_waitcnt vmcnt(20)
    s_barrier
    s_lshl_b32 s23, s22, 7
    s_add_u32 s23, s23, s17
    s_add_u32 s22, s22, 1
    s_cmp_eq_u32 s22, 10
    s_cselect_b32 s22, 0, s22
    s_add_u32 m0, s18, 4096
    s_add_u32 s20, s23, 0
    buffer_load_dwordx4 v2, s[8:11], s20 offen lds
    s_add_u32 m0, s18, 5120
    s_add_u32 s20, s23, 0
    buffer_load_dwordx4 v3, s[8:11], s20 offen lds
    s_add_u32 m0, s18, 6144
    s_add_u32 s20, s23, 20480
    buffer_load_dwordx4 v2, s[8:11], s20 offen lds
    s_add_u32 m0, s18, 7168
    s_add_u32 s20, s23, 20480
    buffer_load_dwordx4 v3, s[8:11], s20 offen lds
    s_add_u32 m0, s18, 8192
    s_add_u32 s20, s23, 40960
    buffer_load_dwordx4 v2, s[8:11], s20 offen lds
    s_add_u32 m0, s18, 9216
    s_add_u32 s20, s23, 40960
    buffer_load_dwordx4 v3, s[8:11], s20 offen lds
    s_add_u32 m0, s18, 10240
    s_add_u32 s20, s23, 61440
    buffer_load_dwordx4 v2, s[8:11], s20 offen lds
    s_add_u32 m0, s18, 11264
    s_add_u32 s20, s23, 61440
    buffer_load_dwordx4 v3, s[8:11], s20 offen lds
    s_mov_b32 s28, s56
    s_mov_b32 s29, s57
    s_mov_b32 s30, 256
    s_mov_b32 s31, 0x00020000
    v_mov_b32 v14, 0
    buffer_load_dword v15, v14, s[28:31], 0 offen sc1
    s_waitcnt vmcnt(9)
    s_barrier
    s_lshl_b32 s23, s22, 7
    s_add_u32 s23, s23, s17
    s_add_u32 s22, s22, 1
    s_cmp_eq_u32 s22, 10
    s_cselect_b32 s22, 0, s22
    s_add_u32 m0, s18, 32768
    s_add_u32 s20, s23, 0
    buffer_load_dwordx4 v2, s[8:11], s20 offen lds
    s_add_u32 m0, s18, 33792
    s_add_u32 s20, s23, 0
    buffer_load_dwordx4 v3, s[8:11], s20 offen lds
    s_add_u32 m0, s18, 34816
    s_add_u32 s20, s23, 20480
    buffer_load_dwordx4 v2, s[8:11], s20 offen lds
    s_add_u32 m0, s18, 35840
    s_add_u32 s20, s23, 20480
    buffer_load_dwordx4 v3, s[8:11], s20 offen lds
    s_add_u32 m0, s18, 36864
    s_add_u32 s20, s23, 40960
    buffer_load_dwordx4 v2, s[8:11], s20 offen lds
    s_add_u32 m0, s18, 37888
    s_add_u32 s20, s23, 40960
    buffer_load_dwordx4 v3, s[8:11], s20 offen lds
    s_add_u32 m0, s18, 38912
    s_add_u32 s20, s23, 61440
    buffer_load_dwordx4 v2, s[8:11], s20 offen lds
    s_add_u32 m0, s18, 39936
    s_add_u32 s20, s23, 61440
    buffer_load_dwordx4 v3, s[8:11], s20 offen lds
    s_waitcnt vmcnt(9)
    s_barrier
    s_lshl_b32 s23, s22, 7
    s_add_u32 s23, s23, s17
    s_add_u32 s22, s22, 1
    s_cmp_eq_u32 s22, 10
    s_cselect_b32 s22, 0, s22
    s_add_u32 m0, s18, 61440
    s_add_u32 s20, s23, 0
    buffer_load_dwordx4 v2, s[8:11], s20 offen lds
    s_add_u32 m0, s18, 62464
    s_add_u32 s20, s23, 0
    buffer_load_dwordx4 v3, s[8:11], s20 offen lds
    s_add_u32 m0, s18, 63488
    s_add_u32 s20, s23, 20480
    buffer_load_dwordx4 v2, s[8:11], s20 offen lds
    s_add_u32 m0, s18, 64512
    s_add_u32 s20, s23, 20480
    buffer_load_dwordx4 v3, s[8:11], s20 offen lds
    s_add_u32 m0, s18, 65536
    s_add_u32 s20, s23, 40960
    buffer_load_dwordx4 v2, s[8:11], s20 offen lds
    s_add_u32 m0, s18, 66560
    s_add_u32 s20, s23, 40960
    buffer_load_dwordx4 v3, s[8:11], s20 offen lds
    s_add_u32 m0, s18, 67584
    s_add_u32 s20, s23, 61440
    buffer_load_dwordx4 v2, s[8:11], s20 offen lds
    s_add_u32 m0, s18, 68608
    s_add_u32 s20, s23, 61440
    buffer_load_dwordx4 v3, s[8:11], s20 offen lds
    s_waitcnt vmcnt(8)
    s_barrier
    s_lshl_b32 s23, s22, 7
    s_add_u32 s23, s23, s17
    s_add_u32 s22, s22, 1
    s_cmp_eq_u32 s22, 10
    s_cselect_b32 s22, 0, s22
    s_add_u32 m0, s18, 4096
    s_add_u32 s20, s23, 0
    buffer_load_dwordx4 v2, s[8:11], s20 offen lds
    s_add_u32 m0, s18, 5120
    s_add_u32 s20, s23, 0
    buffer_load_dwordx4 v3, s[8:11], s20 offen lds
    s_add_u32 m0, s18, 6144
    s_add_u32 s20, s23, 20480
    buffer_load_dwordx4 v2, s[8:11], s20 offen lds
    s_add_u32 m0, s18, 7168
    s_add_u32 s20, s23, 20480
    buffer_load_dwordx4 v3, s[8:11], s20 offen lds
    s_add_u32 m0, s18, 8192
    s_add_u32 s20, s23, 40960
    buffer_load_dwordx4 v2, s[8:11], s20 offen lds
    s_add_u32 m0, s18, 9216
    s_add_u32 s20, s23, 40960
    buffer_load_dwordx4 v3, s[8:11], s20 offen lds
    s_add_u32 m0, s18, 10240
    s_add_u32 s20, s23, 61440
    buffer_load_dwordx4 v2, s[8:11], s20 offen lds
    s_add_u32 m0, s18, 11264
    s_add_u32 s20, s23, 61440
    buffer_load_dwordx4 v3, s[8:11], s20 offen lds
    s_waitcnt vmcnt(16)
    v_readfirstlane_b32 s62, v15
    s_nop 1
    s_cmp_lg_u32 s62, 0
    s_cbranch_scc1 Lnok_209
    s_mov_b32 s28, s56
    s_mov_b32 s29, s57
    s_mov_b32 s30, 256
    s_mov_b32 s31, 0x00020000
    v_mov_b32 v14, 0
    s_mov_b32 s32, 0
Lnonce_210:
    buffer_load_dword v15, v14, s[28:31], 0 offen sc1
    s_waitcnt vmcnt(0)
    v_readfirstlane_b32 s62, v15
    s_add_u32 s32, s32, 1
    s_cmp_gt_u32 s32, 65536
    s_cbranch_scc1 Lnonce_o_211
    s_cmp_eq_u32 s62, 0
    s_cbranch_scc1 Lnonce_210
Lnonce_o_211:
Lnok_209:
    s_waitcnt vmcnt(8)
    s_barrier
    s_lshl_b32 s23, s22, 7
    s_add_u32 s23, s23, s17
    s_add_u32 s22, s22, 1
    s_cmp_eq_u32 s22, 10
    s_cselect_b32 s22, 0, s22
    s_add_u32 m0, s18, 32768
    s_add_u32 s20, s23, 0
    buffer_load_dwordx4 v2, s[8:11], s20 offen lds
    s_add_u32 m0, s18, 33792
    s_add_u32 s20, s23, 0
    buffer_load_dwordx4 v3, s[8:11], s20 offen lds
    s_add_u32 m0, s18, 34816
    s_add_u32 s20, s23, 20480
    buffer_load_dwordx4 v2, s[8:11], s20 offen lds
    s_add_u32 m0, s18, 35840
    s_add_u32 s20, s23, 20480
    buffer_load_dwordx4 v3, s[8:11], s20 offen lds
    s_add_u32 m0, s18, 36864
    s_add_u32 s20, s23, 40960
    buffer_load_dwordx4 v2, s[8:11], s20 offen lds
    s_add_u32 m0, s18, 37888
    s_add_u32 s20, s23, 40960
    buffer_load_dwordx4 v3, s[8:11], s20 offen lds
    s_add_u32 m0, s18, 38912
    s_add_u32 s20, s23, 61440
    buffer_load_dwordx4 v2, s[8:11], s20 offen lds
    s_add_u32 m0, s18, 39936
    s_add_u32 s20, s23, 61440
    buffer_load_dwordx4 v3, s[8:11], s20 offen lds
    s_cmp_lg_u32 s3, 6
    s_cbranch_scc1 Lonly_212
    s_lshl_b32 s24, s5, 7
    s_lshl_b32 s25, s4, 2
    s_add_u32 s24, s24, s25
    s_add_u32 s24, s24, 0
    s_add_u32 s28, s58, 13107200
    s_addc_u32 s29, s59, 0
    s_mov_b32 s30, 16384
    s_mov_b32 s31, 0x00020000
    s_mov_b64 s[32:33], exec
    s_mov_b64 exec, 1
    v_mov_b32 v12, 0
    v_mov_b32 v13, s62
    buffer_store_dword v13, v12, s[28:31], s24 offen sc1
    s_mov_b64 exec, s[32:33]
Lonly_212:
    s_waitcnt vmcnt(8)
    s_barrier
    s_lshl_b32 s23, s22, 7
    s_add_u32 s23, s23, s17
    s_add_u32 s22, s22, 1
    s_cmp_eq_u32 s22, 10
    s_cselect_b32 s22, 0, s22
    s_add_u32 m0, s18, 61440
    s_add_u32 s20, s23, 0
    buffer_load_dwordx4 v2, s[8:11], s20 offen lds
    s_add_u32 m0, s18, 62464
    s_add_u32 s20, s23, 0
    buffer_load_dwordx4 v3, s[8:11], s20 offen lds
    s_add_u32 m0, s18, 63488
    s_add_u32 s20, s23, 20480
    buffer_load_dwordx4 v2, s[8:11], s20 offen lds
    s_add_u32 m0, s18, 64512
    s_add_u32 s20, s23, 20480
    buffer_load_dwordx4 v3, s[8:11], s20 offen lds
    s_add_u32 m0, s18, 65536
    s_add_u32 s20, s23, 40960
    buffer_load_dwordx4 v2, s[8:11], s20 offen lds
    s_add_u32 m0, s18, 66560
    s_add_u32 s20, s23, 40960
    buffer_load_dwordx4 v3, s[8:11], s20 offen lds
    s_add_u32 m0, s18, 67584
    s_add_u32 s20, s23, 61440
    buffer_load_dwordx4 v2, s[8:11], s20 offen lds
    s_add_u32 m0, s18, 68608
    s_add_u32 s20, s23, 61440
    buffer_load_dwordx4 v3, s[8:11], s20 offen lds
    s_barrier
    s_waitcnt vmcnt(8)
    s_barrier
    s_lshl_b32 s23, s22, 7
    s_add_u32 s23, s23, s17
    s_add_u32 s22, s22, 1
    s_cmp_eq_u32 s22, 10
    s_cselect_b32 s22, 0, s22
    s_add_u32 m0, s18, 4096
    s_add_u32 s20, s23, 0
    buffer_load_dwordx4 v2, s[8:11], s20 offen lds
    s_add_u32 m0, s18, 5120
    s_add_u32 s20, s23, 0
    buffer_load_dwordx4 v3, s[8:11], s20 offen lds
    s_add_u32 m0, s18, 6144
    s_add_u32 s20, s23, 20480
    buffer_load_dwordx4 v2, s[8:11], s20 offen lds
    s_add_u32 m0, s18, 7168
    s_add_u32 s20, s23, 20480
    buffer_load_dwordx4 v3, s[8:11], s20 offen lds
    s_add_u32 m0, s18, 8192
    s_add_u32 s20, s23, 40960
    buffer_load_dwordx4 v2, s[8:11], s20 offen lds
    s_add_u32 m0, s18, 9216
    s_add_u32 s20, s23, 40960
    buffer_load_dwordx4 v3, s[8:11], s20 offen lds
    s_add_u32 m0, s18, 10240
    s_add_u32 s20, s23, 61440
    buffer_load_dwordx4 v2, s[8:11], s20 offen lds
    s_add_u32 m0, s18, 11264
    s_add_u32 s20, s23, 61440
    buffer_load_dwordx4 v3, s[8:11], s20 offen lds
    s_waitcnt vmcnt(8)
    s_barrier
    s_lshl_b32 s23, s22, 7
    s_add_u32 s23, s23, s17
    s_add_u32 s22, s22, 1
    s_cmp_eq_u32 s22, 10
    s_cselect_b32 s22, 0, s22
    s_add_u32 m0, s18, 32768
    s_add_u32 s20, s23, 0
    buffer_load_dwordx4 v2, s[8:11], s20 offen lds
    s_add_u32 m0, s18, 33792
    s_add_u32 s20, s23, 0
    buffer_load_dwordx4 v3, s[8:11], s20 offen lds
    s_add_u32 m0, s18, 34816
    s_add_u32 s20, s23, 20480
    buffer_load_dwordx4 v2, s[8:11], s20 offen lds
    s_add_u32 m0, s18, 35840
    s_add_u32 s20, s23, 20480
    buffer_load_dwordx4 v3, s[8:11], s20 offen lds
    s_add_u32 m0, s18, 36864
    s_add_u32 s20, s23, 40960
    buffer_load_dwordx4 v2, s[8:11], s20 offen lds
    s_add_u32 m0, s18, 37888
    s_add_u32 s20, s23, 40960
    buffer_load_dwordx4 v3, s[8:11], s20 offen lds
    s_add_u32 m0, s18, 38912
    s_add_u32 s20, s23, 61440
    buffer_load_dwordx4 v2, s[8:11], s20 offen lds
    s_add_u32 m0, s18, 39936
    s_add_u32 s20, s23, 61440
    buffer_load_dwordx4 v3, s[8:11], s20 offen lds
    s_waitcnt vmcnt(8)
    s_barrier
    s_lshl_b32 s23, s22, 7
    s_add_u32 s23, s23, s17
    s_add_u32 s22, s22, 1
    s_cmp_eq_u32 s22, 10
    s_cselect_b32 s22, 0, s22
    s_add_u32 m0, s18, 61440
    s_add_u32 s20, s23, 0
    buffer_load_dwordx4 v2, s[8:11], s20 offen lds
    s_add_u32 m0, s18, 62464
    s_add_u32 s20, s23, 0
    buffer_load_dwordx4 v3, s[8:11], s20 offen lds
    s_add_u32 m0, s18, 63488
    s_add_u32 s20, s23, 20480
    buffer_load_dwordx4 v2, s[8:11], s20 offen lds
    s_add_u32 m0, s18, 64512
    s_add_u32 s20, s23, 20480
    buffer_load_dwordx4 v3, s[8:11], s20 offen lds
    s_add_u32 m0, s18, 65536
    s_add_u32 s20, s23, 40960
    buffer_load_dwordx4 v2, s[8:11], s20 offen lds
    s_add_u32 m0, s18, 66560
    s_add_u32 s20, s23, 40960
    buffer_load_dwordx4 v3, s[8:11], s20 offen lds
    s_add_u32 m0, s18, 67584
    s_add_u32 s20, s23, 61440
    buffer_load_dwordx4 v2, s[8:11], s20 offen lds
    s_add_u32 m0, s18, 68608
    s_add_u32 s20, s23, 61440
    buffer_load_dwordx4 v3, s[8:11], s20 offen lds
    s_waitcnt vmcnt(8)
    s_barrier
    s_lshl_b32 s23, s22, 7
    s_add_u32 s23, s23, s17
    s_add_u32 s22, s22, 1
    s_cmp_eq_u32 s22, 10
    s_cselect_b32 s22, 0, s22
    s_add_u32 m0, s18, 4096
    s_add_u32 s20, s23, 0
    buffer_load_dwordx4 v2, s[8:11], s20 offen lds
    s_add_u32 m0, s18, 5120
    s_add_u32 s20, s23, 0
    buffer_load_dwordx4 v3, s[8:11], s20 offen lds
    s_add_u32 m0, s18, 6144
    s_add_u32 s20, s23, 20480
    buffer_load_dwordx4 v2, s[8:11], s20 offen lds
    s_add_u32 m0, s18, 7168
    s_add_u32 s20, s23, 20480
    buffer_load_dwordx4 v3, s[8:11], s20 offen lds
    s_add_u32 m0, s18, 8192
    s_add_u32 s20, s23, 40960
    buffer_load_dwordx4 v2, s[8:11], s20 offen lds
    s_add_u32 m0, s18, 9216
    s_add_u32 s20, s23, 40960
    buffer_load_dwordx4 v3, s[8:11], s20 offen lds
    s_add_u32 m0, s18, 10240
    s_add_u32 s20, s23, 61440
    buffer_load_dwordx4 v2, s[8:11], s20 offen lds
    s_add_u32 m0, s18, 11264
    s_add_u32 s20, s23, 61440
    buffer_load_dwordx4 v3, s[8:11], s20 offen lds
    s_lshl_b32 s24, s60, 18
    s_mov_b32 s40, s46
    s_mov_b32 s41, s47
    s_add_u32 s40, s40, s24
    s_addc_u32 s41, s41, 0
    s_mov_b32 s42, 262144
    s_mov_b32 s43, 0x00020000
    v_lshrrev_b32 v90, 5, v0
    s_sub_u32 s24, s3, 4
    s_lshl_b32 s24, s24, 2
    v_add_u32 v90, s24, v90
    v_and_b32 v91, 31, v0
    v_xor_b32 v92, v91, v90
    v_lshlrev_b32 v92, 4, v92
    v_lshl_add_u32 v92, v90, 12, v92
    v_add_u32 v90, 2, v90
    v_xor_b32 v93, v91, v90
    v_lshlrev_b32 v93, 4, v93
    v_lshl_add_u32 v93, v90, 12, v93
    s_sub_u32 s25, s3, 4
    s_lshl_b32 s25, s25, 11
    s_add_u32 s26, s100, 0
    s_and_b32 s26, s26, 3
    s_lshl_b32 s26, s26, 9
    s_add_u32 m0, s25, 98304
    s_add_u32 s24, s26, 0
    buffer_load_dwordx4 v92, s[40:43], s24 offen lds
    s_add_u32 m0, s25, 99328
    s_add_u32 s24, s26, 0
    buffer_load_dwordx4 v93, s[40:43], s24 offen lds
    s_add_u32 m0, s25, 106496
    s_add_u32 s24, s26, 65536
    buffer_load_dwordx4 v92, s[40:43], s24 offen lds
    s_add_u32 m0, s25, 107520
    s_add_u32 s24, s26, 65536
    buffer_load_dwordx4 v93, s[40:43], s24 offen lds
    s_add_u32 m0, s25, 114688
    s_add_u32 s24, s26, 131072
    buffer_load_dwordx4 v92, s[40:43], s24 offen lds
    s_add_u32 m0, s25, 115712
    s_add_u32 s24, s26, 131072
    buffer_load_dwordx4 v93, s[40:43], s24 offen lds
    s_add_u32 m0, s25, 122880
    s_add_u32 s24, s26, 196608
    buffer_load_dwordx4 v92, s[40:43], s24 offen lds
    s_add_u32 m0, s25, 123904
    s_add_u32 s24, s26, 196608
    buffer_load_dwordx4 v93, s[40:43], s24 offen lds
    s_add_u32 s26, s100, 0
    s_and_b32 s26, s26, 3
    s_lshl_b32 s26, s26, 9
    s_add_u32 s26, s26, 2048
    s_add_u32 m0, s25, 131072
    s_add_u32 s24, s26, 0
    buffer_load_dwordx4 v92, s[40:43], s24 offen lds
    s_add_u32 m0, s25, 132096
    s_add_u32 s24, s26, 0
    buffer_load_dwordx4 v93, s[40:43], s24 offen lds
    s_add_u32 m0, s25, 139264
    s_add_u32 s24, s26, 65536
    buffer_load_dwordx4 v92, s[40:43], s24 offen lds
    s_add_u32 m0, s25, 140288
    s_add_u32 s24, s26, 65536
    buffer_load_dwordx4 v93, s[40:43], s24 offen lds
    s_add_u32 m0, s25, 147456
    s_add_u32 s24, s26, 131072
    buffer_load_dwordx4 v92, s[40:43], s24 offen lds
    s_add_u32 m0, s25, 148480
    s_add_u32 s24, s26, 131072
    buffer_load_dwordx4 v93, s[40:43], s24 offen lds
    s_add_u32 m0, s25, 155648
    s_add_u32 s24, s26, 196608
    buffer_load_dwordx4 v92, s[40:43], s24 offen lds
    s_add_u32 m0, s25, 156672
    s_add_u32 s24, s26, 196608
    buffer_load_dwordx4 v93, s[40:43], s24 offen lds
    s_waitcnt vmcnt(24)
    s_barrier
    s_lshl_b32 s23, s22, 7
    s_add_u32 s23, s23, s17
    s_add_u32 s22, s22, 1
    s_cmp_eq_u32 s22, 10
    s_cselect_b32 s22, 0, s22
    s_add_u32 m0, s18, 32768
    s_add_u32 s20, s23, 0
    buffer_load_dwordx4 v2, s[8:11], s20 offen lds
    s_add_u32 m0, s18, 33792
    s_add_u32 s20, s23, 0
    buffer_load_dwordx4 v3, s[8:11], s20 offen lds
    s_add_u32 m0, s18, 34816
    s_add_u32 s20, s23, 20480
    buffer_load_dwordx4 v2, s[8:11], s20 offen lds
    s_add_u32 m0, s18, 35840
    s_add_u32 s20, s23, 20480
    buffer_load_dwordx4 v3, s[8:11], s20 offen lds
    s_add_u32 m0, s18, 36864
    s_add_u32 s20, s23, 40960
    buffer_load_dwordx4 v2, s[8:11], s20 offen lds
    s_add_u32 m0, s18, 37888
    s_add_u32 s20, s23, 40960
    buffer_load_dwordx4 v3, s[8:11], s20 offen lds
    s_add_u32 m0, s18, 38912
    s_add_u32 s20, s23, 61440
    buffer_load_dwordx4 v2, s[8:11], s20 offen lds
    s_add_u32 m0, s18, 39936
    s_add_u32 s20, s23, 61440
    buffer_load_dwordx4 v3, s[8:11], s20 offen lds
    s_waitcnt vmcnt(24)
    s_barrier
    s_lshl_b32 s23, s22, 7
    s_add_u32 s23, s23, s17
    s_add_u32 s22, s22, 1
    s_cmp_eq_u32 s22, 10
    s_cselect_b32 s22, 0, s22
    s_add_u32 m0, s18, 61440
    s_add_u32 s20, s23, 0
    buffer_load_dwordx4 v2, s[8:11], s20 offen lds
    s_add_u32 m0, s18, 62464
    s_add_u32 s20, s23, 0
    buffer_load_dwordx4 v3, s[8:11], s20 offen lds
    s_add_u32 m0, s18, 63488
    s_add_u32 s20, s23, 20480
    buffer_load_dwordx4 v2, s[8:11], s20 offen lds
    s_add_u32 m0, s18, 64512
    s_add_u32 s20, s23, 20480
    buffer_load_dwordx4 v3, s[8:11], s20 offen lds
    s_add_u32 m0, s18, 65536
    s_add_u32 s20, s23, 40960
    buffer_load_dwordx4 v2, s[8:11], s20 offen lds
    s_add_u32 m0, s18, 66560
    s_add_u32 s20, s23, 40960
    buffer_load_dwordx4 v3, s[8:11], s20 offen lds
    s_add_u32 m0, s18, 67584
    s_add_u32 s20, s23, 61440
    buffer_load_dwordx4 v2, s[8:11], s20 offen lds
    s_add_u32 m0, s18, 68608
    s_add_u32 s20, s23, 61440
    buffer_load_dwordx4 v3, s[8:11], s20 offen lds
    s_waitcnt vmcnt(8)
    s_barrier
    s_lshl_b32 s23, s22, 7
    s_add_u32 s23, s23, s17
    s_add_u32 s22, s22, 1
    s_cmp_eq_u32 s22, 10
    s_cselect_b32 s22, 0, s22
    s_add_u32 m0, s18, 4096
    s_add_u32 s20, s23, 0
    buffer_load_dwordx4 v2, s[8:11], s20 offen lds
    s_add_u32 m0, s18, 5120
    s_add_u32 s20, s23, 0
    buffer_load_dwordx4 v3, s[8:11], s20 offen lds
    s_add_u32 m0, s18, 6144
    s_add_u32 s20, s23, 20480
    buffer_load_dwordx4 v2, s[8:11], s20 offen lds
    s_add_u32 m0, s18, 7168
    s_add_u32 s20, s23, 20480
    buffer_load_dwordx4 v3, s[8:11], s20 offen lds
    s_add_u32 m0, s18, 8192
    s_add_u32 s20, s23, 40960
    buffer_load_dwordx4 v2, s[8:11], s20 offen lds
    s_add_u32 m0, s18, 9216
    s_add_u32 s20, s23, 40960
    buffer_load_dwordx4 v3, s[8:11], s20 offen lds
    s_add_u32 m0, s18, 10240
    s_add_u32 s20, s23, 61440
    buffer_load_dwordx4 v2, s[8:11], s20 offen lds
    s_add_u32 m0, s18, 11264
    s_add_u32 s20, s23, 61440
    buffer_load_dwordx4 v3, s[8:11], s20 offen lds
    s_waitcnt vmcnt(8)
    s_barrier
    s_lshl_b32 s23, s22, 7
    s_add_u32 s23, s23, s17
    s_add_u32 s22, s22, 1
    s_cmp_eq_u32 s22, 10
    s_cselect_b32 s22, 0, s22
    s_add_u32 m0, s18, 32768
    s_add_u32 s20, s23, 0
    buffer_load_dwordx4 v2, s[8:11], s20 offen lds
    s_add_u32 m0, s18, 33792
    s_add_u32 s20, s23, 0
    buffer_load_dwordx4 v3, s[8:11], s20 offen lds
    s_add_u32 m0, s18, 34816
    s_add_u32 s20, s23, 20480
    buffer_load_dwordx4 v2, s[8:11], s20 offen lds
    s_add_u32 m0, s18, 35840
    s_add_u32 s20, s23, 20480
    buffer_load_dwordx4 v3, s[8:11], s20 offen lds
    s_add_u32 m0, s18, 36864
    s_add_u32 s20, s23, 40960
    buffer_load_dwordx4 v2, s[8:11], s20 offen lds
    s_add_u32 m0, s18, 37888
    s_add_u32 s20, s23, 40960
    buffer_load_dwordx4 v3, s[8:11], s20 offen lds
    s_add_u32 m0, s18, 38912
    s_add_u32 s20, s23, 61440
    buffer_load_dwordx4 v2, s[8:11], s20 offen lds
    s_add_u32 m0, s18, 39936
    s_add_u32 s20, s23, 61440
    buffer_load_dwordx4 v3, s[8:11], s20 offen lds
    s_waitcnt vmcnt(8)
    s_barrier
    s_waitcnt vmcnt(0)
    s_barrier
Lzl_j_198:
    s_cmp_ge_u32 s3, 6
    s_cbranch_scc1 Lzxw_213
    s_mov_b32 s20, 0
Lst_215:
    s_waitcnt vmcnt(0)
    v_mov_b32 v12, 0
    v_xor_b32 v13, s62, v57
    v_or_b32 v12, v12, v13
    v_xor_b32 v13, s62, v59
    v_or_b32 v12, v12, v13
    v_xor_b32 v13, s62, v61
    v_or_b32 v12, v12, v13
    v_xor_b32 v13, s62, v63
    v_or_b32 v12, v12, v13
    v_xor_b32 v13, s62, v65
    v_or_b32 v12, v12, v13
    v_xor_b32 v13, s62, v67
    v_or_b32 v12, v12, v13
    v_xor_b32 v13, s62, v69
    v_or_b32 v12, v12, v13
    v_xor_b32 v13, s62, v71
    v_or_b32 v12, v12, v13
    v_xor_b32 v13, s62, v73
    v_or_b32 v12, v12, v13
    v_xor_b32 v13, s62, v75
    v_or_b32 v12, v12, v13
    v_xor_b32 v13, s62, v77
    v_or_b32 v12, v12, v13
    v_xor_b32 v13, s62, v79
    v_or_b32 v12, v12, v13
    v_xor_b32 v13, s62, v81
    v_or_b32 v12, v12, v13
    v_xor_b32 v13, s62, v83
    v_or_b32 v12, v12, v13
    v_xor_b32 v13, s62, v85
    v_or_b32 v12, v12, v13
    v_xor_b32 v13, s62, v87
    v_or_b32 v12, v12, v13
    v_cmp_ne_u32 vcc, 0, v12
    s_nop 1
    s_cmp_eq_u64 vcc, 0
    s_cbranch_scc1 Lstok_216
    s_add_u32 s20, s20, 1
    s_cmp_gt_u32 s20, 16384
    s_cbranch_scc1 Lstok_216
    s_sleep 1
    s_mov_b32 s21, 0
    buffer_load_dwordx4 v[56:59], v89, s[92:95], s21 offen sc1
    s_mov_b32 s21, 2048
    buffer_load_dwordx4 v[60:63], v89, s[92:95], s21 offen sc1
    s_mov_b32 s21, 4096
    buffer_load_dwordx4 v[64:67], v89, s[92:95], s21 offen sc1
    s_mov_b32 s21, 6144
    buffer_load_dwordx4 v[68:71], v89, s[92:95], s21 offen sc1
    s_mov_b32 s21, 8192
    buffer_load_dwordx4 v[72:75], v89, s[92:95], s21 offen sc1
    s_mov_b32 s21, 10240
    buffer_load_dwordx4 v[76:79], v89, s[92:95], s21 offen sc1
    s_mov_b32 s21, 12288
    buffer_load_dwordx4 v[80:83], v89, s[92:95], s21 offen sc1
    s_mov_b32 s21, 14336
    buffer_load_dwordx4 v[84:87], v89, s[92:95], s21 offen sc1
    s_branch Lst_215
Lstok_216:
    v_add_f32 v40, v56, v60
    v_add_f32 v41, v58, v62
    v_add_f32 v40, v40, v64
    v_add_f32 v41, v41, v66
    v_add_f32 v40, v40, v68
    v_add_f32 v41, v41, v70
    v_add_f32 v40, v40, v72
    v_add_f32 v41, v41, v74
    v_add_f32 v40, v40, v76
    v_add_f32 v41, v41, v78
    v_add_f32 v40, v40, v80
    v_add_f32 v41, v41, v82
    v_add_f32 v40, v40, v84
    v_add_f32 v41, v41, v86
    v_mul_f32 v40, 0x3aaaaaab, v40
    v_mul_f32 v41, 0x3aaaaaab, v41
    v_fma_f32 v41, -v40, v40, v41
    v_max_f32 v41, 0, v41
    v_add_f32 v41, 0x3727c5ac, v41
    v_rsq_f32 v42, v41
    s_nop 0
    v_mul_f32 v43, -v40, v42
    ds_write_b64 v88, v[42:43] offset:2048
    s_waitcnt lgkmcnt(0)
    s_branch Lzxj_214
Lzxw_213:
Lzxj_214:
    s_barrier
    s_barrier
    s_lshl_b32 s16, s4, 5
    s_lshl_b32 s17, s5, 2
    s_add_u32 s16, s16, s17
    s_add_u32 s63, s16, 2048
LP2_150:
    s_mov_b32 s4, s60
    s_mov_b32 s5, s61
    s_cmp_ge_u32 s3, 4
    s_cbranch_scc1 Lp2ld_217
    s_lshr_b32 s16, s3, 1
    s_and_b32 s17, s3, 1
    s_mul_i32 s18, s5, 393216
    s_add_u32 s8, s58, 9437184
    s_addc_u32 s9, s59, 0
    s_add_u32 s8, s8, s18
    s_addc_u32 s9, s9, 0
    s_mov_b32 s10, 393216
    s_mov_b32 s11, 0x00020000
    s_mul_i32 s32, s16, 196608
    s_mul_i32 s18, s17, 3072
    s_add_u32 s32, s32, s18
    v_lshlrev_b32 v188, 4, v0
    s_add_u32 s46, s100, 0
    s_and_b32 s46, s46, 3
    s_mul_i32 s46, s46, 49152
    s_add_u32 s46, s46, s32
    s_add_u32 s33, s101, 0
    s_and_b32 s33, s33, 7
    s_mul_i32 s33, s33, 6144
    s_add_u32 s19, s33, s46
    buffer_load_dwordx4 v[56:59], v188, s[8:11], s19 offen offset:0 sc1
    buffer_load_dwordx4 v[60:63], v188, s[8:11], s19 offen offset:1024 sc1
    buffer_load_dwordx4 v[64:67], v188, s[8:11], s19 offen offset:2048 sc1
    s_add_u32 s33, s101, 1
    s_and_b32 s33, s33, 7
    s_mul_i32 s33, s33, 6144
    s_add_u32 s19, s33, s46
    buffer_load_dwordx4 v[68:71], v188, s[8:11], s19 offen offset:0 sc1
    buffer_load_dwordx4 v[72:75], v188, s[8:11], s19 offen offset:1024 sc1
    buffer_load_dwordx4 v[76:79], v188, s[8:11], s19 offen offset:2048 sc1
    s_add_u32 s33, s101, 2
    s_and_b32 s33, s33, 7
    s_mul_i32 s33, s33, 6144
    s_add_u32 s19, s33, s46
    buffer_load_dwordx4 v[80:83], v188, s[8:11], s19 offen offset:0 sc1
    buffer_load_dwordx4 v[84:87], v188, s[8:11], s19 offen offset:1024 sc1
    buffer_load_dwordx4 v[88:91], v188, s[8:11], s19 offen offset:2048 sc1
    v_and_b32 v1, 15, v0
    v_lshrrev_b32 v3, 4, v0
    v_xor_b32 v3, v3, v1
    v_lshlrev_b32 v3, 4, v3
    v_lshl_add_u32 v184, v1, 9, v3
    v_mov_b32 v8, 0
    v_mov_b32 v9, 0
    v_mov_b32 v10, 0
    v_mov_b32 v11, 0
    v_mov_b32 v12, 0
    v_mov_b32 v13, 0
    v_mov_b32 v14, 0
    v_mov_b32 v15, 0
    v_mov_b32 v16, 0
    v_mov_b32 v17, 0
    v_mov_b32 v18, 0
    v_mov_b32 v19, 0
    v_mov_b32 v20, 0
    v_mov_b32 v21, 0
    v_mov_b32 v22, 0
    v_mov_b32 v23, 0
    v_mov_b32 v24, 0
    v_mov_b32 v25, 0
    v_mov_b32 v26, 0
    v_mov_b32 v27, 0
    v_mov_b32 v28, 0
    v_mov_b32 v29, 0
    v_mov_b32 v30, 0
    v_mov_b32 v31, 0
    v_mov_b32 v32, 0
    v_mov_b32 v33, 0
    v_mov_b32 v34, 0
    v_mov_b32 v35, 0
    v_mov_b32 v36, 0
    v_mov_b32 v37, 0
    v_mov_b32 v38, 0
    v_mov_b32 v39, 0
    v_mov_b32 v40, 0
    v_mov_b32 v41, 0
    v_mov_b32 v42, 0
    v_mov_b32 v43, 0
    v_mov_b32 v44, 0
    v_mov_b32 v45, 0
    v_mov_b32 v46, 0
    v_mov_b32 v47, 0
    v_mov_b32 v48, 0
    v_mov_b32 v49, 0
    v_mov_b32 v50, 0
    v_mov_b32 v51, 0
    v_mov_b32 v52, 0
    v_mov_b32 v53, 0
    v_mov_b32 v54, 0
    v_mov_b32 v55, 0
    s_cmp_eq_u32 s16, 0
    s_cselect_b32 s20, 3, 4
    s_cselect_b32 s21, 0, 1
    s_cselect_b32 s22, 2, 3
    s_cselect_b32 s23, 4, 0
    s_lshl_b32 s20, s20, 15
    s_lshl_b32 s21, s21, 15
    s_lshl_b32 s22, s22, 15
    s_lshl_b32 s23, s23, 15
    s_mov_b32 s24, 0
Lp2_219:
    v_add_u32 v185, s20, v184
    s_add_u32 s35, s24, 1
    s_add_u32 s52, s100, s35
    s_and_b32 s52, s52, 3
    s_mul_i32 s52, s52, 49152
    s_add_u32 s52, s52, s32
    s_barrier
    s_cmp_lg_u32 s24, 0
    s_cbranch_scc1 Lzf_220
    s_add_u32 s33, s101, 3
    s_and_b32 s33, s33, 7
    s_mul_i32 s33, s33, 6144
    s_add_u32 s19, s33, s46
    buffer_load_dwordx4 v[92:95], v188, s[8:11], s19 offen offset:0 sc1
    buffer_load_dwordx4 v[96:99], v188, s[8:11], s19 offen offset:1024 sc1
    buffer_load_dwordx4 v[100:103], v188, s[8:11], s19 offen offset:2048 sc1
    s_add_u32 s33, s101, 4
    s_and_b32 s33, s33, 7
    s_mul_i32 s33, s33, 6144
    s_add_u32 s19, s33, s46
    buffer_load_dwordx4 v[104:107], v188, s[8:11], s19 offen offset:0 sc1
    buffer_load_dwordx4 v[108:111], v188, s[8:11], s19 offen offset:1024 sc1
    buffer_load_dwordx4 v[112:115], v188, s[8:11], s19 offen offset:2048 sc1
    s_add_u32 s33, s101, 5
    s_and_b32 s33, s33, 7
    s_mul_i32 s33, s33, 6144
    s_add_u32 s19, s33, s46
    buffer_load_dwordx4 v[116:119], v188, s[8:11], s19 offen offset:0 sc1
    buffer_load_dwordx4 v[120:123], v188, s[8:11], s19 offen offset:1024 sc1
    buffer_load_dwordx4 v[124:127], v188, s[8:11], s19 offen offset:2048 sc1
    s_add_u32 s33, s101, 6
    s_and_b32 s33, s33, 7
    s_mul_i32 s33, s33, 6144
    s_add_u32 s19, s33, s46
    buffer_load_dwordx4 v[128:131], v188, s[8:11], s19 offen offset:0 sc1
    buffer_load_dwordx4 v[132:135], v188, s[8:11], s19 offen offset:1024 sc1
    buffer_load_dwordx4 v[136:139], v188, s[8:11], s19 offen offset:2048 sc1
    s_add_u32 s33, s101, 7
    s_and_b32 s33, s33, 7
    s_mul_i32 s33, s33, 6144
    s_add_u32 s19, s33, s46
    buffer_load_dwordx4 v[140:143], v188, s[8:11], s19 offen offset:0 sc1
    buffer_load_dwordx4 v[144:147], v188, s[8:11], s19 offen offset:1024 sc1
    buffer_load_dwordx4 v[148:151], v188, s[8:11], s19 offen offset:2048 sc1
Lzf_220:
    s_add_u32 s47, s101, 0
    s_and_b32 s47, s47, 7
    s_lshl_b32 s47, s47, 6
    v_xor_b32 v186, s47, v185
    ds_read_b128 v[152:155], v186 offset:0
    ds_read_b128 v[156:159], v186 offset:8192
    ds_read_b128 v[160:163], v186 offset:16384
    ds_read_b128 v[164:167], v186 offset:24576
    s_waitcnt vmcnt(21) lgkmcnt(0)
    v_max3_u32 v2, v56, v58, v60
    v_max3_u32 v3, v62, v64, v66
    v_max_u32 v2, v2, v3
    v_cmp_eq_u32 vcc, -1, v2
    s_nop 1
    s_cmp_eq_u64 vcc, 0
    s_cbranch_scc1 Lzok_221
    s_mov_b32 s35, 0
Lzrl_222:
    s_add_u32 s33, s101, 0
    s_and_b32 s33, s33, 7
    s_mul_i32 s33, s33, 6144
    s_add_u32 s34, s33, s46
    buffer_load_dwordx4 v[56:59], v188, s[8:11], s34 offen offset:0 sc1
    buffer_load_dwordx4 v[60:63], v188, s[8:11], s34 offen offset:1024 sc1
    buffer_load_dwordx4 v[64:67], v188, s[8:11], s34 offen offset:2048 sc1
    s_waitcnt vmcnt(0)
    v_max3_u32 v2, v56, v58, v60
    v_max3_u32 v3, v62, v64, v66
    v_max_u32 v2, v2, v3
    v_cmp_eq_u32 vcc, -1, v2
    s_nop 1
    s_cmp_eq_u64 vcc, 0
    s_cbranch_scc1 Lzok_221
    s_add_u32 s35, s35, 1
    s_cmp_gt_u32 s35, s99
    s_cbranch_scc0 Lzrl_222
    s_mov_b32 s99, 0
Lzok_221:
    s_add_u32 s47, s101, 1
    s_and_b32 s47, s47, 7
    s_lshl_b32 s47, s47, 6
    v_xor_b32 v187, s47, v185
    s_add_u32 s33, s101, 0
    s_and_b32 s33, s33, 7
    s_mul_i32 s33, s33, 6144
    s_add_u32 s19, s33, s52
    v_mfma_f32_16x16x32_bf16 v[8:11], v[56:59], v[152:155], v[8:11]
    ds_read_b128 v[168:171], v187 offset:0
    v_mfma_f32_16x16x32_bf16 v[12:15], v[56:59], v[156:159], v[12:15]
    ds_read_b128 v[172:175], v187 offset:8192
    v_mfma_f32_16x16x32_bf16 v[16:19], v[56:59], v[160:163], v[16:19]
    ds_read_b128 v[176:179], v187 offset:16384
    v_mfma_f32_16x16x32_bf16 v[20:23], v[56:59], v[164:167], v[20:23]
    ds_read_b128 v[180:183], v187 offset:24576
    buffer_load_dwordx4 v[56:59], v188, s[8:11], s19 offen offset:0 sc1
    v_mfma_f32_16x16x32_bf16 v[24:27], v[60:63], v[152:155], v[24:27]
    v_mfma_f32_16x16x32_bf16 v[28:31], v[60:63], v[156:159], v[28:31]
    v_mfma_f32_16x16x32_bf16 v[32:35], v[60:63], v[160:163], v[32:35]
    v_mfma_f32_16x16x32_bf16 v[36:39], v[60:63], v[164:167], v[36:39]
    buffer_load_dwordx4 v[60:63], v188, s[8:11], s19 offen offset:1024 sc1
    v_mfma_f32_16x16x32_bf16 v[40:43], v[64:67], v[152:155], v[40:43]
    v_mfma_f32_16x16x32_bf16 v[44:47], v[64:67], v[156:159], v[44:47]
    v_mfma_f32_16x16x32_bf16 v[48:51], v[64:67], v[160:163], v[48:51]
    v_mfma_f32_16x16x32_bf16 v[52:55], v[64:67], v[164:167], v[52:55]
    buffer_load_dwordx4 v[64:67], v188, s[8:11], s19 offen offset:2048 sc1
    s_waitcnt vmcnt(21) lgkmcnt(0)
    v_max3_u32 v2, v68, v70, v72
    v_max3_u32 v3, v74, v76, v78
    v_max_u32 v2, v2, v3
    v_cmp_eq_u32 vcc, -1, v2
    s_nop 1
    s_cmp_eq_u64 vcc, 0
    s_cbranch_scc1 Lzok_223
    s_mov_b32 s35, 0
Lzrl_224:
    s_add_u32 s33, s101, 1
    s_and_b32 s33, s33, 7
    s_mul_i32 s33, s33, 6144
    s_add_u32 s34, s33, s46
    buffer_load_dwordx4 v[68:71], v188, s[8:11], s34 offen offset:0 sc1
    buffer_load_dwordx4 v[72:75], v188, s[8:11], s34 offen offset:1024 sc1
    buffer_load_dwordx4 v[76:79], v188, s[8:11], s34 offen offset:2048 sc1
    s_waitcnt vmcnt(0)
    v_max3_u32 v2, v68, v70, v72
    v_max3_u32 v3, v74, v76, v78
    v_max_u32 v2, v2, v3
    v_cmp_eq_u32 vcc, -1, v2
    s_nop 1
    s_cmp_eq_u64 vcc, 0
    s_cbranch_scc1 Lzok_223
    s_add_u32 s35, s35, 1
    s_cmp_gt_u32 s35, s99
    s_cbranch_scc0 Lzrl_224
    s_mov_b32 s99, 0
Lzok_223:
    s_add_u32 s47, s101, 2
    s_and_b32 s47, s47, 7
    s_lshl_b32 s47, s47, 6
    v_xor_b32 v186, s47, v185
    s_add_u32 s33, s101, 1
    s_and_b32 s33, s33, 7
    s_mul_i32 s33, s33, 6144
    s_add_u32 s19, s33, s52
    v_mfma_f32_16x16x32_bf16 v[8:11], v[68:71], v[168:171], v[8:11]
    ds_read_b128 v[152:155], v186 offset:0
    v_mfma_f32_16x16x32_bf16 v[12:15], v[68:71], v[172:175], v[12:15]
    ds_read_b128 v[156:159], v186 offset:8192
    v_mfma_f32_16x16x32_bf16 v[16:19], v[68:71], v[176:179], v[16:19]
    ds_read_b128 v[160:163], v186 offset:16384
    v_mfma_f32_16x16x32_bf16 v[20:23], v[68:71], v[180:183], v[20:23]
    ds_read_b128 v[164:167], v186 offset:24576
    buffer_load_dwordx4 v[68:71], v188, s[8:11], s19 offen offset:0 sc1
    v_mfma_f32_16x16x32_bf16 v[24:27], v[72:75], v[168:171], v[24:27]
    v_mfma_f32_16x16x32_bf16 v[28:31], v[72:75], v[172:175], v[28:31]
    v_mfma_f32_16x16x32_bf16 v[32:35], v[72:75], v[176:179], v[32:35]
    v_mfma_f32_16x16x32_bf16 v[36:39], v[72:75], v[180:183], v[36:39]
    buffer_load_dwordx4 v[72:75], v188, s[8:11], s19 offen offset:1024 sc1
    v_mfma_f32_16x16x32_bf16 v[40:43], v[76:79], v[168:171], v[40:43]
    v_mfma_f32_16x16x32_bf16 v[44:47], v[76:79], v[172:175], v[44:47]
    v_mfma_f32_16x16x32_bf16 v[48:51], v[76:79], v[176:179], v[48:51]
    v_mfma_f32_16x16x32_bf16 v[52:55], v[76:79], v[180:183], v[52:55]
    buffer_load_dwordx4 v[76:79], v188, s[8:11], s19 offen offset:2048 sc1
    s_waitcnt vmcnt(21) lgkmcnt(0)
    v_max3_u32 v2, v80, v82, v84
    v_max3_u32 v3, v86, v88, v90
    v_max_u32 v2, v2, v3
    v_cmp_eq_u32 vcc, -1, v2
    s_nop 1
    s_cmp_eq_u64 vcc, 0
    s_cbranch_scc1 Lzok_225
    s_mov_b32 s35, 0
Lzrl_226:
    s_add_u32 s33, s101, 2
    s_and_b32 s33, s33, 7
    s_mul_i32 s33, s33, 6144
    s_add_u32 s34, s33, s46
    buffer_load_dwordx4 v[80:83], v188, s[8:11], s34 offen offset:0 sc1
    buffer_load_dwordx4 v[84:87], v188, s[8:11], s34 offen offset:1024 sc1
    buffer_load_dwordx4 v[88:91], v188, s[8:11], s34 offen offset:2048 sc1
    s_waitcnt vmcnt(0)
    v_max3_u32 v2, v80, v82, v84
    v_max3_u32 v3, v86, v88, v90
    v_max_u32 v2, v2, v3
    v_cmp_eq_u32 vcc, -1, v2
    s_nop 1
    s_cmp_eq_u64 vcc, 0
    s_cbranch_scc1 Lzok_225
    s_add_u32 s35, s35, 1
    s_cmp_gt_u32 s35, s99
    s_cbranch_scc0 Lzrl_226
    s_mov_b32 s99, 0
Lzok_225:
    s_add_u32 s47, s101, 3
    s_and_b32 s47, s47, 7
    s_lshl_b32 s47, s47, 6
    v_xor_b32 v187, s47, v185
    s_add_u32 s33, s101, 2
    s_and_b32 s33, s33, 7
    s_mul_i32 s33, s33, 6144
    s_add_u32 s19, s33, s52
    v_mfma_f32_16x16x32_bf16 v[8:11], v[80:83], v[152:155], v[8:11]
    ds_read_b128 v[168:171], v187 offset:0
    v_mfma_f32_16x16x32_bf16 v[12:15], v[80:83], v[156:159], v[12:15]
    ds_read_b128 v[172:175], v187 offset:8192
    v_mfma_f32_16x16x32_bf16 v[16:19], v[80:83], v[160:163], v[16:19]
    ds_read_b128 v[176:179], v187 offset:16384
    v_mfma_f32_16x16x32_bf16 v[20:23], v[80:83], v[164:167], v[20:23]
    ds_read_b128 v[180:183], v187 offset:24576
    buffer_load_dwordx4 v[80:83], v188, s[8:11], s19 offen offset:0 sc1
    v_mfma_f32_16x16x32_bf16 v[24:27], v[84:87], v[152:155], v[24:27]
    v_mfma_f32_16x16x32_bf16 v[28:31], v[84:87], v[156:159], v[28:31]
    v_mfma_f32_16x16x32_bf16 v[32:35], v[84:87], v[160:163], v[32:35]
    v_mfma_f32_16x16x32_bf16 v[36:39], v[84:87], v[164:167], v[36:39]
    buffer_load_dwordx4 v[84:87], v188, s[8:11], s19 offen offset:1024 sc1
    v_mfma_f32_16x16x32_bf16 v[40:43], v[88:91], v[152:155], v[40:43]
    v_mfma_f32_16x16x32_bf16 v[44:47], v[88:91], v[156:159], v[44:47]
    v_mfma_f32_16x16x32_bf16 v[48:51], v[88:91], v[160:163], v[48:51]
    v_mfma_f32_16x16x32_bf16 v[52:55], v[88:91], v[164:167], v[52:55]
    buffer_load_dwordx4 v[88:91], v188, s[8:11], s19 offen offset:2048 sc1
    s_waitcnt vmcnt(21) lgkmcnt(0)
    v_max3_u32 v2, v92, v94, v96
    v_max3_u32 v3, v98, v100, v102
    v_max_u32 v2, v2, v3
    v_cmp_eq_u32 vcc, -1, v2
    s_nop 1
    s_cmp_eq_u64 vcc, 0
    s_cbranch_scc1 Lzok_227
    s_mov_b32 s35, 0
Lzrl_228:
    s_add_u32 s33, s101, 3
    s_and_b32 s33, s33, 7
    s_mul_i32 s33, s33, 6144
    s_add_u32 s34, s33, s46
    buffer_load_dwordx4 v[92:95], v188, s[8:11], s34 offen offset:0 sc1
    buffer_load_dwordx4 v[96:99], v188, s[8:11], s34 offen offset:1024 sc1
    buffer_load_dwordx4 v[100:103], v188, s[8:11], s34 offen offset:2048 sc1
    s_waitcnt vmcnt(0)
    v_max3_u32 v2, v92, v94, v96
    v_max3_u32 v3, v98, v100, v102
    v_max_u32 v2, v2, v3
    v_cmp_eq_u32 vcc, -1, v2
    s_nop 1
    s_cmp_eq_u64 vcc, 0
    s_cbranch_scc1 Lzok_227
    s_add_u32 s35, s35, 1
    s_cmp_gt_u32 s35, s99
    s_cbranch_scc0 Lzrl_228
    s_mov_b32 s99, 0
Lzok_227:
    s_add_u32 s47, s101, 4
    s_and_b32 s47, s47, 7
    s_lshl_b32 s47, s47, 6
    v_xor_b32 v186, s47, v185
    s_add_u32 s33, s101, 3
    s_and_b32 s33, s33, 7
    s_mul_i32 s33, s33, 6144
    s_add_u32 s19, s33, s52
    v_mfma_f32_16x16x32_bf16 v[8:11], v[92:95], v[168:171], v[8:11]
    ds_read_b128 v[152:155], v186 offset:0
    v_mfma_f32_16x16x32_bf16 v[12:15], v[92:95], v[172:175], v[12:15]
    ds_read_b128 v[156:159], v186 offset:8192
    v_mfma_f32_16x16x32_bf16 v[16:19], v[92:95], v[176:179], v[16:19]
    ds_read_b128 v[160:163], v186 offset:16384
    v_mfma_f32_16x16x32_bf16 v[20:23], v[92:95], v[180:183], v[20:23]
    ds_read_b128 v[164:167], v186 offset:24576
    buffer_load_dwordx4 v[92:95], v188, s[8:11], s19 offen offset:0 sc1
    v_mfma_f32_16x16x32_bf16 v[24:27], v[96:99], v[168:171], v[24:27]
    v_mfma_f32_16x16x32_bf16 v[28:31], v[96:99], v[172:175], v[28:31]
    v_mfma_f32_16x16x32_bf16 v[32:35], v[96:99], v[176:179], v[32:35]
    v_mfma_f32_16x16x32_bf16 v[36:39], v[96:99], v[180:183], v[36:39]
    buffer_load_dwordx4 v[96:99], v188, s[8:11], s19 offen offset:1024 sc1
    v_mfma_f32_16x16x32_bf16 v[40:43], v[100:103], v[168:171], v[40:43]
    v_mfma_f32_16x16x32_bf16 v[44:47], v[100:103], v[172:175], v[44:47]
    v_mfma_f32_16x16x32_bf16 v[48:51], v[100:103], v[176:179], v[48:51]
    v_mfma_f32_16x16x32_bf16 v[52:55], v[100:103], v[180:183], v[52:55]
    buffer_load_dwordx4 v[100:103], v188, s[8:11], s19 offen offset:2048 sc1
    s_waitcnt vmcnt(21) lgkmcnt(0)
    v_max3_u32 v2, v104, v106, v108
    v_max3_u32 v3, v110, v112, v114
    v_max_u32 v2, v2, v3
    v_cmp_eq_u32 vcc, -1, v2
    s_nop 1
    s_cmp_eq_u64 vcc, 0
    s_cbranch_scc1 Lzok_229
    s_mov_b32 s35, 0
Lzrl_230:
    s_add_u32 s33, s101, 4
    s_and_b32 s33, s33, 7
    s_mul_i32 s33, s33, 6144
    s_add_u32 s34, s33, s46
    buffer_load_dwordx4 v[104:107], v188, s[8:11], s34 offen offset:0 sc1
    buffer_load_dwordx4 v[108:111], v188, s[8:11], s34 offen offset:1024 sc1
    buffer_load_dwordx4 v[112:115], v188, s[8:11], s34 offen offset:2048 sc1
    s_waitcnt vmcnt(0)
    v_max3_u32 v2, v104, v106, v108
    v_max3_u32 v3, v110, v112, v114
    v_max_u32 v2, v2, v3
    v_cmp_eq_u32 vcc, -1, v2
    s_nop 1
    s_cmp_eq_u64 vcc, 0
    s_cbranch_scc1 Lzok_229
    s_add_u32 s35, s35, 1
    s_cmp_gt_u32 s35, s99
    s_cbranch_scc0 Lzrl_230
    s_mov_b32 s99, 0
Lzok_229:
    s_add_u32 s47, s101, 5
    s_and_b32 s47, s47, 7
    s_lshl_b32 s47, s47, 6
    v_xor_b32 v187, s47, v185
    s_add_u32 s33, s101, 4
    s_and_b32 s33, s33, 7
    s_mul_i32 s33, s33, 6144
    s_add_u32 s19, s33, s52
    v_mfma_f32_16x16x32_bf16 v[8:11], v[104:107], v[152:155], v[8:11]
    ds_read_b128 v[168:171], v187 offset:0
    v_mfma_f32_16x16x32_bf16 v[12:15], v[104:107], v[156:159], v[12:15]
    ds_read_b128 v[172:175], v187 offset:8192
    v_mfma_f32_16x16x32_bf16 v[16:19], v[104:107], v[160:163], v[16:19]
    ds_read_b128 v[176:179], v187 offset:16384
    v_mfma_f32_16x16x32_bf16 v[20:23], v[104:107], v[164:167], v[20:23]
    ds_read_b128 v[180:183], v187 offset:24576
    buffer_load_dwordx4 v[104:107], v188, s[8:11], s19 offen offset:0 sc1
    v_mfma_f32_16x16x32_bf16 v[24:27], v[108:111], v[152:155], v[24:27]
    v_mfma_f32_16x16x32_bf16 v[28:31], v[108:111], v[156:159], v[28:31]
    v_mfma_f32_16x16x32_bf16 v[32:35], v[108:111], v[160:163], v[32:35]
    v_mfma_f32_16x16x32_bf16 v[36:39], v[108:111], v[164:167], v[36:39]
    buffer_load_dwordx4 v[108:111], v188, s[8:11], s19 offen offset:1024 sc1
    v_mfma_f32_16x16x32_bf16 v[40:43], v[112:115], v[152:155], v[40:43]
    v_mfma_f32_16x16x32_bf16 v[44:47], v[112:115], v[156:159], v[44:47]
    v_mfma_f32_16x16x32_bf16 v[48:51], v[112:115], v[160:163], v[48:51]
    v_mfma_f32_16x16x32_bf16 v[52:55], v[112:115], v[164:167], v[52:55]
    buffer_load_dwordx4 v[112:115], v188, s[8:11], s19 offen offset:2048 sc1
    s_waitcnt vmcnt(21) lgkmcnt(0)
    v_max3_u32 v2, v116, v118, v120
    v_max3_u32 v3, v122, v124, v126
    v_max_u32 v2, v2, v3
    v_cmp_eq_u32 vcc, -1, v2
    s_nop 1
    s_cmp_eq_u64 vcc, 0
    s_cbranch_scc1 Lzok_231
    s_mov_b32 s35, 0
Lzrl_232:
    s_add_u32 s33, s101, 5
    s_and_b32 s33, s33, 7
    s_mul_i32 s33, s33, 6144
    s_add_u32 s34, s33, s46
    buffer_load_dwordx4 v[116:119], v188, s[8:11], s34 offen offset:0 sc1
    buffer_load_dwordx4 v[120:123], v188, s[8:11], s34 offen offset:1024 sc1
    buffer_load_dwordx4 v[124:127], v188, s[8:11], s34 offen offset:2048 sc1
    s_waitcnt vmcnt(0)
    v_max3_u32 v2, v116, v118, v120
    v_max3_u32 v3, v122, v124, v126
    v_max_u32 v2, v2, v3
    v_cmp_eq_u32 vcc, -1, v2
    s_nop 1
    s_cmp_eq_u64 vcc, 0
    s_cbranch_scc1 Lzok_231
    s_add_u32 s35, s35, 1
    s_cmp_gt_u32 s35, s99
    s_cbranch_scc0 Lzrl_232
    s_mov_b32 s99, 0
Lzok_231:
    s_add_u32 s47, s101, 6
    s_and_b32 s47, s47, 7
    s_lshl_b32 s47, s47, 6
    v_xor_b32 v186, s47, v185
    s_add_u32 s33, s101, 5
    s_and_b32 s33, s33, 7
    s_mul_i32 s33, s33, 6144
    s_add_u32 s19, s33, s52
    v_mfma_f32_16x16x32_bf16 v[8:11], v[116:119], v[168:171], v[8:11]
    ds_read_b128 v[152:155], v186 offset:0
    v_mfma_f32_16x16x32_bf16 v[12:15], v[116:119], v[172:175], v[12:15]
    ds_read_b128 v[156:159], v186 offset:8192
    v_mfma_f32_16x16x32_bf16 v[16:19], v[116:119], v[176:179], v[16:19]
    ds_read_b128 v[160:163], v186 offset:16384
    v_mfma_f32_16x16x32_bf16 v[20:23], v[116:119], v[180:183], v[20:23]
    ds_read_b128 v[164:167], v186 offset:24576
    buffer_load_dwordx4 v[116:119], v188, s[8:11], s19 offen offset:0 sc1
    v_mfma_f32_16x16x32_bf16 v[24:27], v[120:123], v[168:171], v[24:27]
    v_mfma_f32_16x16x32_bf16 v[28:31], v[120:123], v[172:175], v[28:31]
    v_mfma_f32_16x16x32_bf16 v[32:35], v[120:123], v[176:179], v[32:35]
    v_mfma_f32_16x16x32_bf16 v[36:39], v[120:123], v[180:183], v[36:39]
    buffer_load_dwordx4 v[120:123], v188, s[8:11], s19 offen offset:1024 sc1
    v_mfma_f32_16x16x32_bf16 v[40:43], v[124:127], v[168:171], v[40:43]
    v_mfma_f32_16x16x32_bf16 v[44:47], v[124:127], v[172:175], v[44:47]
    v_mfma_f32_16x16x32_bf16 v[48:51], v[124:127], v[176:179], v[48:51]
    v_mfma_f32_16x16x32_bf16 v[52:55], v[124:127], v[180:183], v[52:55]
    buffer_load_dwordx4 v[124:127], v188, s[8:11], s19 offen offset:2048 sc1
    s_waitcnt vmcnt(21) lgkmcnt(0)
    v_max3_u32 v2, v128, v130, v132
    v_max3_u32 v3, v134, v136, v138
    v_max_u32 v2, v2, v3
    v_cmp_eq_u32 vcc, -1, v2
    s_nop 1
    s_cmp_eq_u64 vcc, 0
    s_cbranch_scc1 Lzok_233
    s_mov_b32 s35, 0
Lzrl_234:
    s_add_u32 s33, s101, 6
    s_and_b32 s33, s33, 7
    s_mul_i32 s33, s33, 6144
    s_add_u32 s34, s33, s46
    buffer_load_dwordx4 v[128:131], v188, s[8:11], s34 offen offset:0 sc1
    buffer_load_dwordx4 v[132:135], v188, s[8:11], s34 offen offset:1024 sc1
    buffer_load_dwordx4 v[136:139], v188, s[8:11], s34 offen offset:2048 sc1
    s_waitcnt vmcnt(0)
    v_max3_u32 v2, v128, v130, v132
    v_max3_u32 v3, v134, v136, v138
    v_max_u32 v2, v2, v3
    v_cmp_eq_u32 vcc, -1, v2
    s_nop 1
    s_cmp_eq_u64 vcc, 0
    s_cbranch_scc1 Lzok_233
    s_add_u32 s35, s35, 1
    s_cmp_gt_u32 s35, s99
    s_cbranch_scc0 Lzrl_234
    s_mov_b32 s99, 0
Lzok_233:
    s_add_u32 s47, s101, 7
    s_and_b32 s47, s47, 7
    s_lshl_b32 s47, s47, 6
    v_xor_b32 v187, s47, v185
    s_add_u32 s33, s101, 6
    s_and_b32 s33, s33, 7
    s_mul_i32 s33, s33, 6144
    s_add_u32 s19, s33, s52
    v_mfma_f32_16x16x32_bf16 v[8:11], v[128:131], v[152:155], v[8:11]
    ds_read_b128 v[168:171], v187 offset:0
    v_mfma_f32_16x16x32_bf16 v[12:15], v[128:131], v[156:159], v[12:15]
    ds_read_b128 v[172:175], v187 offset:8192
    v_mfma_f32_16x16x32_bf16 v[16:19], v[128:131], v[160:163], v[16:19]
    ds_read_b128 v[176:179], v187 offset:16384
    v_mfma_f32_16x16x32_bf16 v[20:23], v[128:131], v[164:167], v[20:23]
    ds_read_b128 v[180:183], v187 offset:24576
    buffer_load_dwordx4 v[128:131], v188, s[8:11], s19 offen offset:0 sc1
    v_mfma_f32_16x16x32_bf16 v[24:27], v[132:135], v[152:155], v[24:27]
    v_mfma_f32_16x16x32_bf16 v[28:31], v[132:135], v[156:159], v[28:31]
    v_mfma_f32_16x16x32_bf16 v[32:35], v[132:135], v[160:163], v[32:35]
    v_mfma_f32_16x16x32_bf16 v[36:39], v[132:135], v[164:167], v[36:39]
    buffer_load_dwordx4 v[132:135], v188, s[8:11], s19 offen offset:1024 sc1
    v_mfma_f32_16x16x32_bf16 v[40:43], v[136:139], v[152:155], v[40:43]
    v_mfma_f32_16x16x32_bf16 v[44:47], v[136:139], v[156:159], v[44:47]
    v_mfma_f32_16x16x32_bf16 v[48:51], v[136:139], v[160:163], v[48:51]
    v_mfma_f32_16x16x32_bf16 v[52:55], v[136:139], v[164:167], v[52:55]
    buffer_load_dwordx4 v[136:139], v188, s[8:11], s19 offen offset:2048 sc1
    s_waitcnt vmcnt(21) lgkmcnt(0)
    v_max3_u32 v2, v140, v142, v144
    v_max3_u32 v3, v146, v148, v150
    v_max_u32 v2, v2, v3
    v_cmp_eq_u32 vcc, -1, v2
    s_nop 1
    s_cmp_eq_u64 vcc, 0
    s_cbranch_scc1 Lzok_235
    s_mov_b32 s35, 0
Lzrl_236:
    s_add_u32 s33, s101, 7
    s_and_b32 s33, s33, 7
    s_mul_i32 s33, s33, 6144
    s_add_u32 s34, s33, s46
    buffer_load_dwordx4 v[140:143], v188, s[8:11], s34 offen offset:0 sc1
    buffer_load_dwordx4 v[144:147], v188, s[8:11], s34 offen offset:1024 sc1
    buffer_load_dwordx4 v[148:151], v188, s[8:11], s34 offen offset:2048 sc1
    s_waitcnt vmcnt(0)
    v_max3_u32 v2, v140, v142, v144
    v_max3_u32 v3, v146, v148, v150
    v_max_u32 v2, v2, v3
    v_cmp_eq_u32 vcc, -1, v2
    s_nop 1
    s_cmp_eq_u64 vcc, 0
    s_cbranch_scc1 Lzok_235
    s_add_u32 s35, s35, 1
    s_cmp_gt_u32 s35, s99
    s_cbranch_scc0 Lzrl_236
    s_mov_b32 s99, 0
Lzok_235:
    s_add_u32 s33, s101, 7
    s_and_b32 s33, s33, 7
    s_mul_i32 s33, s33, 6144
    s_add_u32 s19, s33, s52
    v_mfma_f32_16x16x32_bf16 v[8:11], v[140:143], v[168:171], v[8:11]
    v_mfma_f32_16x16x32_bf16 v[12:15], v[140:143], v[172:175], v[12:15]
    v_mfma_f32_16x16x32_bf16 v[16:19], v[140:143], v[176:179], v[16:19]
    v_mfma_f32_16x16x32_bf16 v[20:23], v[140:143], v[180:183], v[20:23]
    buffer_load_dwordx4 v[140:143], v188, s[8:11], s19 offen offset:0 sc1
    v_mfma_f32_16x16x32_bf16 v[24:27], v[144:147], v[168:171], v[24:27]
    v_mfma_f32_16x16x32_bf16 v[28:31], v[144:147], v[172:175], v[28:31]
    v_mfma_f32_16x16x32_bf16 v[32:35], v[144:147], v[176:179], v[32:35]
    v_mfma_f32_16x16x32_bf16 v[36:39], v[144:147], v[180:183], v[36:39]
    buffer_load_dwordx4 v[144:147], v188, s[8:11], s19 offen offset:1024 sc1
    v_mfma_f32_16x16x32_bf16 v[40:43], v[148:151], v[168:171], v[40:43]
    v_mfma_f32_16x16x32_bf16 v[44:47], v[148:151], v[172:175], v[44:47]
    v_mfma_f32_16x16x32_bf16 v[48:51], v[148:151], v[176:179], v[48:51]
    v_mfma_f32_16x16x32_bf16 v[52:55], v[148:151], v[180:183], v[52:55]
    buffer_load_dwordx4 v[148:151], v188, s[8:11], s19 offen offset:2048 sc1
    s_mov_b32 s20, s21
    s_mov_b32 s21, s22
    s_mov_b32 s22, s23
    s_mov_b32 s46, s52
    s_add_u32 s24, s24, 1
    s_cmp_lt_u32 s24, 3
    s_cbranch_scc1 Lp2_219
    v_add_u32 v185, s20, v184
    s_barrier
    s_lshl_b32 s26, s4, 3
    s_add_u32 s26, s26, s5
    s_lshl_b32 s26, s26, 2
    s_lshl_b32 s27, s17, 1
    s_add_u32 s26, s26, s27
    s_add_u32 s26, s26, s16
    s_mul_i32 s26, s26, 3072
    s_add_u32 s12, s58, 6291456
    s_addc_u32 s13, s59, 0
    s_add_u32 s12, s12, s26
    s_addc_u32 s13, s13, 0
    s_mov_b32 s14, 3072
    s_mov_b32 s15, 0x00020000
    buffer_load_dwordx4 v[192:195], v188, s[12:15], 0 offen offset:0 sc1
    buffer_load_dwordx4 v[196:199], v188, s[12:15], 0 offen offset:1024 sc1
    buffer_load_dwordx4 v[200:203], v188, s[12:15], 0 offen offset:2048 sc1
    s_lshl_b32 s26, s4, 7
    s_lshl_b32 s27, s16, 6
    s_add_u32 s26, s26, s27
    s_mov_b32 s28, s48
    s_mov_b32 s29, s49
    s_add_u32 s28, s28, s26
    s_addc_u32 s29, s29, 0
    s_mov_b32 s30, 64
    s_mov_b32 s31, 0x00020000
    v_and_b32 v1, 15, v0
    v_lshlrev_b32 v2, 1, v1
    buffer_load_ushort v204, v2, s[28:31], 0 offen
    buffer_load_ushort v205, v2, s[28:31], 0 offen offset:32
    s_lshr_b32 s38, s3, 1
    s_and_b32 s39, s3, 1
    s_lshl_b32 s44, s4, 2
    s_lshl_b32 s45, s39, 1
    s_add_u32 s44, s44, s45
    s_mul_i32 s44, s44, 45056
    s_mov_b32 s40, s58
    s_mov_b32 s41, s59
    s_add_u32 s40, s40, s44
    s_addc_u32 s41, s41, 0
    s_mov_b32 s42, 90112
    s_mov_b32 s43, 0x00020000
    v_lshlrev_b32 v242, 4, v0
    s_lshl_b32 s44, s4, 8
    s_lshl_b32 s45, s39, 7
    s_add_u32 s44, s44, s45
    s_add_u32 s48, s58, 5767168
    s_addc_u32 s49, s59, 0
    s_add_u32 s48, s48, s44
    s_addc_u32 s49, s49, 0
    s_mov_b32 s50, 128
    s_mov_b32 s51, 0x00020000
    v_and_b32 v243, 15, v0
    v_lshlrev_b32 v243, 2, v243
    buffer_load_dword v240, v243, s[48:51], 0 offen sc1
    buffer_load_dword v241, v243, s[48:51], 0 offen offset:64 sc1
    s_lshl_b32 s44, s38, 11
    s_add_u32 s45, s44, 45056
    buffer_load_dwordx4 v[208:211], v242, s[40:43], s44 offen sc1
    buffer_load_dwordx4 v[212:215], v242, s[40:43], s45 offen sc1
    buffer_load_dwordx4 v[216:219], v242, s[40:43], s44 offen offset:1024 sc1
    buffer_load_dwordx4 v[220:223], v242, s[40:43], s45 offen offset:1024 sc1
    s_add_u32 s44, s44, 4096
    s_add_u32 s45, s45, 4096
    buffer_load_dwordx4 v[224:227], v242, s[40:43], s44 offen sc1
    buffer_load_dwordx4 v[228:231], v242, s[40:43], s45 offen sc1
    buffer_load_dwordx4 v[232:235], v242, s[40:43], s44 offen offset:1024 sc1
    buffer_load_dwordx4 v[236:239], v242, s[40:43], s45 offen offset:1024 sc1
    s_add_u32 s44, s44, 4096
    s_add_u32 s45, s45, 4096
    s_add_u32 s47, s101, 0
    s_and_b32 s47, s47, 7
    s_lshl_b32 s47, s47, 6
    v_xor_b32 v186, s47, v185
    ds_read_b128 v[152:155], v186 offset:0
    ds_read_b128 v[156:159], v186 offset:8192
    ds_read_b128 v[160:163], v186 offset:16384
    ds_read_b128 v[164:167], v186 offset:24576
    s_waitcnt vmcnt(36) lgkmcnt(0)
    v_max3_u32 v2, v56, v58, v60
    v_max3_u32 v3, v62, v64, v66
    v_max_u32 v2, v2, v3
    v_cmp_eq_u32 vcc, -1, v2
    s_nop 1
    s_cmp_eq_u64 vcc, 0
    s_cbranch_scc1 Lzok_237
    s_mov_b32 s35, 0
Lzrl_238:
    s_add_u32 s33, s101, 0
    s_and_b32 s33, s33, 7
    s_mul_i32 s33, s33, 6144
    s_add_u32 s34, s33, s46
    buffer_load_dwordx4 v[56:59], v188, s[8:11], s34 offen offset:0 sc1
    buffer_load_dwordx4 v[60:63], v188, s[8:11], s34 offen offset:1024 sc1
    buffer_load_dwordx4 v[64:67], v188, s[8:11], s34 offen offset:2048 sc1
    s_waitcnt vmcnt(0)
    v_max3_u32 v2, v56, v58, v60
    v_max3_u32 v3, v62, v64, v66
    v_max_u32 v2, v2, v3
    v_cmp_eq_u32 vcc, -1, v2
    s_nop 1
    s_cmp_eq_u64 vcc, 0
    s_cbranch_scc1 Lzok_237
    s_add_u32 s35, s35, 1
    s_cmp_gt_u32 s35, s99
    s_cbranch_scc0 Lzrl_238
    s_mov_b32 s99, 0
Lzok_237:
    s_add_u32 s47, s101, 1
    s_and_b32 s47, s47, 7
    s_lshl_b32 s47, s47, 6
    v_xor_b32 v187, s47, v185
    v_mfma_f32_16x16x32_bf16 v[8:11], v[56:59], v[152:155], v[8:11]
    ds_read_b128 v[168:171], v187 offset:0
    v_mfma_f32_16x16x32_bf16 v[12:15], v[56:59], v[156:159], v[12:15]
    ds_read_b128 v[172:175], v187 offset:8192
    v_mfma_f32_16x16x32_bf16 v[16:19], v[56:59], v[160:163], v[16:19]
    ds_read_b128 v[176:179], v187 offset:16384
    v_mfma_f32_16x16x32_bf16 v[20:23], v[56:59], v[164:167], v[20:23]
    ds_read_b128 v[180:183], v187 offset:24576
    v_mfma_f32_16x16x32_bf16 v[24:27], v[60:63], v[152:155], v[24:27]
    v_mfma_f32_16x16x32_bf16 v[28:31], v[60:63], v[156:159], v[28:31]
    v_mfma_f32_16x16x32_bf16 v[32:35], v[60:63], v[160:163], v[32:35]
    v_mfma_f32_16x16x32_bf16 v[36:39], v[60:63], v[164:167], v[36:39]
    v_mfma_f32_16x16x32_bf16 v[40:43], v[64:67], v[152:155], v[40:43]
    v_mfma_f32_16x16x32_bf16 v[44:47], v[64:67], v[156:159], v[44:47]
    v_mfma_f32_16x16x32_bf16 v[48:51], v[64:67], v[160:163], v[48:51]
    v_mfma_f32_16x16x32_bf16 v[52:55], v[64:67], v[164:167], v[52:55]
    s_waitcnt vmcnt(33) lgkmcnt(0)
    v_max3_u32 v2, v68, v70, v72
    v_max3_u32 v3, v74, v76, v78
    v_max_u32 v2, v2, v3
    v_cmp_eq_u32 vcc, -1, v2
    s_nop 1
    s_cmp_eq_u64 vcc, 0
    s_cbranch_scc1 Lzok_239
    s_mov_b32 s35, 0
Lzrl_240:
    s_add_u32 s33, s101, 1
    s_and_b32 s33, s33, 7
    s_mul_i32 s33, s33, 6144
    s_add_u32 s34, s33, s46
    buffer_load_dwordx4 v[68:71], v188, s[8:11], s34 offen offset:0 sc1
    buffer_load_dwordx4 v[72:75], v188, s[8:11], s34 offen offset:1024 sc1
    buffer_load_dwordx4 v[76:79], v188, s[8:11], s34 offen offset:2048 sc1
    s_waitcnt vmcnt(0)
    v_max3_u32 v2, v68, v70, v72
    v_max3_u32 v3, v74, v76, v78
    v_max_u32 v2, v2, v3
    v_cmp_eq_u32 vcc, -1, v2
    s_nop 1
    s_cmp_eq_u64 vcc, 0
    s_cbranch_scc1 Lzok_239
    s_add_u32 s35, s35, 1
    s_cmp_gt_u32 s35, s99
    s_cbranch_scc0 Lzrl_240
    s_mov_b32 s99, 0
Lzok_239:
    s_add_u32 s47, s101, 2
    s_and_b32 s47, s47, 7
    s_lshl_b32 s47, s47, 6
    v_xor_b32 v186, s47, v185
    v_mfma_f32_16x16x32_bf16 v[8:11], v[68:71], v[168:171], v[8:11]
    ds_read_b128 v[152:155], v186 offset:0
    v_mfma_f32_16x16x32_bf16 v[12:15], v[68:71], v[172:175], v[12:15]
    ds_read_b128 v[156:159], v186 offset:8192
    v_mfma_f32_16x16x32_bf16 v[16:19], v[68:71], v[176:179], v[16:19]
    ds_read_b128 v[160:163], v186 offset:16384
    v_mfma_f32_16x16x32_bf16 v[20:23], v[68:71], v[180:183], v[20:23]
    ds_read_b128 v[164:167], v186 offset:24576
    v_mfma_f32_16x16x32_bf16 v[24:27], v[72:75], v[168:171], v[24:27]
    v_mfma_f32_16x16x32_bf16 v[28:31], v[72:75], v[172:175], v[28:31]
    v_mfma_f32_16x16x32_bf16 v[32:35], v[72:75], v[176:179], v[32:35]
    v_mfma_f32_16x16x32_bf16 v[36:39], v[72:75], v[180:183], v[36:39]
    v_mfma_f32_16x16x32_bf16 v[40:43], v[76:79], v[168:171], v[40:43]
    v_mfma_f32_16x16x32_bf16 v[44:47], v[76:79], v[172:175], v[44:47]
    v_mfma_f32_16x16x32_bf16 v[48:51], v[76:79], v[176:179], v[48:51]
    v_mfma_f32_16x16x32_bf16 v[52:55], v[76:79], v[180:183], v[52:55]
    s_waitcnt vmcnt(30) lgkmcnt(0)
    v_max3_u32 v2, v80, v82, v84
    v_max3_u32 v3, v86, v88, v90
    v_max_u32 v2, v2, v3
    v_cmp_eq_u32 vcc, -1, v2
    s_nop 1
    s_cmp_eq_u64 vcc, 0
    s_cbranch_scc1 Lzok_241
    s_mov_b32 s35, 0
Lzrl_242:
    s_add_u32 s33, s101, 2
    s_and_b32 s33, s33, 7
    s_mul_i32 s33, s33, 6144
    s_add_u32 s34, s33, s46
    buffer_load_dwordx4 v[80:83], v188, s[8:11], s34 offen offset:0 sc1
    buffer_load_dwordx4 v[84:87], v188, s[8:11], s34 offen offset:1024 sc1
    buffer_load_dwordx4 v[88:91], v188, s[8:11], s34 offen offset:2048 sc1
    s_waitcnt vmcnt(0)
    v_max3_u32 v2, v80, v82, v84
    v_max3_u32 v3, v86, v88, v90
    v_max_u32 v2, v2, v3
    v_cmp_eq_u32 vcc, -1, v2
    s_nop 1
    s_cmp_eq_u64 vcc, 0
    s_cbranch_scc1 Lzok_241
    s_add_u32 s35, s35, 1
    s_cmp_gt_u32 s35, s99
    s_cbranch_scc0 Lzrl_242
    s_mov_b32 s99, 0
Lzok_241:
    s_add_u32 s47, s101, 3
    s_and_b32 s47, s47, 7
    s_lshl_b32 s47, s47, 6
    v_xor_b32 v187, s47, v185
    v_mfma_f32_16x16x32_bf16 v[8:11], v[80:83], v[152:155], v[8:11]
    ds_read_b128 v[168:171], v187 offset:0
    v_mfma_f32_16x16x32_bf16 v[12:15], v[80:83], v[156:159], v[12:15]
    ds_read_b128 v[172:175], v187 offset:8192
    v_mfma_f32_16x16x32_bf16 v[16:19], v[80:83], v[160:163], v[16:19]
    ds_read_b128 v[176:179], v187 offset:16384
    v_mfma_f32_16x16x32_bf16 v[20:23], v[80:83], v[164:167], v[20:23]
    ds_read_b128 v[180:183], v187 offset:24576
    v_mfma_f32_16x16x32_bf16 v[24:27], v[84:87], v[152:155], v[24:27]
    v_mfma_f32_16x16x32_bf16 v[28:31], v[84:87], v[156:159], v[28:31]
    v_mfma_f32_16x16x32_bf16 v[32:35], v[84:87], v[160:163], v[32:35]
    v_mfma_f32_16x16x32_bf16 v[36:39], v[84:87], v[164:167], v[36:39]
    v_mfma_f32_16x16x32_bf16 v[40:43], v[88:91], v[152:155], v[40:43]
    v_mfma_f32_16x16x32_bf16 v[44:47], v[88:91], v[156:159], v[44:47]
    v_mfma_f32_16x16x32_bf16 v[48:51], v[88:91], v[160:163], v[48:51]
    v_mfma_f32_16x16x32_bf16 v[52:55], v[88:91], v[164:167], v[52:55]
    s_waitcnt vmcnt(27) lgkmcnt(0)
    v_max3_u32 v2, v92, v94, v96
    v_max3_u32 v3, v98, v100, v102
    v_max_u32 v2, v2, v3
    v_cmp_eq_u32 vcc, -1, v2
    s_nop 1
    s_cmp_eq_u64 vcc, 0
    s_cbranch_scc1 Lzok_243
    s_mov_b32 s35, 0
Lzrl_244:
    s_add_u32 s33, s101, 3
    s_and_b32 s33, s33, 7
    s_mul_i32 s33, s33, 6144
    s_add_u32 s34, s33, s46
    buffer_load_dwordx4 v[92:95], v188, s[8:11], s34 offen offset:0 sc1
    buffer_load_dwordx4 v[96:99], v188, s[8:11], s34 offen offset:1024 sc1
    buffer_load_dwordx4 v[100:103], v188, s[8:11], s34 offen offset:2048 sc1
    s_waitcnt vmcnt(0)
    v_max3_u32 v2, v92, v94, v96
    v_max3_u32 v3, v98, v100, v102
    v_max_u32 v2, v2, v3
    v_cmp_eq_u32 vcc, -1, v2
    s_nop 1
    s_cmp_eq_u64 vcc, 0
    s_cbranch_scc1 Lzok_243
    s_add_u32 s35, s35, 1
    s_cmp_gt_u32 s35, s99
    s_cbranch_scc0 Lzrl_244
    s_mov_b32 s99, 0
Lzok_243:
    s_add_u32 s47, s101, 4
    s_and_b32 s47, s47, 7
    s_lshl_b32 s47, s47, 6
    v_xor_b32 v186, s47, v185
    v_mfma_f32_16x16x32_bf16 v[8:11], v[92:95], v[168:171], v[8:11]
    ds_read_b128 v[152:155], v186 offset:0
    v_mfma_f32_16x16x32_bf16 v[12:15], v[92:95], v[172:175], v[12:15]
    ds_read_b128 v[156:159], v186 offset:8192
    v_mfma_f32_16x16x32_bf16 v[16:19], v[92:95], v[176:179], v[16:19]
    ds_read_b128 v[160:163], v186 offset:16384
    v_mfma_f32_16x16x32_bf16 v[20:23], v[92:95], v[180:183], v[20:23]
    ds_read_b128 v[164:167], v186 offset:24576
    v_mfma_f32_16x16x32_bf16 v[24:27], v[96:99], v[168:171], v[24:27]
    v_mfma_f32_16x16x32_bf16 v[28:31], v[96:99], v[172:175], v[28:31]
    v_mfma_f32_16x16x32_bf16 v[32:35], v[96:99], v[176:179], v[32:35]
    v_mfma_f32_16x16x32_bf16 v[36:39], v[96:99], v[180:183], v[36:39]
    v_mfma_f32_16x16x32_bf16 v[40:43], v[100:103], v[168:171], v[40:43]
    v_mfma_f32_16x16x32_bf16 v[44:47], v[100:103], v[172:175], v[44:47]
    v_mfma_f32_16x16x32_bf16 v[48:51], v[100:103], v[176:179], v[48:51]
    v_mfma_f32_16x16x32_bf16 v[52:55], v[100:103], v[180:183], v[52:55]
    s_waitcnt vmcnt(24) lgkmcnt(0)
    v_max3_u32 v2, v104, v106, v108
    v_max3_u32 v3, v110, v112, v114
    v_max_u32 v2, v2, v3
    v_cmp_eq_u32 vcc, -1, v2
    s_nop 1
    s_cmp_eq_u64 vcc, 0
    s_cbranch_scc1 Lzok_245
    s_mov_b32 s35, 0
Lzrl_246:
    s_add_u32 s33, s101, 4
    s_and_b32 s33, s33, 7
    s_mul_i32 s33, s33, 6144
    s_add_u32 s34, s33, s46
    buffer_load_dwordx4 v[104:107], v188, s[8:11], s34 offen offset:0 sc1
    buffer_load_dwordx4 v[108:111], v188, s[8:11], s34 offen offset:1024 sc1
    buffer_load_dwordx4 v[112:115], v188, s[8:11], s34 offen offset:2048 sc1
    s_waitcnt vmcnt(0)
    v_max3_u32 v2, v104, v106, v108
    v_max3_u32 v3, v110, v112, v114
    v_max_u32 v2, v2, v3
    v_cmp_eq_u32 vcc, -1, v2
    s_nop 1
    s_cmp_eq_u64 vcc, 0
    s_cbranch_scc1 Lzok_245
    s_add_u32 s35, s35, 1
    s_cmp_gt_u32 s35, s99
    s_cbranch_scc0 Lzrl_246
    s_mov_b32 s99, 0
Lzok_245:
    s_add_u32 s47, s101, 5
    s_and_b32 s47, s47, 7
    s_lshl_b32 s47, s47, 6
    v_xor_b32 v187, s47, v185
    v_mfma_f32_16x16x32_bf16 v[8:11], v[104:107], v[152:155], v[8:11]
    ds_read_b128 v[168:171], v187 offset:0
    v_mfma_f32_16x16x32_bf16 v[12:15], v[104:107], v[156:159], v[12:15]
    ds_read_b128 v[172:175], v187 offset:8192
    v_mfma_f32_16x16x32_bf16 v[16:19], v[104:107], v[160:163], v[16:19]
    ds_read_b128 v[176:179], v187 offset:16384
    v_mfma_f32_16x16x32_bf16 v[20:23], v[104:107], v[164:167], v[20:23]
    ds_read_b128 v[180:183], v187 offset:24576
    v_mfma_f32_16x16x32_bf16 v[24:27], v[108:111], v[152:155], v[24:27]
    v_mfma_f32_16x16x32_bf16 v[28:31], v[108:111], v[156:159], v[28:31]
    v_mfma_f32_16x16x32_bf16 v[32:35], v[108:111], v[160:163], v[32:35]
    v_mfma_f32_16x16x32_bf16 v[36:39], v[108:111], v[164:167], v[36:39]
    v_mfma_f32_16x16x32_bf16 v[40:43], v[112:115], v[152:155], v[40:43]
    v_mfma_f32_16x16x32_bf16 v[44:47], v[112:115], v[156:159], v[44:47]
    v_mfma_f32_16x16x32_bf16 v[48:51], v[112:115], v[160:163], v[48:51]
    v_mfma_f32_16x16x32_bf16 v[52:55], v[112:115], v[164:167], v[52:55]
    s_waitcnt vmcnt(21) lgkmcnt(0)
    v_max3_u32 v2, v116, v118, v120
    v_max3_u32 v3, v122, v124, v126
    v_max_u32 v2, v2, v3
    v_cmp_eq_u32 vcc, -1, v2
    s_nop 1
    s_cmp_eq_u64 vcc, 0
    s_cbranch_scc1 Lzok_247
    s_mov_b32 s35, 0
Lzrl_248:
    s_add_u32 s33, s101, 5
    s_and_b32 s33, s33, 7
    s_mul_i32 s33, s33, 6144
    s_add_u32 s34, s33, s46
    buffer_load_dwordx4 v[116:119], v188, s[8:11], s34 offen offset:0 sc1
    buffer_load_dwordx4 v[120:123], v188, s[8:11], s34 offen offset:1024 sc1
    buffer_load_dwordx4 v[124:127], v188, s[8:11], s34 offen offset:2048 sc1
    s_waitcnt vmcnt(0)
    v_max3_u32 v2, v116, v118, v120
    v_max3_u32 v3, v122, v124, v126
    v_max_u32 v2, v2, v3
    v_cmp_eq_u32 vcc, -1, v2
    s_nop 1
    s_cmp_eq_u64 vcc, 0
    s_cbranch_scc1 Lzok_247
    s_add_u32 s35, s35, 1
    s_cmp_gt_u32 s35, s99
    s_cbranch_scc0 Lzrl_248
    s_mov_b32 s99, 0
Lzok_247:
    s_add_u32 s47, s101, 6
    s_and_b32 s47, s47, 7
    s_lshl_b32 s47, s47, 6
    v_xor_b32 v186, s47, v185
    v_mfma_f32_16x16x32_bf16 v[8:11], v[116:119], v[168:171], v[8:11]
    ds_read_b128 v[152:155], v186 offset:0
    v_mfma_f32_16x16x32_bf16 v[12:15], v[116:119], v[172:175], v[12:15]
    ds_read_b128 v[156:159], v186 offset:8192
    v_mfma_f32_16x16x32_bf16 v[16:19], v[116:119], v[176:179], v[16:19]
    ds_read_b128 v[160:163], v186 offset:16384
    v_mfma_f32_16x16x32_bf16 v[20:23], v[116:119], v[180:183], v[20:23]
    ds_read_b128 v[164:167], v186 offset:24576
    v_mfma_f32_16x16x32_bf16 v[24:27], v[120:123], v[168:171], v[24:27]
    v_mfma_f32_16x16x32_bf16 v[28:31], v[120:123], v[172:175], v[28:31]
    v_mfma_f32_16x16x32_bf16 v[32:35], v[120:123], v[176:179], v[32:35]
    v_mfma_f32_16x16x32_bf16 v[36:39], v[120:123], v[180:183], v[36:39]
    v_mfma_f32_16x16x32_bf16 v[40:43], v[124:127], v[168:171], v[40:43]
    v_mfma_f32_16x16x32_bf16 v[44:47], v[124:127], v[172:175], v[44:47]
    v_mfma_f32_16x16x32_bf16 v[48:51], v[124:127], v[176:179], v[48:51]
    v_mfma_f32_16x16x32_bf16 v[52:55], v[124:127], v[180:183], v[52:55]
    s_waitcnt vmcnt(18) lgkmcnt(0)
    v_max3_u32 v2, v128, v130, v132
    v_max3_u32 v3, v134, v136, v138
    v_max_u32 v2, v2, v3
    v_cmp_eq_u32 vcc, -1, v2
    s_nop 1
    s_cmp_eq_u64 vcc, 0
    s_cbranch_scc1 Lzok_249
    s_mov_b32 s35, 0
Lzrl_250:
    s_add_u32 s33, s101, 6
    s_and_b32 s33, s33, 7
    s_mul_i32 s33, s33, 6144
    s_add_u32 s34, s33, s46
    buffer_load_dwordx4 v[128:131], v188, s[8:11], s34 offen offset:0 sc1
    buffer_load_dwordx4 v[132:135], v188, s[8:11], s34 offen offset:1024 sc1
    buffer_load_dwordx4 v[136:139], v188, s[8:11], s34 offen offset:2048 sc1
    s_waitcnt vmcnt(0)
    v_max3_u32 v2, v128, v130, v132
    v_max3_u32 v3, v134, v136, v138
    v_max_u32 v2, v2, v3
    v_cmp_eq_u32 vcc, -1, v2
    s_nop 1
    s_cmp_eq_u64 vcc, 0
    s_cbranch_scc1 Lzok_249
    s_add_u32 s35, s35, 1
    s_cmp_gt_u32 s35, s99
    s_cbranch_scc0 Lzrl_250
    s_mov_b32 s99, 0
Lzok_249:
    s_add_u32 s47, s101, 7
    s_and_b32 s47, s47, 7
    s_lshl_b32 s47, s47, 6
    v_xor_b32 v187, s47, v185
    v_mfma_f32_16x16x32_bf16 v[8:11], v[128:131], v[152:155], v[8:11]
    ds_read_b128 v[168:171], v187 offset:0
    v_mfma_f32_16x16x32_bf16 v[12:15], v[128:131], v[156:159], v[12:15]
    ds_read_b128 v[172:175], v187 offset:8192
    v_mfma_f32_16x16x32_bf16 v[16:19], v[128:131], v[160:163], v[16:19]
    ds_read_b128 v[176:179], v187 offset:16384
    v_mfma_f32_16x16x32_bf16 v[20:23], v[128:131], v[164:167], v[20:23]
    ds_read_b128 v[180:183], v187 offset:24576
    v_mfma_f32_16x16x32_bf16 v[24:27], v[132:135], v[152:155], v[24:27]
    v_mfma_f32_16x16x32_bf16 v[28:31], v[132:135], v[156:159], v[28:31]
    v_mfma_f32_16x16x32_bf16 v[32:35], v[132:135], v[160:163], v[32:35]
    v_mfma_f32_16x16x32_bf16 v[36:39], v[132:135], v[164:167], v[36:39]
    v_mfma_f32_16x16x32_bf16 v[40:43], v[136:139], v[152:155], v[40:43]
    v_mfma_f32_16x16x32_bf16 v[44:47], v[136:139], v[156:159], v[44:47]
    v_mfma_f32_16x16x32_bf16 v[48:51], v[136:139], v[160:163], v[48:51]
    v_mfma_f32_16x16x32_bf16 v[52:55], v[136:139], v[164:167], v[52:55]
    s_waitcnt vmcnt(15) lgkmcnt(0)
    v_max3_u32 v2, v140, v142, v144
    v_max3_u32 v3, v146, v148, v150
    v_max_u32 v2, v2, v3
    v_cmp_eq_u32 vcc, -1, v2
    s_nop 1
    s_cmp_eq_u64 vcc, 0
    s_cbranch_scc1 Lzok_251
    s_mov_b32 s35, 0
Lzrl_252:
    s_add_u32 s33, s101, 7
    s_and_b32 s33, s33, 7
    s_mul_i32 s33, s33, 6144
    s_add_u32 s34, s33, s46
    buffer_load_dwordx4 v[140:143], v188, s[8:11], s34 offen offset:0 sc1
    buffer_load_dwordx4 v[144:147], v188, s[8:11], s34 offen offset:1024 sc1
    buffer_load_dwordx4 v[148:151], v188, s[8:11], s34 offen offset:2048 sc1
    s_waitcnt vmcnt(0)
    v_max3_u32 v2, v140, v142, v144
    v_max3_u32 v3, v146, v148, v150
    v_max_u32 v2, v2, v3
    v_cmp_eq_u32 vcc, -1, v2
    s_nop 1
    s_cmp_eq_u64 vcc, 0
    s_cbranch_scc1 Lzok_251
    s_add_u32 s35, s35, 1
    s_cmp_gt_u32 s35, s99
    s_cbranch_scc0 Lzrl_252
    s_mov_b32 s99, 0
Lzok_251:
    v_mfma_f32_16x16x32_bf16 v[8:11], v[140:143], v[168:171], v[8:11]
    v_mfma_f32_16x16x32_bf16 v[12:15], v[140:143], v[172:175], v[12:15]
    v_mfma_f32_16x16x32_bf16 v[16:19], v[140:143], v[176:179], v[16:19]
    v_mfma_f32_16x16x32_bf16 v[20:23], v[140:143], v[180:183], v[20:23]
    v_mfma_f32_16x16x32_bf16 v[24:27], v[144:147], v[168:171], v[24:27]
    v_mfma_f32_16x16x32_bf16 v[28:31], v[144:147], v[172:175], v[28:31]
    v_mfma_f32_16x16x32_bf16 v[32:35], v[144:147], v[176:179], v[32:35]
    v_mfma_f32_16x16x32_bf16 v[36:39], v[144:147], v[180:183], v[36:39]
    v_mfma_f32_16x16x32_bf16 v[40:43], v[148:151], v[168:171], v[40:43]
    v_mfma_f32_16x16x32_bf16 v[44:47], v[148:151], v[172:175], v[44:47]
    v_mfma_f32_16x16x32_bf16 v[48:51], v[148:151], v[176:179], v[48:51]
    v_mfma_f32_16x16x32_bf16 v[52:55], v[148:151], v[180:183], v[52:55]
    s_mul_i32 s18, s3, 6144
    s_add_u32 s18, s18, 98304
    v_add_u32 v3, s18, v188
    s_xor_b32 s25, s3, 2
    s_mul_i32 s25, s25, 6144
    s_add_u32 s25, s25, 98304
    v_add_u32 v4, s25, v188
    s_cmp_eq_u32 s16, 0
    s_cbranch_scc0 Lsnd1_253
    ds_write_b128 v3, v[16:19] offset:0
    ds_write_b128 v3, v[20:23] offset:1024
    ds_write_b128 v3, v[32:35] offset:2048
    ds_write_b128 v3, v[36:39] offset:3072
    ds_write_b128 v3, v[48:51] offset:4096
    ds_write_b128 v3, v[52:55] offset:5120
    s_branch Lsnde_254
Lsnd1_253:
    ds_write_b128 v3, v[8:11] offset:0
    ds_write_b128 v3, v[12:15] offset:1024
    ds_write_b128 v3, v[24:27] offset:2048
    ds_write_b128 v3, v[28:31] offset:3072
    ds_write_b128 v3, v[40:43] offset:4096
    ds_write_b128 v3, v[44:47] offset:5120
    v_mov_b32 v8, v16
    v_mov_b32 v9, v17
    v_mov_b32 v10, v18
    v_mov_b32 v11, v19
    v_mov_b32 v12, v20
    v_mov_b32 v13, v21
    v_mov_b32 v14, v22
    v_mov_b32 v15, v23
    v_mov_b32 v24, v32
    v_mov_b32 v25, v33
    v_mov_b32 v26, v34
    v_mov_b32 v27, v35
    v_mov_b32 v28, v36
    v_mov_b32 v29, v37
    v_mov_b32 v30, v38
    v_mov_b32 v31, v39
    v_mov_b32 v40, v48
    v_mov_b32 v41, v49
    v_mov_b32 v42, v50
    v_mov_b32 v43, v51
    v_mov_b32 v44, v52
    v_mov_b32 v45, v53
    v_mov_b32 v46, v54
    v_mov_b32 v47, v55
Lsnde_254:
    s_waitcnt lgkmcnt(0)
    s_barrier
    ds_read_b128 v[56:59], v4 offset:0
    ds_read_b128 v[60:63], v4 offset:1024
    ds_read_b128 v[64:67], v4 offset:2048
    ds_read_b128 v[68:71], v4 offset:3072
    ds_read_b128 v[72:75], v4 offset:4096
    ds_read_b128 v[76:79], v4 offset:5120
    s_waitcnt vmcnt(0) lgkmcnt(0)
    v_lshlrev_b32 v204, 16, v204
    v_lshlrev_b32 v205, 16, v205
    s_mul_i32 s18, s4, 180224
    s_mov_b32 s8, s58
    s_mov_b32 s9, s59
    s_add_u32 s8, s8, s18
    s_addc_u32 s9, s9, 0
    s_mov_b32 s10, 180224
    s_mov_b32 s11, 0x00020000
    s_mul_i32 s18, s16, 90112
    s_mul_i32 s19, s5, 3072
    s_add_u32 s18, s18, s19
    s_add_u32 s18, s18, 20480
    v_add_f32 v8, v8, v56
    v_add_f32 v9, v9, v57
    v_add_f32 v10, v10, v58
    v_add_f32 v11, v11, v59
    v_add_f32 v8, v8, v204
    v_add_f32 v9, v9, v204
    v_add_f32 v10, v10, v204
    v_add_f32 v11, v11, v204
    v_lshlrev_b32 v100, 16, v192
    v_and_b32 v101, 0xffff0000, v192
    v_lshlrev_b32 v102, 16, v193
    v_and_b32 v103, 0xffff0000, v193
    v_mul_f32 v8, v8, v100
    v_mul_f32 v9, v9, v101
    v_mul_f32 v10, v10, v102
    v_mul_f32 v11, v11, v103
    v_cvt_pk_bf16_f32 v104, v8, v9
    v_cvt_pk_bf16_f32 v105, v10, v11
    v_add_f32 v12, v12, v60
    v_add_f32 v13, v13, v61
    v_add_f32 v14, v14, v62
    v_add_f32 v15, v15, v63
    v_add_f32 v12, v12, v205
    v_add_f32 v13, v13, v205
    v_add_f32 v14, v14, v205
    v_add_f32 v15, v15, v205
    v_lshlrev_b32 v100, 16, v194
    v_and_b32 v101, 0xffff0000, v194
    v_lshlrev_b32 v102, 16, v195
    v_and_b32 v103, 0xffff0000, v195
    v_mul_f32 v12, v12, v100
    v_mul_f32 v13, v13, v101
    v_mul_f32 v14, v14, v102
    v_mul_f32 v15, v15, v103
    v_cvt_pk_bf16_f32 v110, v12, v13
    v_cvt_pk_bf16_f32 v111, v14, v15
    v_add_f32 v24, v24, v64
    v_add_f32 v25, v25, v65
    v_add_f32 v26, v26, v66
    v_add_f32 v27, v27, v67
    v_add_f32 v24, v24, v204
    v_add_f32 v25, v25, v204
    v_add_f32 v26, v26, v204
    v_add_f32 v27, v27, v204
    v_lshlrev_b32 v100, 16, v196
    v_and_b32 v101, 0xffff0000, v196
    v_lshlrev_b32 v102, 16, v197
    v_and_b32 v103, 0xffff0000, v197
    v_mul_f32 v24, v24, v100
    v_mul_f32 v25, v25, v101
    v_mul_f32 v26, v26, v102
    v_mul_f32 v27, v27, v103
    v_cvt_pk_bf16_f32 v106, v24, v25
    v_cvt_pk_bf16_f32 v107, v26, v27
    v_add_f32 v28, v28, v68
    v_add_f32 v29, v29, v69
    v_add_f32 v30, v30, v70
    v_add_f32 v31, v31, v71
    v_add_f32 v28, v28, v205
    v_add_f32 v29, v29, v205
    v_add_f32 v30, v30, v205
    v_add_f32 v31, v31, v205
    v_lshlrev_b32 v100, 16, v198
    v_and_b32 v101, 0xffff0000, v198
    v_lshlrev_b32 v102, 16, v199
    v_and_b32 v103, 0xffff0000, v199
    v_mul_f32 v28, v28, v100
    v_mul_f32 v29, v29, v101
    v_mul_f32 v30, v30, v102
    v_mul_f32 v31, v31, v103
    v_cvt_pk_bf16_f32 v112, v28, v29
    v_cvt_pk_bf16_f32 v113, v30, v31
    v_add_f32 v40, v40, v72
    v_add_f32 v41, v41, v73
    v_add_f32 v42, v42, v74
    v_add_f32 v43, v43, v75
    v_add_f32 v40, v40, v204
    v_add_f32 v41, v41, v204
    v_add_f32 v42, v42, v204
    v_add_f32 v43, v43, v204
    v_lshlrev_b32 v100, 16, v200
    v_and_b32 v101, 0xffff0000, v200
    v_lshlrev_b32 v102, 16, v201
    v_and_b32 v103, 0xffff0000, v201
    v_mul_f32 v40, v40, v100
    v_mul_f32 v41, v41, v101
    v_mul_f32 v42, v42, v102
    v_mul_f32 v43, v43, v103
    v_cvt_pk_bf16_f32 v108, v40, v41
    v_cvt_pk_bf16_f32 v109, v42, v43
    v_add_f32 v44, v44, v76
    v_add_f32 v45, v45, v77
    v_add_f32 v46, v46, v78
    v_add_f32 v47, v47, v79
    v_add_f32 v44, v44, v205
    v_add_f32 v45, v45, v205
    v_add_f32 v46, v46, v205
    v_add_f32 v47, v47, v205
    v_lshlrev_b32 v100, 16, v202
    v_and_b32 v101, 0xffff0000, v202
    v_lshlrev_b32 v102, 16, v203
    v_and_b32 v103, 0xffff0000, v203
    v_mul_f32 v44, v44, v100
    v_mul_f32 v45, v45, v101
    v_mul_f32 v46, v46, v102
    v_mul_f32 v47, v47, v103
    v_cvt_pk_bf16_f32 v114, v44, v45
    v_cvt_pk_bf16_f32 v115, v46, v47
    s_add_u32 s26, s18, 45056
    s_cmp_eq_u32 s17, 0
    s_cbranch_scc0 Lh1_255
    buffer_store_dwordx4 v[104:107], v188, s[8:11], s18 offen sc1
    buffer_store_dwordx2 v[108:109], v188, s[8:11], s18 offen offset:1024 sc1
    buffer_store_dwordx4 v[110:113], v188, s[8:11], s26 offen sc1
    buffer_store_dwordx2 v[114:115], v188, s[8:11], s26 offen offset:1024 sc1
    s_branch Lhe_256
Lh1_255:
    buffer_store_dwordx2 v[104:105], v188, s[8:11], s18 offen offset:1032 sc1
    buffer_store_dwordx4 v[106:109], v188, s[8:11], s18 offen offset:2048 sc1
    buffer_store_dwordx2 v[110:111], v188, s[8:11], s26 offen offset:1032 sc1
    buffer_store_dwordx4 v[112:115], v188, s[8:11], s26 offen offset:2048 sc1
Lhe_256:
    s_lshr_b32 s16, s3, 1
    s_and_b32 s17, s3, 1
    v_and_b32 v1, 15, v0
    s_mul_i32 s21, s16, 10240
    v_add_u32 v194, s21, v242
    s_mov_b32 s22, 32768
    v_add_u32 v192, s22, v194
    s_barrier
    ds_read_b128 v[152:155], v192 offset:0
    ds_read_b128 v[156:159], v192 offset:1024
    ds_read_b128 v[160:163], v192 offset:2048
    ds_read_b128 v[164:167], v192 offset:3072
    ds_read_b128 v[168:171], v192 offset:4096
    s_waitcnt vmcnt(8) lgkmcnt(4)
    v_mfma_f32_16x16x32_bf16 v[8:11], v[152:155], v[208:211], 0
    ds_read_b128 v[172:175], v192 offset:5120
    v_mfma_f32_16x16x32_bf16 v[28:31], v[152:155], v[212:215], 0
    s_waitcnt lgkmcnt(4)
    v_mfma_f32_16x16x32_bf16 v[12:15], v[156:159], v[208:211], 0
    ds_read_b128 v[176:179], v192 offset:6144
    v_mfma_f32_16x16x32_bf16 v[32:35], v[156:159], v[212:215], 0
    s_waitcnt lgkmcnt(4)
    v_mfma_f32_16x16x32_bf16 v[16:19], v[160:163], v[208:211], 0
    ds_read_b128 v[180:183], v192 offset:7168
    v_mfma_f32_16x16x32_bf16 v[36:39], v[160:163], v[212:215], 0
    s_waitcnt lgkmcnt(4)
    v_mfma_f32_16x16x32_bf16 v[20:23], v[164:167], v[208:211], 0
    ds_read_b128 v[184:187], v192 offset:8192
    v_mfma_f32_16x16x32_bf16 v[40:43], v[164:167], v[212:215], 0
    s_waitcnt lgkmcnt(4)
    v_mfma_f32_16x16x32_bf16 v[24:27], v[168:171], v[208:211], 0
    ds_read_b128 v[188:191], v192 offset:9216
    v_mfma_f32_16x16x32_bf16 v[44:47], v[168:171], v[212:215], 0
    buffer_load_dwordx4 v[88:91], v242, s[40:43], s44 offen sc1
    buffer_load_dwordx4 v[92:95], v242, s[40:43], s45 offen sc1
    buffer_load_dwordx4 v[96:99], v242, s[40:43], s44 offen offset:1024 sc1
    buffer_load_dwordx4 v[100:103], v242, s[40:43], s45 offen offset:1024 sc1
    s_add_u32 s44, s44, 4096
    s_add_u32 s45, s45, 4096
    s_add_u32 s22, s22, 20480
    s_cmp_eq_u32 s22, 155648
    s_cselect_b32 s22, 32768, s22
    v_add_u32 v192, s22, v194
    s_barrier
    s_waitcnt lgkmcnt(4)
    v_mfma_f32_16x16x32_bf16 v[8:11], v[172:175], v[216:219], v[8:11]
    ds_read_b128 v[152:155], v192 offset:0
    v_mfma_f32_16x16x32_bf16 v[28:31], v[172:175], v[220:223], v[28:31]
    s_waitcnt lgkmcnt(4)
    v_mfma_f32_16x16x32_bf16 v[12:15], v[176:179], v[216:219], v[12:15]
    ds_read_b128 v[156:159], v192 offset:1024
    v_mfma_f32_16x16x32_bf16 v[32:35], v[176:179], v[220:223], v[32:35]
    s_waitcnt lgkmcnt(4)
    v_mfma_f32_16x16x32_bf16 v[16:19], v[180:183], v[216:219], v[16:19]
    ds_read_b128 v[160:163], v192 offset:2048
    v_mfma_f32_16x16x32_bf16 v[36:39], v[180:183], v[220:223], v[36:39]
    s_waitcnt lgkmcnt(4)
    v_mfma_f32_16x16x32_bf16 v[20:23], v[184:187], v[216:219], v[20:23]
    ds_read_b128 v[164:167], v192 offset:3072
    v_mfma_f32_16x16x32_bf16 v[40:43], v[184:187], v[220:223], v[40:43]
    s_waitcnt lgkmcnt(4)
    v_mfma_f32_16x16x32_bf16 v[24:27], v[188:191], v[216:219], v[24:27]
    ds_read_b128 v[168:171], v192 offset:4096
    v_mfma_f32_16x16x32_bf16 v[44:47], v[188:191], v[220:223], v[44:47]
    s_waitcnt vmcnt(8) lgkmcnt(4)
    v_mfma_f32_16x16x32_bf16 v[8:11], v[152:155], v[224:227], v[8:11]
    ds_read_b128 v[172:175], v192 offset:5120
    v_mfma_f32_16x16x32_bf16 v[28:31], v[152:155], v[228:231], v[28:31]
    s_waitcnt lgkmcnt(4)
    v_mfma_f32_16x16x32_bf16 v[12:15], v[156:159], v[224:227], v[12:15]
    ds_read_b128 v[176:179], v192 offset:6144
    v_mfma_f32_16x16x32_bf16 v[32:35], v[156:159], v[228:231], v[32:35]
    s_waitcnt lgkmcnt(4)
    v_mfma_f32_16x16x32_bf16 v[16:19], v[160:163], v[224:227], v[16:19]
    ds_read_b128 v[180:183], v192 offset:7168
    v_mfma_f32_16x16x32_bf16 v[36:39], v[160:163], v[228:231], v[36:39]
    s_waitcnt lgkmcnt(4)
    v_mfma_f32_16x16x32_bf16 v[20:23], v[164:167], v[224:227], v[20:23]
    ds_read_b128 v[184:187], v192 offset:8192
    v_mfma_f32_16x16x32_bf16 v[40:43], v[164:167], v[228:231], v[40:43]
    s_waitcnt lgkmcnt(4)
    v_mfma_f32_16x16x32_bf16 v[24:27], v[168:171], v[224:227], v[24:27]
    ds_read_b128 v[188:191], v192 offset:9216
    v_mfma_f32_16x16x32_bf16 v[44:47], v[168:171], v[228:231], v[44:47]
    buffer_load_dwordx4 v[208:211], v242, s[40:43], s44 offen sc1
    buffer_load_dwordx4 v[212:215], v242, s[40:43], s45 offen sc1
    buffer_load_dwordx4 v[216:219], v242, s[40:43], s44 offen offset:1024 sc1
    buffer_load_dwordx4 v[220:223], v242, s[40:43], s45 offen offset:1024 sc1
    s_add_u32 s44, s44, 4096
    s_add_u32 s45, s45, 4096
    s_add_u32 s22, s22, 20480
    s_cmp_eq_u32 s22, 155648
    s_cselect_b32 s22, 32768, s22
    v_add_u32 v192, s22, v194
    s_barrier
    s_waitcnt lgkmcnt(4)
    v_mfma_f32_16x16x32_bf16 v[8:11], v[172:175], v[232:235], v[8:11]
    ds_read_b128 v[152:155], v192 offset:0
    v_mfma_f32_16x16x32_bf16 v[28:31], v[172:175], v[236:239], v[28:31]
    s_waitcnt lgkmcnt(4)
    v_mfma_f32_16x16x32_bf16 v[12:15], v[176:179], v[232:235], v[12:15]
    ds_read_b128 v[156:159], v192 offset:1024
    v_mfma_f32_16x16x32_bf16 v[32:35], v[176:179], v[236:239], v[32:35]
    s_waitcnt lgkmcnt(4)
    v_mfma_f32_16x16x32_bf16 v[16:19], v[180:183], v[232:235], v[16:19]
    ds_read_b128 v[160:163], v192 offset:2048
    v_mfma_f32_16x16x32_bf16 v[36:39], v[180:183], v[236:239], v[36:39]
    s_waitcnt lgkmcnt(4)
    v_mfma_f32_16x16x32_bf16 v[20:23], v[184:187], v[232:235], v[20:23]
    ds_read_b128 v[164:167], v192 offset:3072
    v_mfma_f32_16x16x32_bf16 v[40:43], v[184:187], v[236:239], v[40:43]
    s_waitcnt lgkmcnt(4)
    v_mfma_f32_16x16x32_bf16 v[24:27], v[188:191], v[232:235], v[24:27]
    ds_read_b128 v[168:171], v192 offset:4096
    v_mfma_f32_16x16x32_bf16 v[44:47], v[188:191], v[236:239], v[44:47]
    s_waitcnt vmcnt(4) lgkmcnt(4)
    v_mfma_f32_16x16x32_bf16 v[8:11], v[152:155], v[88:91], v[8:11]
    ds_read_b128 v[172:175], v192 offset:5120
    v_mfma_f32_16x16x32_bf16 v[28:31], v[152:155], v[92:95], v[28:31]
    s_waitcnt lgkmcnt(4)
    v_mfma_f32_16x16x32_bf16 v[12:15], v[156:159], v[88:91], v[12:15]
    ds_read_b128 v[176:179], v192 offset:6144
    v_mfma_f32_16x16x32_bf16 v[32:35], v[156:159], v[92:95], v[32:35]
    s_waitcnt lgkmcnt(4)
    v_mfma_f32_16x16x32_bf16 v[16:19], v[160:163], v[88:91], v[16:19]
    ds_read_b128 v[180:183], v192 offset:7168
    v_mfma_f32_16x16x32_bf16 v[36:39], v[160:163], v[92:95], v[36:39]
    s_waitcnt lgkmcnt(4)
    v_mfma_f32_16x16x32_bf16 v[20:23], v[164:167], v[88:91], v[20:23]
    ds_read_b128 v[184:187], v192 offset:8192
    v_mfma_f32_16x16x32_bf16 v[40:43], v[164:167], v[92:95], v[40:43]
    s_waitcnt lgkmcnt(4)
    v_mfma_f32_16x16x32_bf16 v[24:27], v[168:171], v[88:91], v[24:27]
    ds_read_b128 v[188:191], v192 offset:9216
    v_mfma_f32_16x16x32_bf16 v[44:47], v[168:171], v[92:95], v[44:47]
    buffer_load_dwordx4 v[224:227], v242, s[40:43], s44 offen sc1
    buffer_load_dwordx4 v[228:231], v242, s[40:43], s45 offen sc1
    buffer_load_dwordx4 v[232:235], v242, s[40:43], s44 offen offset:1024 sc1
    buffer_load_dwordx4 v[236:239], v242, s[40:43], s45 offen offset:1024 sc1
    s_add_u32 s44, s44, 4096
    s_add_u32 s45, s45, 4096
    s_add_u32 s22, s22, 20480
    s_cmp_eq_u32 s22, 155648
    s_cselect_b32 s22, 32768, s22
    v_add_u32 v192, s22, v194
    s_barrier
    s_waitcnt lgkmcnt(4)
    v_mfma_f32_16x16x32_bf16 v[8:11], v[172:175], v[96:99], v[8:11]
    ds_read_b128 v[152:155], v192 offset:0
    v_mfma_f32_16x16x32_bf16 v[28:31], v[172:175], v[100:103], v[28:31]
    s_waitcnt lgkmcnt(4)
    v_mfma_f32_16x16x32_bf16 v[12:15], v[176:179], v[96:99], v[12:15]
    ds_read_b128 v[156:159], v192 offset:1024
    v_mfma_f32_16x16x32_bf16 v[32:35], v[176:179], v[100:103], v[32:35]
    s_waitcnt lgkmcnt(4)
    v_mfma_f32_16x16x32_bf16 v[16:19], v[180:183], v[96:99], v[16:19]
    ds_read_b128 v[160:163], v192 offset:2048
    v_mfma_f32_16x16x32_bf16 v[36:39], v[180:183], v[100:103], v[36:39]
    s_waitcnt lgkmcnt(4)
    v_mfma_f32_16x16x32_bf16 v[20:23], v[184:187], v[96:99], v[20:23]
    ds_read_b128 v[164:167], v192 offset:3072
    v_mfma_f32_16x16x32_bf16 v[40:43], v[184:187], v[100:103], v[40:43]
    s_waitcnt lgkmcnt(4)
    v_mfma_f32_16x16x32_bf16 v[24:27], v[188:191], v[96:99], v[24:27]
    ds_read_b128 v[168:171], v192 offset:4096
    v_mfma_f32_16x16x32_bf16 v[44:47], v[188:191], v[100:103], v[44:47]
    s_waitcnt vmcnt(4) lgkmcnt(4)
    v_mfma_f32_16x16x32_bf16 v[8:11], v[152:155], v[208:211], v[8:11]
    ds_read_b128 v[172:175], v192 offset:5120
    v_mfma_f32_16x16x32_bf16 v[28:31], v[152:155], v[212:215], v[28:31]
    s_waitcnt lgkmcnt(4)
    v_mfma_f32_16x16x32_bf16 v[12:15], v[156:159], v[208:211], v[12:15]
    ds_read_b128 v[176:179], v192 offset:6144
    v_mfma_f32_16x16x32_bf16 v[32:35], v[156:159], v[212:215], v[32:35]
    s_waitcnt lgkmcnt(4)
    v_mfma_f32_16x16x32_bf16 v[16:19], v[160:163], v[208:211], v[16:19]
    ds_read_b128 v[180:183], v192 offset:7168
    v_mfma_f32_16x16x32_bf16 v[36:39], v[160:163], v[212:215], v[36:39]
    s_waitcnt lgkmcnt(4)
    v_mfma_f32_16x16x32_bf16 v[20:23], v[164:167], v[208:211], v[20:23]
    ds_read_b128 v[184:187], v192 offset:8192
    v_mfma_f32_16x16x32_bf16 v[40:43], v[164:167], v[212:215], v[40:43]
    s_waitcnt lgkmcnt(4)
    v_mfma_f32_16x16x32_bf16 v[24:27], v[168:171], v[208:211], v[24:27]
    ds_read_b128 v[188:191], v192 offset:9216
    v_mfma_f32_16x16x32_bf16 v[44:47], v[168:171], v[212:215], v[44:47]
    buffer_load_dwordx4 v[88:91], v242, s[40:43], s44 offen sc1
    buffer_load_dwordx4 v[92:95], v242, s[40:43], s45 offen sc1
    buffer_load_dwordx4 v[96:99], v242, s[40:43], s44 offen offset:1024 sc1
    buffer_load_dwordx4 v[100:103], v242, s[40:43], s45 offen offset:1024 sc1
    s_add_u32 s44, s44, 4096
    s_add_u32 s45, s45, 4096
    s_add_u32 s22, s22, 20480
    s_cmp_eq_u32 s22, 155648
    s_cselect_b32 s22, 32768, s22
    v_add_u32 v192, s22, v194
    s_barrier
    s_waitcnt lgkmcnt(4)
    v_mfma_f32_16x16x32_bf16 v[8:11], v[172:175], v[216:219], v[8:11]
    ds_read_b128 v[152:155], v192 offset:0
    v_mfma_f32_16x16x32_bf16 v[28:31], v[172:175], v[220:223], v[28:31]
    s_waitcnt lgkmcnt(4)
    v_mfma_f32_16x16x32_bf16 v[12:15], v[176:179], v[216:219], v[12:15]
    ds_read_b128 v[156:159], v192 offset:1024
    v_mfma_f32_16x16x32_bf16 v[32:35], v[176:179], v[220:223], v[32:35]
    s_waitcnt lgkmcnt(4)
    v_mfma_f32_16x16x32_bf16 v[16:19], v[180:183], v[216:219], v[16:19]
    ds_read_b128 v[160:163], v192 offset:2048
    v_mfma_f32_16x16x32_bf16 v[36:39], v[180:183], v[220:223], v[36:39]
    s_waitcnt lgkmcnt(4)
    v_mfma_f32_16x16x32_bf16 v[20:23], v[184:187], v[216:219], v[20:23]
    ds_read_b128 v[164:167], v192 offset:3072
    v_mfma_f32_16x16x32_bf16 v[40:43], v[184:187], v[220:223], v[40:43]
    s_waitcnt lgkmcnt(4)
    v_mfma_f32_16x16x32_bf16 v[24:27], v[188:191], v[216:219], v[24:27]
    ds_read_b128 v[168:171], v192 offset:4096
    v_mfma_f32_16x16x32_bf16 v[44:47], v[188:191], v[220:223], v[44:47]
    s_waitcnt vmcnt(4) lgkmcnt(4)
    v_mfma_f32_16x16x32_bf16 v[8:11], v[152:155], v[224:227], v[8:11]
    ds_read_b128 v[172:175], v192 offset:5120
    v_mfma_f32_16x16x32_bf16 v[28:31], v[152:155], v[228:231], v[28:31]
    s_waitcnt lgkmcnt(4)
    v_mfma_f32_16x16x32_bf16 v[12:15], v[156:159], v[224:227], v[12:15]
    ds_read_b128 v[176:179], v192 offset:6144
    v_mfma_f32_16x16x32_bf16 v[32:35], v[156:159], v[228:231], v[32:35]
    s_waitcnt lgkmcnt(4)
    v_mfma_f32_16x16x32_bf16 v[16:19], v[160:163], v[224:227], v[16:19]
    ds_read_b128 v[180:183], v192 offset:7168
    v_mfma_f32_16x16x32_bf16 v[36:39], v[160:163], v[228:231], v[36:39]
    s_waitcnt lgkmcnt(4)
    v_mfma_f32_16x16x32_bf16 v[20:23], v[164:167], v[224:227], v[20:23]
    ds_read_b128 v[184:187], v192 offset:8192
    v_mfma_f32_16x16x32_bf16 v[40:43], v[164:167], v[228:231], v[40:43]
    s_waitcnt lgkmcnt(4)
    v_mfma_f32_16x16x32_bf16 v[24:27], v[168:171], v[224:227], v[24:27]
    ds_read_b128 v[188:191], v192 offset:9216
    v_mfma_f32_16x16x32_bf16 v[44:47], v[168:171], v[228:231], v[44:47]
    buffer_load_dwordx4 v[208:211], v242, s[40:43], s44 offen sc1
    buffer_load_dwordx4 v[212:215], v242, s[40:43], s45 offen sc1
    buffer_load_dwordx4 v[216:219], v242, s[40:43], s44 offen offset:1024 sc1
    buffer_load_dwordx4 v[220:223], v242, s[40:43], s45 offen offset:1024 sc1
    s_add_u32 s44, s44, 4096
    s_add_u32 s45, s45, 4096
    s_add_u32 s22, s22, 20480
    s_cmp_eq_u32 s22, 155648
    s_cselect_b32 s22, 32768, s22
    v_add_u32 v192, s22, v194
    s_barrier
    s_waitcnt lgkmcnt(4)
    v_mfma_f32_16x16x32_bf16 v[8:11], v[172:175], v[232:235], v[8:11]
    ds_read_b128 v[152:155], v192 offset:0
    v_mfma_f32_16x16x32_bf16 v[28:31], v[172:175], v[236:239], v[28:31]
    s_waitcnt lgkmcnt(4)
    v_mfma_f32_16x16x32_bf16 v[12:15], v[176:179], v[232:235], v[12:15]
    ds_read_b128 v[156:159], v192 offset:1024
    v_mfma_f32_16x16x32_bf16 v[32:35], v[176:179], v[236:239], v[32:35]
    s_waitcnt lgkmcnt(4)
    v_mfma_f32_16x16x32_bf16 v[16:19], v[180:183], v[232:235], v[16:19]
    ds_read_b128 v[160:163], v192 offset:2048
    v_mfma_f32_16x16x32_bf16 v[36:39], v[180:183], v[236:239], v[36:39]
    s_waitcnt lgkmcnt(4)
    v_mfma_f32_16x16x32_bf16 v[20:23], v[184:187], v[232:235], v[20:23]
    ds_read_b128 v[164:167], v192 offset:3072
    v_mfma_f32_16x16x32_bf16 v[40:43], v[184:187], v[236:239], v[40:43]
    s_waitcnt lgkmcnt(4)
    v_mfma_f32_16x16x32_bf16 v[24:27], v[188:191], v[232:235], v[24:27]
    ds_read_b128 v[168:171], v192 offset:4096
    v_mfma_f32_16x16x32_bf16 v[44:47], v[188:191], v[236:239], v[44:47]
    s_waitcnt vmcnt(4) lgkmcnt(4)
    v_max3_u32 v2, v88, v90, v92
    v_max3_u32 v3, v94, v96, v98
    v_max3_u32 v2, v2, v100, v102
    v_max_u32 v2, v2, v3
    v_cmp_eq_u32 vcc, -1, v2
    s_nop 1
    s_cmp_eq_u64 vcc, 0
    s_cbranch_scc1 Lxok_257
    s_mov_b32 s35, 0
Lxrl_258:
    s_sub_u32 s32, s44, 8192
    s_sub_u32 s33, s45, 8192
    buffer_load_dwordx4 v[88:91], v242, s[40:43], s32 offen sc1
    buffer_load_dwordx4 v[92:95], v242, s[40:43], s33 offen sc1
    buffer_load_dwordx4 v[96:99], v242, s[40:43], s32 offen offset:1024 sc1
    buffer_load_dwordx4 v[100:103], v242, s[40:43], s33 offen offset:1024 sc1
    s_waitcnt vmcnt(0)
    v_max3_u32 v2, v88, v90, v92
    v_max3_u32 v3, v94, v96, v98
    v_max3_u32 v2, v2, v100, v102
    v_max_u32 v2, v2, v3
    v_cmp_eq_u32 vcc, -1, v2
    s_nop 1
    s_cmp_eq_u64 vcc, 0
    s_cbranch_scc1 Lxok_257
    s_add_u32 s35, s35, 1
    s_cmp_gt_u32 s35, s99
    s_cbranch_scc0 Lxrl_258
    s_mov_b32 s99, 0
Lxok_257:
    v_mfma_f32_16x16x32_bf16 v[48:51], v[152:155], v[88:91], 0
    ds_read_b128 v[172:175], v192 offset:5120
    v_mfma_f32_16x16x32_bf16 v[68:71], v[152:155], v[92:95], 0
    s_waitcnt lgkmcnt(4)
    v_mfma_f32_16x16x32_bf16 v[52:55], v[156:159], v[88:91], 0
    ds_read_b128 v[176:179], v192 offset:6144
    v_mfma_f32_16x16x32_bf16 v[72:75], v[156:159], v[92:95], 0
    s_waitcnt lgkmcnt(4)
    v_mfma_f32_16x16x32_bf16 v[56:59], v[160:163], v[88:91], 0
    ds_read_b128 v[180:183], v192 offset:7168
    v_mfma_f32_16x16x32_bf16 v[76:79], v[160:163], v[92:95], 0
    s_waitcnt lgkmcnt(4)
    v_mfma_f32_16x16x32_bf16 v[60:63], v[164:167], v[88:91], 0
    ds_read_b128 v[184:187], v192 offset:8192
    v_mfma_f32_16x16x32_bf16 v[80:83], v[164:167], v[92:95], 0
    s_waitcnt lgkmcnt(4)
    v_mfma_f32_16x16x32_bf16 v[64:67], v[168:171], v[88:91], 0
    ds_read_b128 v[188:191], v192 offset:9216
    v_mfma_f32_16x16x32_bf16 v[84:87], v[168:171], v[92:95], 0
    buffer_load_dwordx4 v[224:227], v242, s[40:43], s44 offen sc1
    buffer_load_dwordx4 v[228:231], v242, s[40:43], s45 offen sc1
    buffer_load_dwordx4 v[232:235], v242, s[40:43], s44 offen offset:1024 sc1
    buffer_load_dwordx4 v[236:239], v242, s[40:43], s45 offen offset:1024 sc1
    s_add_u32 s44, s44, 4096
    s_add_u32 s45, s45, 4096
    s_add_u32 s22, s22, 20480
    s_cmp_eq_u32 s22, 155648
    s_cselect_b32 s22, 32768, s22
    v_add_u32 v192, s22, v194
    s_barrier
    s_waitcnt lgkmcnt(4)
    v_mfma_f32_16x16x32_bf16 v[48:51], v[172:175], v[96:99], v[48:51]
    ds_read_b128 v[152:155], v192 offset:0
    v_mfma_f32_16x16x32_bf16 v[68:71], v[172:175], v[100:103], v[68:71]
    s_waitcnt lgkmcnt(4)
    v_mfma_f32_16x16x32_bf16 v[52:55], v[176:179], v[96:99], v[52:55]
    ds_read_b128 v[156:159], v192 offset:1024
    v_mfma_f32_16x16x32_bf16 v[72:75], v[176:179], v[100:103], v[72:75]
    s_waitcnt lgkmcnt(4)
    v_mfma_f32_16x16x32_bf16 v[56:59], v[180:183], v[96:99], v[56:59]
    ds_read_b128 v[160:163], v192 offset:2048
    v_mfma_f32_16x16x32_bf16 v[76:79], v[180:183], v[100:103], v[76:79]
    s_waitcnt lgkmcnt(4)
    v_mfma_f32_16x16x32_bf16 v[60:63], v[184:187], v[96:99], v[60:63]
    ds_read_b128 v[164:167], v192 offset:3072
    v_mfma_f32_16x16x32_bf16 v[80:83], v[184:187], v[100:103], v[80:83]
    s_waitcnt lgkmcnt(4)
    v_mfma_f32_16x16x32_bf16 v[64:67], v[188:191], v[96:99], v[64:67]
    ds_read_b128 v[168:171], v192 offset:4096
    v_mfma_f32_16x16x32_bf16 v[84:87], v[188:191], v[100:103], v[84:87]
    s_waitcnt vmcnt(4) lgkmcnt(4)
    v_max3_u32 v2, v208, v210, v212
    v_max3_u32 v3, v214, v216, v218
    v_max3_u32 v2, v2, v220, v222
    v_max_u32 v2, v2, v3
    v_cmp_eq_u32 vcc, -1, v2
    s_nop 1
    s_cmp_eq_u64 vcc, 0
    s_cbranch_scc1 Lxok_259
    s_mov_b32 s35, 0
Lxrl_260:
    s_sub_u32 s32, s44, 8192
    s_sub_u32 s33, s45, 8192
    buffer_load_dwordx4 v[208:211], v242, s[40:43], s32 offen sc1
    buffer_load_dwordx4 v[212:215], v242, s[40:43], s33 offen sc1
    buffer_load_dwordx4 v[216:219], v242, s[40:43], s32 offen offset:1024 sc1
    buffer_load_dwordx4 v[220:223], v242, s[40:43], s33 offen offset:1024 sc1
    s_waitcnt vmcnt(0)
    v_max3_u32 v2, v208, v210, v212
    v_max3_u32 v3, v214, v216, v218
    v_max3_u32 v2, v2, v220, v222
    v_max_u32 v2, v2, v3
    v_cmp_eq_u32 vcc, -1, v2
    s_nop 1
    s_cmp_eq_u64 vcc, 0
    s_cbranch_scc1 Lxok_259
    s_add_u32 s35, s35, 1
    s_cmp_gt_u32 s35, s99
    s_cbranch_scc0 Lxrl_260
    s_mov_b32 s99, 0
Lxok_259:
    v_mfma_f32_16x16x32_bf16 v[48:51], v[152:155], v[208:211], v[48:51]
    ds_read_b128 v[172:175], v192 offset:5120
    v_mfma_f32_16x16x32_bf16 v[68:71], v[152:155], v[212:215], v[68:71]
    s_waitcnt lgkmcnt(4)
    v_mfma_f32_16x16x32_bf16 v[52:55], v[156:159], v[208:211], v[52:55]
    ds_read_b128 v[176:179], v192 offset:6144
    v_mfma_f32_16x16x32_bf16 v[72:75], v[156:159], v[212:215], v[72:75]
    s_waitcnt lgkmcnt(4)
    v_mfma_f32_16x16x32_bf16 v[56:59], v[160:163], v[208:211], v[56:59]
    ds_read_b128 v[180:183], v192 offset:7168
    v_mfma_f32_16x16x32_bf16 v[76:79], v[160:163], v[212:215], v[76:79]
    s_waitcnt lgkmcnt(4)
    v_mfma_f32_16x16x32_bf16 v[60:63], v[164:167], v[208:211], v[60:63]
    ds_read_b128 v[184:187], v192 offset:8192
    v_mfma_f32_16x16x32_bf16 v[80:83], v[164:167], v[212:215], v[80:83]
    s_waitcnt lgkmcnt(4)
    v_mfma_f32_16x16x32_bf16 v[64:67], v[168:171], v[208:211], v[64:67]
    ds_read_b128 v[188:191], v192 offset:9216
    v_mfma_f32_16x16x32_bf16 v[84:87], v[168:171], v[212:215], v[84:87]
    buffer_load_dwordx4 v[88:91], v242, s[40:43], s44 offen sc1
    buffer_load_dwordx4 v[92:95], v242, s[40:43], s45 offen sc1
    buffer_load_dwordx4 v[96:99], v242, s[40:43], s44 offen offset:1024 sc1
    buffer_load_dwordx4 v[100:103], v242, s[40:43], s45 offen offset:1024 sc1
    s_add_u32 s44, s44, 4096
    s_add_u32 s45, s45, 4096
    s_add_u32 s22, s22, 20480
    s_cmp_eq_u32 s22, 155648
    s_cselect_b32 s22, 32768, s22
    v_add_u32 v192, s22, v194
    s_barrier
    s_waitcnt lgkmcnt(4)
    v_mfma_f32_16x16x32_bf16 v[48:51], v[172:175], v[216:219], v[48:51]
    ds_read_b128 v[152:155], v192 offset:0
    v_mfma_f32_16x16x32_bf16 v[68:71], v[172:175], v[220:223], v[68:71]
    s_waitcnt lgkmcnt(4)
    v_mfma_f32_16x16x32_bf16 v[52:55], v[176:179], v[216:219], v[52:55]
    ds_read_b128 v[156:159], v192 offset:1024
    v_mfma_f32_16x16x32_bf16 v[72:75], v[176:179], v[220:223], v[72:75]
    s_waitcnt lgkmcnt(4)
    v_mfma_f32_16x16x32_bf16 v[56:59], v[180:183], v[216:219], v[56:59]
    ds_read_b128 v[160:163], v192 offset:2048
    v_mfma_f32_16x16x32_bf16 v[76:79], v[180:183], v[220:223], v[76:79]
    s_waitcnt lgkmcnt(4)
    v_mfma_f32_16x16x32_bf16 v[60:63], v[184:187], v[216:219], v[60:63]
    ds_read_b128 v[164:167], v192 offset:3072
    v_mfma_f32_16x16x32_bf16 v[80:83], v[184:187], v[220:223], v[80:83]
    s_waitcnt lgkmcnt(4)
    v_mfma_f32_16x16x32_bf16 v[64:67], v[188:191], v[216:219], v[64:67]
    ds_read_b128 v[168:171], v192 offset:4096
    v_mfma_f32_16x16x32_bf16 v[84:87], v[188:191], v[220:223], v[84:87]
    s_waitcnt vmcnt(4) lgkmcnt(4)
    v_max3_u32 v2, v224, v226, v228
    v_max3_u32 v3, v230, v232, v234
    v_max3_u32 v2, v2, v236, v238
    v_max_u32 v2, v2, v3
    v_cmp_eq_u32 vcc, -1, v2
    s_nop 1
    s_cmp_eq_u64 vcc, 0
    s_cbranch_scc1 Lxok_261
    s_mov_b32 s35, 0
Lxrl_262:
    s_sub_u32 s32, s44, 8192
    s_sub_u32 s33, s45, 8192
    buffer_load_dwordx4 v[224:227], v242, s[40:43], s32 offen sc1
    buffer_load_dwordx4 v[228:231], v242, s[40:43], s33 offen sc1
    buffer_load_dwordx4 v[232:235], v242, s[40:43], s32 offen offset:1024 sc1
    buffer_load_dwordx4 v[236:239], v242, s[40:43], s33 offen offset:1024 sc1
    s_waitcnt vmcnt(0)
    v_max3_u32 v2, v224, v226, v228
    v_max3_u32 v3, v230, v232, v234
    v_max3_u32 v2, v2, v236, v238
    v_max_u32 v2, v2, v3
    v_cmp_eq_u32 vcc, -1, v2
    s_nop 1
    s_cmp_eq_u64 vcc, 0
    s_cbranch_scc1 Lxok_261
    s_add_u32 s35, s35, 1
    s_cmp_gt_u32 s35, s99
    s_cbranch_scc0 Lxrl_262
    s_mov_b32 s99, 0
Lxok_261:
    v_mfma_f32_16x16x32_bf16 v[48:51], v[152:155], v[224:227], v[48:51]
    ds_read_b128 v[172:175], v192 offset:5120
    v_mfma_f32_16x16x32_bf16 v[68:71], v[152:155], v[228:231], v[68:71]
    s_waitcnt lgkmcnt(4)
    v_mfma_f32_16x16x32_bf16 v[52:55], v[156:159], v[224:227], v[52:55]
    ds_read_b128 v[176:179], v192 offset:6144
    v_mfma_f32_16x16x32_bf16 v[72:75], v[156:159], v[228:231], v[72:75]
    s_waitcnt lgkmcnt(4)
    v_mfma_f32_16x16x32_bf16 v[56:59], v[160:163], v[224:227], v[56:59]
    ds_read_b128 v[180:183], v192 offset:7168
    v_mfma_f32_16x16x32_bf16 v[76:79], v[160:163], v[228:231], v[76:79]
    s_waitcnt lgkmcnt(4)
    v_mfma_f32_16x16x32_bf16 v[60:63], v[164:167], v[224:227], v[60:63]
    ds_read_b128 v[184:187], v192 offset:8192
    v_mfma_f32_16x16x32_bf16 v[80:83], v[164:167], v[228:231], v[80:83]
    s_waitcnt lgkmcnt(4)
    v_mfma_f32_16x16x32_bf16 v[64:67], v[168:171], v[224:227], v[64:67]
    ds_read_b128 v[188:191], v192 offset:9216
    v_mfma_f32_16x16x32_bf16 v[84:87], v[168:171], v[228:231], v[84:87]
    buffer_load_dwordx4 v[208:211], v242, s[40:43], s44 offen sc1
    buffer_load_dwordx4 v[212:215], v242, s[40:43], s45 offen sc1
    buffer_load_dwordx4 v[216:219], v242, s[40:43], s44 offen offset:1024 sc1
    buffer_load_dwordx4 v[220:223], v242, s[40:43], s45 offen offset:1024 sc1
    s_add_u32 s44, s44, 4096
    s_add_u32 s45, s45, 4096
    s_add_u32 s22, s22, 20480
    s_cmp_eq_u32 s22, 155648
    s_cselect_b32 s22, 32768, s22
    v_add_u32 v192, s22, v194
    s_barrier
    s_waitcnt lgkmcnt(4)
    v_mfma_f32_16x16x32_bf16 v[48:51], v[172:175], v[232:235], v[48:51]
    ds_read_b128 v[152:155], v192 offset:0
    v_mfma_f32_16x16x32_bf16 v[68:71], v[172:175], v[236:239], v[68:71]
    s_waitcnt lgkmcnt(4)
    v_mfma_f32_16x16x32_bf16 v[52:55], v[176:179], v[232:235], v[52:55]
    ds_read_b128 v[156:159], v192 offset:1024
    v_mfma_f32_16x16x32_bf16 v[72:75], v[176:179], v[236:239], v[72:75]
    s_waitcnt lgkmcnt(4)
    v_mfma_f32_16x16x32_bf16 v[56:59], v[180:183], v[232:235], v[56:59]
    ds_read_b128 v[160:163], v192 offset:2048
    v_mfma_f32_16x16x32_bf16 v[76:79], v[180:183], v[236:239], v[76:79]
    s_waitcnt lgkmcnt(4)
    v_mfma_f32_16x16x32_bf16 v[60:63], v[184:187], v[232:235], v[60:63]
    ds_read_b128 v[164:167], v192 offset:3072
    v_mfma_f32_16x16x32_bf16 v[80:83], v[184:187], v[236:239], v[80:83]
    s_waitcnt lgkmcnt(4)
    v_mfma_f32_16x16x32_bf16 v[64:67], v[188:191], v[232:235], v[64:67]
    ds_read_b128 v[168:171], v192 offset:4096
    v_mfma_f32_16x16x32_bf16 v[84:87], v[188:191], v[236:239], v[84:87]
    s_waitcnt vmcnt(4) lgkmcnt(4)
    v_max3_u32 v2, v88, v90, v92
    v_max3_u32 v3, v94, v96, v98
    v_max3_u32 v2, v2, v100, v102
    v_max_u32 v2, v2, v3
    v_cmp_eq_u32 vcc, -1, v2
    s_nop 1
    s_cmp_eq_u64 vcc, 0
    s_cbranch_scc1 Lxok_263
    s_mov_b32 s35, 0
Lxrl_264:
    s_sub_u32 s32, s44, 8192
    s_sub_u32 s33, s45, 8192
    buffer_load_dwordx4 v[88:91], v242, s[40:43], s32 offen sc1
    buffer_load_dwordx4 v[92:95], v242, s[40:43], s33 offen sc1
    buffer_load_dwordx4 v[96:99], v242, s[40:43], s32 offen offset:1024 sc1
    buffer_load_dwordx4 v[100:103], v242, s[40:43], s33 offen offset:1024 sc1
    s_waitcnt vmcnt(0)
    v_max3_u32 v2, v88, v90, v92
    v_max3_u32 v3, v94, v96, v98
    v_max3_u32 v2, v2, v100, v102
    v_max_u32 v2, v2, v3
    v_cmp_eq_u32 vcc, -1, v2
    s_nop 1
    s_cmp_eq_u64 vcc, 0
    s_cbranch_scc1 Lxok_263
    s_add_u32 s35, s35, 1
    s_cmp_gt_u32 s35, s99
    s_cbranch_scc0 Lxrl_264
    s_mov_b32 s99, 0
Lxok_263:
    v_mfma_f32_16x16x32_bf16 v[48:51], v[152:155], v[88:91], v[48:51]
    ds_read_b128 v[172:175], v192 offset:5120
    v_mfma_f32_16x16x32_bf16 v[68:71], v[152:155], v[92:95], v[68:71]
    s_waitcnt lgkmcnt(4)
    v_mfma_f32_16x16x32_bf16 v[52:55], v[156:159], v[88:91], v[52:55]
    ds_read_b128 v[176:179], v192 offset:6144
    v_mfma_f32_16x16x32_bf16 v[72:75], v[156:159], v[92:95], v[72:75]
    s_waitcnt lgkmcnt(4)
    v_mfma_f32_16x16x32_bf16 v[56:59], v[160:163], v[88:91], v[56:59]
    ds_read_b128 v[180:183], v192 offset:7168
    v_mfma_f32_16x16x32_bf16 v[76:79], v[160:163], v[92:95], v[76:79]
    s_waitcnt lgkmcnt(4)
    v_mfma_f32_16x16x32_bf16 v[60:63], v[164:167], v[88:91], v[60:63]
    ds_read_b128 v[184:187], v192 offset:8192
    v_mfma_f32_16x16x32_bf16 v[80:83], v[164:167], v[92:95], v[80:83]
    s_waitcnt lgkmcnt(4)
    v_mfma_f32_16x16x32_bf16 v[64:67], v[168:171], v[88:91], v[64:67]
    ds_read_b128 v[188:191], v192 offset:9216
    v_mfma_f32_16x16x32_bf16 v[84:87], v[168:171], v[92:95], v[84:87]
    buffer_load_dwordx4 v[224:227], v242, s[40:43], s44 offen sc1
    buffer_load_dwordx4 v[228:231], v242, s[40:43], s45 offen sc1
    buffer_load_dwordx4 v[232:235], v242, s[40:43], s44 offen offset:1024 sc1
    buffer_load_dwordx4 v[236:239], v242, s[40:43], s45 offen offset:1024 sc1
    s_add_u32 s44, s44, 4096
    s_add_u32 s45, s45, 4096
    s_add_u32 s22, s22, 20480
    s_cmp_eq_u32 s22, 155648
    s_cselect_b32 s22, 32768, s22
    v_add_u32 v192, s22, v194
    s_barrier
    s_waitcnt lgkmcnt(4)
    v_mfma_f32_16x16x32_bf16 v[48:51], v[172:175], v[96:99], v[48:51]
    ds_read_b128 v[152:155], v192 offset:0
    v_mfma_f32_16x16x32_bf16 v[68:71], v[172:175], v[100:103], v[68:71]
    s_waitcnt lgkmcnt(4)
    v_mfma_f32_16x16x32_bf16 v[52:55], v[176:179], v[96:99], v[52:55]
    ds_read_b128 v[156:159], v192 offset:1024
    v_mfma_f32_16x16x32_bf16 v[72:75], v[176:179], v[100:103], v[72:75]
    s_waitcnt lgkmcnt(4)
    v_mfma_f32_16x16x32_bf16 v[56:59], v[180:183], v[96:99], v[56:59]
    ds_read_b128 v[160:163], v192 offset:2048
    v_mfma_f32_16x16x32_bf16 v[76:79], v[180:183], v[100:103], v[76:79]
    s_waitcnt lgkmcnt(4)
    v_mfma_f32_16x16x32_bf16 v[60:63], v[184:187], v[96:99], v[60:63]
    ds_read_b128 v[164:167], v192 offset:3072
    v_mfma_f32_16x16x32_bf16 v[80:83], v[184:187], v[100:103], v[80:83]
    s_waitcnt lgkmcnt(4)
    v_mfma_f32_16x16x32_bf16 v[64:67], v[188:191], v[96:99], v[64:67]
    ds_read_b128 v[168:171], v192 offset:4096
    v_mfma_f32_16x16x32_bf16 v[84:87], v[188:191], v[100:103], v[84:87]
    s_waitcnt vmcnt(4) lgkmcnt(4)
    v_max3_u32 v2, v208, v210, v212
    v_max3_u32 v3, v214, v216, v218
    v_max3_u32 v2, v2, v220, v222
    v_max_u32 v2, v2, v3
    v_cmp_eq_u32 vcc, -1, v2
    s_nop 1
    s_cmp_eq_u64 vcc, 0
    s_cbranch_scc1 Lxok_265
    s_mov_b32 s35, 0
Lxrl_266:
    s_sub_u32 s32, s44, 8192
    s_sub_u32 s33, s45, 8192
    buffer_load_dwordx4 v[208:211], v242, s[40:43], s32 offen sc1
    buffer_load_dwordx4 v[212:215], v242, s[40:43], s33 offen sc1
    buffer_load_dwordx4 v[216:219], v242, s[40:43], s32 offen offset:1024 sc1
    buffer_load_dwordx4 v[220:223], v242, s[40:43], s33 offen offset:1024 sc1
    s_waitcnt vmcnt(0)
    v_max3_u32 v2, v208, v210, v212
    v_max3_u32 v3, v214, v216, v218
    v_max3_u32 v2, v2, v220, v222
    v_max_u32 v2, v2, v3
    v_cmp_eq_u32 vcc, -1, v2
    s_nop 1
    s_cmp_eq_u64 vcc, 0
    s_cbranch_scc1 Lxok_265
    s_add_u32 s35, s35, 1
    s_cmp_gt_u32 s35, s99
    s_cbranch_scc0 Lxrl_266
    s_mov_b32 s99, 0
Lxok_265:
    v_mfma_f32_16x16x32_bf16 v[48:51], v[152:155], v[208:211], v[48:51]
    ds_read_b128 v[172:175], v192 offset:5120
    v_mfma_f32_16x16x32_bf16 v[68:71], v[152:155], v[212:215], v[68:71]
    s_waitcnt lgkmcnt(4)
    v_mfma_f32_16x16x32_bf16 v[52:55], v[156:159], v[208:211], v[52:55]
    ds_read_b128 v[176:179], v192 offset:6144
    v_mfma_f32_16x16x32_bf16 v[72:75], v[156:159], v[212:215], v[72:75]
    s_waitcnt lgkmcnt(4)
    v_mfma_f32_16x16x32_bf16 v[56:59], v[160:163], v[208:211], v[56:59]
    ds_read_b128 v[180:183], v192 offset:7168
    v_mfma_f32_16x16x32_bf16 v[76:79], v[160:163], v[212:215], v[76:79]
    s_waitcnt lgkmcnt(4)
    v_mfma_f32_16x16x32_bf16 v[60:63], v[164:167], v[208:211], v[60:63]
    ds_read_b128 v[184:187], v192 offset:8192
    v_mfma_f32_16x16x32_bf16 v[80:83], v[164:167], v[212:215], v[80:83]
    s_waitcnt lgkmcnt(4)
    v_mfma_f32_16x16x32_bf16 v[64:67], v[168:171], v[208:211], v[64:67]
    ds_read_b128 v[188:191], v192 offset:9216
    v_mfma_f32_16x16x32_bf16 v[84:87], v[168:171], v[212:215], v[84:87]
    s_add_u32 s22, s22, 20480
    s_cmp_eq_u32 s22, 155648
    s_cselect_b32 s22, 32768, s22
    v_add_u32 v192, s22, v194
    s_barrier
    s_waitcnt lgkmcnt(4)
    v_mfma_f32_16x16x32_bf16 v[48:51], v[172:175], v[216:219], v[48:51]
    ds_read_b128 v[152:155], v192 offset:0
    v_mfma_f32_16x16x32_bf16 v[68:71], v[172:175], v[220:223], v[68:71]
    s_waitcnt lgkmcnt(4)
    v_mfma_f32_16x16x32_bf16 v[52:55], v[176:179], v[216:219], v[52:55]
    ds_read_b128 v[156:159], v192 offset:1024
    v_mfma_f32_16x16x32_bf16 v[72:75], v[176:179], v[220:223], v[72:75]
    s_waitcnt lgkmcnt(4)
    v_mfma_f32_16x16x32_bf16 v[56:59], v[180:183], v[216:219], v[56:59]
    ds_read_b128 v[160:163], v192 offset:2048
    v_mfma_f32_16x16x32_bf16 v[76:79], v[180:183], v[220:223], v[76:79]
    s_waitcnt lgkmcnt(4)
    v_mfma_f32_16x16x32_bf16 v[60:63], v[184:187], v[216:219], v[60:63]
    ds_read_b128 v[164:167], v192 offset:3072
    v_mfma_f32_16x16x32_bf16 v[80:83], v[184:187], v[220:223], v[80:83]
    s_waitcnt lgkmcnt(4)
    v_mfma_f32_16x16x32_bf16 v[64:67], v[188:191], v[216:219], v[64:67]
    ds_read_b128 v[168:171], v192 offset:4096
    v_mfma_f32_16x16x32_bf16 v[84:87], v[188:191], v[220:223], v[84:87]
    s_waitcnt vmcnt(0) lgkmcnt(4)
    v_max3_u32 v2, v224, v226, v228
    v_max3_u32 v3, v230, v232, v234
    v_max3_u32 v2, v2, v236, v238
    v_max_u32 v2, v2, v3
    v_cmp_eq_u32 vcc, -1, v2
    s_nop 1
    s_cmp_eq_u64 vcc, 0
    s_cbranch_scc1 Lxok_267
    s_mov_b32 s35, 0
Lxrl_268:
    s_sub_u32 s32, s44, 4096
    s_sub_u32 s33, s45, 4096
    buffer_load_dwordx4 v[224:227], v242, s[40:43], s32 offen sc1
    buffer_load_dwordx4 v[228:231], v242, s[40:43], s33 offen sc1
    buffer_load_dwordx4 v[232:235], v242, s[40:43], s32 offen offset:1024 sc1
    buffer_load_dwordx4 v[236:239], v242, s[40:43], s33 offen offset:1024 sc1
    s_waitcnt vmcnt(0)
    v_max3_u32 v2, v224, v226, v228
    v_max3_u32 v3, v230, v232, v234
    v_max3_u32 v2, v2, v236, v238
    v_max_u32 v2, v2, v3
    v_cmp_eq_u32 vcc, -1, v2
    s_nop 1
    s_cmp_eq_u64 vcc, 0
    s_cbranch_scc1 Lxok_267
    s_add_u32 s35, s35, 1
    s_cmp_gt_u32 s35, s99
    s_cbranch_scc0 Lxrl_268
    s_mov_b32 s99, 0
Lxok_267:
    v_mfma_f32_16x16x32_bf16 v[48:51], v[152:155], v[224:227], v[48:51]
    ds_read_b128 v[172:175], v192 offset:5120
    v_mfma_f32_16x16x32_bf16 v[68:71], v[152:155], v[228:231], v[68:71]
    s_waitcnt lgkmcnt(4)
    v_mfma_f32_16x16x32_bf16 v[52:55], v[156:159], v[224:227], v[52:55]
    ds_read_b128 v[176:179], v192 offset:6144
    v_mfma_f32_16x16x32_bf16 v[72:75], v[156:159], v[228:231], v[72:75]
    s_waitcnt lgkmcnt(4)
    v_mfma_f32_16x16x32_bf16 v[56:59], v[160:163], v[224:227], v[56:59]
    ds_read_b128 v[180:183], v192 offset:7168
    v_mfma_f32_16x16x32_bf16 v[76:79], v[160:163], v[228:231], v[76:79]
    s_waitcnt lgkmcnt(4)
    v_mfma_f32_16x16x32_bf16 v[60:63], v[164:167], v[224:227], v[60:63]
    ds_read_b128 v[184:187], v192 offset:8192
    v_mfma_f32_16x16x32_bf16 v[80:83], v[164:167], v[228:231], v[80:83]
    s_waitcnt lgkmcnt(4)
    v_mfma_f32_16x16x32_bf16 v[64:67], v[168:171], v[224:227], v[64:67]
    ds_read_b128 v[188:191], v192 offset:9216
    v_mfma_f32_16x16x32_bf16 v[84:87], v[168:171], v[228:231], v[84:87]
    s_waitcnt lgkmcnt(4)
    v_mfma_f32_16x16x32_bf16 v[48:51], v[172:175], v[232:235], v[48:51]
    v_mfma_f32_16x16x32_bf16 v[68:71], v[172:175], v[236:239], v[68:71]
    s_waitcnt lgkmcnt(3)
    v_mfma_f32_16x16x32_bf16 v[52:55], v[176:179], v[232:235], v[52:55]
    v_mfma_f32_16x16x32_bf16 v[72:75], v[176:179], v[236:239], v[72:75]
    s_waitcnt lgkmcnt(2)
    v_mfma_f32_16x16x32_bf16 v[56:59], v[180:183], v[232:235], v[56:59]
    v_mfma_f32_16x16x32_bf16 v[76:79], v[180:183], v[236:239], v[76:79]
    s_waitcnt lgkmcnt(1)
    v_mfma_f32_16x16x32_bf16 v[60:63], v[184:187], v[232:235], v[60:63]
    v_mfma_f32_16x16x32_bf16 v[80:83], v[184:187], v[236:239], v[80:83]
    s_waitcnt lgkmcnt(0)
    v_mfma_f32_16x16x32_bf16 v[64:67], v[188:191], v[232:235], v[64:67]
    v_mfma_f32_16x16x32_bf16 v[84:87], v[188:191], v[236:239], v[84:87]
    v_sub_f32 v8, v8, v48
    v_sub_f32 v9, v9, v49
    v_sub_f32 v10, v10, v50
    v_sub_f32 v11, v11, v51
    v_fma_f32 v8, v240, v8, v48
    v_fma_f32 v9, v240, v9, v49
    v_fma_f32 v10, v240, v10, v50
    v_fma_f32 v11, v240, v11, v51
    v_sub_f32 v12, v12, v52
    v_sub_f32 v13, v13, v53
    v_sub_f32 v14, v14, v54
    v_sub_f32 v15, v15, v55
    v_fma_f32 v12, v240, v12, v52
    v_fma_f32 v13, v240, v13, v53
    v_fma_f32 v14, v240, v14, v54
    v_fma_f32 v15, v240, v15, v55
    v_sub_f32 v16, v16, v56
    v_sub_f32 v17, v17, v57
    v_sub_f32 v18, v18, v58
    v_sub_f32 v19, v19, v59
    v_fma_f32 v16, v240, v16, v56
    v_fma_f32 v17, v240, v17, v57
    v_fma_f32 v18, v240, v18, v58
    v_fma_f32 v19, v240, v19, v59
    v_sub_f32 v20, v20, v60
    v_sub_f32 v21, v21, v61
    v_sub_f32 v22, v22, v62
    v_sub_f32 v23, v23, v63
    v_fma_f32 v20, v240, v20, v60
    v_fma_f32 v21, v240, v21, v61
    v_fma_f32 v22, v240, v22, v62
    v_fma_f32 v23, v240, v23, v63
    v_sub_f32 v24, v24, v64
    v_sub_f32 v25, v25, v65
    v_sub_f32 v26, v26, v66
    v_sub_f32 v27, v27, v67
    v_fma_f32 v24, v240, v24, v64
    v_fma_f32 v25, v240, v25, v65
    v_fma_f32 v26, v240, v26, v66
    v_fma_f32 v27, v240, v27, v67
    v_sub_f32 v28, v28, v68
    v_sub_f32 v29, v29, v69
    v_sub_f32 v30, v30, v70
    v_sub_f32 v31, v31, v71
    v_fma_f32 v28, v241, v28, v68
    v_fma_f32 v29, v241, v29, v69
    v_fma_f32 v30, v241, v30, v70
    v_fma_f32 v31, v241, v31, v71
    v_sub_f32 v32, v32, v72
    v_sub_f32 v33, v33, v73
    v_sub_f32 v34, v34, v74
    v_sub_f32 v35, v35, v75
    v_fma_f32 v32, v241, v32, v72
    v_fma_f32 v33, v241, v33, v73
    v_fma_f32 v34, v241, v34, v74
    v_fma_f32 v35, v241, v35, v75
    v_sub_f32 v36, v36, v76
    v_sub_f32 v37, v37, v77
    v_sub_f32 v38, v38, v78
    v_sub_f32 v39, v39, v79
    v_fma_f32 v36, v241, v36, v76
    v_fma_f32 v37, v241, v37, v77
    v_fma_f32 v38, v241, v38, v78
    v_fma_f32 v39, v241, v39, v79
    v_sub_f32 v40, v40, v80
    v_sub_f32 v41, v41, v81
    v_sub_f32 v42, v42, v82
    v_sub_f32 v43, v43, v83
    v_fma_f32 v40, v241, v40, v80
    v_fma_f32 v41, v241, v41, v81
    v_fma_f32 v42, v241, v42, v82
    v_fma_f32 v43, v241, v43, v83
    v_sub_f32 v44, v44, v84
    v_sub_f32 v45, v45, v85
    v_sub_f32 v46, v46, v86
    v_sub_f32 v47, v47, v87
    v_fma_f32 v44, v241, v44, v84
    v_fma_f32 v45, v241, v45, v85
    v_fma_f32 v46, v241, v46, v86
    v_fma_f32 v47, v241, v47, v87
    s_mul_i32 s18, s3, 5120
    v_add_u32 v3, s18, v242
    s_xor_b32 s18, s3, 2
    s_mul_i32 s18, s18, 5120
    v_add_u32 v4, s18, v242
    s_cmp_eq_u32 s16, 0
    s_cbranch_scc0 Lp3k1_269
    ds_write_b128 v3, v[28:31] offset:0
    ds_write_b128 v3, v[32:35] offset:1024
    ds_write_b128 v3, v[36:39] offset:2048
    ds_write_b128 v3, v[40:43] offset:3072
    ds_write_b128 v3, v[44:47] offset:4096
    s_branch Lp3ke_270
Lp3k1_269:
    ds_write_b128 v3, v[8:11] offset:0
    ds_write_b128 v3, v[12:15] offset:1024
    ds_write_b128 v3, v[16:19] offset:2048
    ds_write_b128 v3, v[20:23] offset:3072
    ds_write_b128 v3, v[24:27] offset:4096
    v_mov_b32 v8, v28
    v_mov_b32 v9, v29
    v_mov_b32 v10, v30
    v_mov_b32 v11, v31
    v_mov_b32 v12, v32
    v_mov_b32 v13, v33
    v_mov_b32 v14, v34
    v_mov_b32 v15, v35
    v_mov_b32 v16, v36
    v_mov_b32 v17, v37
    v_mov_b32 v18, v38
    v_mov_b32 v19, v39
    v_mov_b32 v20, v40
    v_mov_b32 v21, v41
    v_mov_b32 v22, v42
    v_mov_b32 v23, v43
    v_mov_b32 v24, v44
    v_mov_b32 v25, v45
    v_mov_b32 v26, v46
    v_mov_b32 v27, v47
Lp3ke_270:
    s_waitcnt lgkmcnt(0)
    s_barrier
    ds_read_b128 v[48:51], v4 offset:0
    ds_read_b128 v[52:55], v4 offset:1024
    ds_read_b128 v[56:59], v4 offset:2048
    ds_read_b128 v[60:63], v4 offset:3072
    ds_read_b128 v[64:67], v4 offset:4096
    s_lshl_b32 s18, s4, 2
    s_lshl_b32 s19, s17, 1
    s_add_u32 s18, s18, s19
    s_add_u32 s18, s18, s16
    s_mul_i32 s18, s18, 20480
    s_mul_i32 s19, s5, 160
    s_add_u32 s18, s18, s19
    s_mov_b32 s12, s54
    s_mov_b32 s13, s55
    s_mov_b32 s14, 2621440
    s_mov_b32 s15, 0x00020000
    s_movk_i32 s19, 1280
    v_mul_u32_u24 v2, s19, v1
    v_lshrrev_b32 v4, 4, v0
    v_lshl_add_u32 v2, v4, 3, v2
    s_waitcnt lgkmcnt(0)
    v_add_f32 v8, v8, v48
    v_add_f32 v9, v9, v49
    v_add_f32 v10, v10, v50
    v_add_f32 v11, v11, v51
    v_cvt_pk_bf16_f32 v104, v8, v9
    v_cvt_pk_bf16_f32 v105, v10, v11
    buffer_store_dwordx2 v[104:105], v2, s[12:15], s18 offen offset:0
    v_add_f32 v12, v12, v52
    v_add_f32 v13, v13, v53
    v_add_f32 v14, v14, v54
    v_add_f32 v15, v15, v55
    v_cvt_pk_bf16_f32 v106, v12, v13
    v_cvt_pk_bf16_f32 v107, v14, v15
    buffer_store_dwordx2 v[106:107], v2, s[12:15], s18 offen offset:32
    v_add_f32 v16, v16, v56
    v_add_f32 v17, v17, v57
    v_add_f32 v18, v18, v58
    v_add_f32 v19, v19, v59
    v_cvt_pk_bf16_f32 v108, v16, v17
    v_cvt_pk_bf16_f32 v109, v18, v19
    buffer_store_dwordx2 v[108:109], v2, s[12:15], s18 offen offset:64
    v_add_f32 v20, v20, v60
    v_add_f32 v21, v21, v61
    v_add_f32 v22, v22, v62
    v_add_f32 v23, v23, v63
    v_cvt_pk_bf16_f32 v110, v20, v21
    v_cvt_pk_bf16_f32 v111, v22, v23
    buffer_store_dwordx2 v[110:111], v2, s[12:15], s18 offen offset:96
    v_add_f32 v24, v24, v64
    v_add_f32 v25, v25, v65
    v_add_f32 v26, v26, v66
    v_add_f32 v27, v27, v67
    v_cvt_pk_bf16_f32 v112, v24, v25
    v_cvt_pk_bf16_f32 v113, v26, v27
    buffer_store_dwordx2 v[112:113], v2, s[12:15], s18 offen offset:128
    s_waitcnt vmcnt(0)
    s_branch Lfin_218
Lp2ld_217:
    s_waitcnt vmcnt(0)
    s_sub_u32 s16, s3, 4
    s_lshl_b32 s17, s60, 18
    s_mov_b32 s8, s46
    s_mov_b32 s9, s47
    s_add_u32 s8, s8, s17
    s_addc_u32 s9, s9, 0
    s_mov_b32 s10, 262144
    s_mov_b32 s11, 0x00020000
    v_lshrrev_b32 v4, 5, v0
    s_lshl_b32 s17, s16, 2
    v_add_u32 v4, s17, v4
    v_and_b32 v5, 31, v0
    v_xor_b32 v6, v5, v4
    v_lshlrev_b32 v6, 4, v6
    v_lshl_add_u32 v2, v4, 12, v6
    v_add_u32 v4, 2, v4
    v_xor_b32 v6, v5, v4
    v_lshlrev_b32 v6, 4, v6
    v_lshl_add_u32 v3, v4, 12, v6
    s_lshl_b32 s18, s16, 11
    s_cmp_ge_u32 s27, 352
    s_cbranch_scc1 Lpkf_271
    s_and_b32 s16, s27, 7
    s_lshl_b32 s16, s16, 8
    s_lshr_b32 s17, s27, 3
    s_lshl_b32 s17, s17, 2
    s_add_u32 s16, s16, s17
    s_add_u32 s16, s16, 8192
    s_add_u32 s28, s58, 13107200
    s_addc_u32 s29, s59, 0
    s_mov_b32 s30, 16384
    s_mov_b32 s31, 0x00020000
    s_mov_b64 s[32:33], exec
    s_mov_b64 exec, 1
    v_mov_b32 v12, 0
    v_mov_b32 v13, s62
    buffer_store_dword v13, v12, s[28:31], s16 offen sc1
    s_mov_b64 exec, s[32:33]
Lpkf_271:
    s_lshl_b32 s26, s60, 2
    s_add_u32 s26, s26, s3
    s_sub_u32 s26, s26, 4
    s_mul_i32 s26, s26, 44
    s_mul_i32 s25, s61, 3
    s_add_u32 s26, s26, s25
    s_add_u32 s26, s26, 20
    s_lshl_b32 s26, s26, 10
    s_mov_b32 s28, s58
    s_mov_b32 s29, s59
    s_mov_b32 s30, 5767168
    s_mov_b32 s31, 0x00020000
    v_mov_b32 v20, -1
    v_mov_b32 v21, -1
    v_mov_b32 v22, -1
    v_mov_b32 v23, -1
    v_lshlrev_b32 v19, 4, v0
    buffer_store_dwordx4 v[20:23], v19, s[28:31], s26 offen offset:0 sc1
    buffer_store_dwordx4 v[20:23], v19, s[28:31], s26 offen offset:1024 sc1
    buffer_store_dwordx4 v[20:23], v19, s[28:31], s26 offen offset:2048 sc1
    s_waitcnt vmcnt(3)
    s_barrier
    s_add_u32 s19, s100, 1
    s_and_b32 s19, s19, 3
    s_lshl_b32 s19, s19, 9
    s_add_u32 m0, s18, 0
    s_add_u32 s20, s19, 0
    buffer_load_dwordx4 v2, s[8:11], s20 offen  lds
    s_add_u32 m0, s18, 1024
    s_add_u32 s20, s19, 0
    buffer_load_dwordx4 v3, s[8:11], s20 offen  lds
    s_add_u32 m0, s18, 8192
    s_add_u32 s20, s19, 65536
    buffer_load_dwordx4 v2, s[8:11], s20 offen  lds
    s_add_u32 m0, s18, 9216
    s_add_u32 s20, s19, 65536
    buffer_load_dwordx4 v3, s[8:11], s20 offen  lds
    s_add_u32 m0, s18, 16384
    s_add_u32 s20, s19, 131072
    buffer_load_dwordx4 v2, s[8:11], s20 offen  lds
    s_add_u32 m0, s18, 17408
    s_add_u32 s20, s19, 131072
    buffer_load_dwordx4 v3, s[8:11], s20 offen  lds
    s_add_u32 m0, s18, 24576
    s_add_u32 s20, s19, 196608
    buffer_load_dwordx4 v2, s[8:11], s20 offen  lds
    s_add_u32 m0, s18, 25600
    s_add_u32 s20, s19, 196608
    buffer_load_dwordx4 v3, s[8:11], s20 offen  lds
    s_add_u32 s19, s100, 1
    s_and_b32 s19, s19, 3
    s_lshl_b32 s19, s19, 9
    s_add_u32 s19, s19, 2048
    s_add_u32 m0, s18, 32768
    s_add_u32 s20, s19, 0
    buffer_load_dwordx4 v2, s[8:11], s20 offen  lds
    s_add_u32 m0, s18, 33792
    s_add_u32 s20, s19, 0
    buffer_load_dwordx4 v3, s[8:11], s20 offen  lds
    s_add_u32 m0, s18, 40960
    s_add_u32 s20, s19, 65536
    buffer_load_dwordx4 v2, s[8:11], s20 offen  lds
    s_add_u32 m0, s18, 41984
    s_add_u32 s20, s19, 65536
    buffer_load_dwordx4 v3, s[8:11], s20 offen  lds
    s_add_u32 m0, s18, 49152
    s_add_u32 s20, s19, 131072
    buffer_load_dwordx4 v2, s[8:11], s20 offen  lds
    s_add_u32 m0, s18, 50176
    s_add_u32 s20, s19, 131072
    buffer_load_dwordx4 v3, s[8:11], s20 offen  lds
    s_add_u32 m0, s18, 57344
    s_add_u32 s20, s19, 196608
    buffer_load_dwordx4 v2, s[8:11], s20 offen  lds
    s_add_u32 m0, s18, 58368
    s_add_u32 s20, s19, 196608
    buffer_load_dwordx4 v3, s[8:11], s20 offen  lds
    s_add_u32 s19, s100, 2
    s_and_b32 s19, s19, 3
    s_lshl_b32 s19, s19, 9
    s_add_u32 m0, s18, 65536
    s_add_u32 s20, s19, 0
    buffer_load_dwordx4 v2, s[8:11], s20 offen  lds
    s_add_u32 m0, s18, 66560
    s_add_u32 s20, s19, 0
    buffer_load_dwordx4 v3, s[8:11], s20 offen  lds
    s_add_u32 m0, s18, 73728
    s_add_u32 s20, s19, 65536
    buffer_load_dwordx4 v2, s[8:11], s20 offen  lds
    s_add_u32 m0, s18, 74752
    s_add_u32 s20, s19, 65536
    buffer_load_dwordx4 v3, s[8:11], s20 offen  lds
    s_add_u32 m0, s18, 81920
    s_add_u32 s20, s19, 131072
    buffer_load_dwordx4 v2, s[8:11], s20 offen  lds
    s_add_u32 m0, s18, 82944
    s_add_u32 s20, s19, 131072
    buffer_load_dwordx4 v3, s[8:11], s20 offen  lds
    s_add_u32 m0, s18, 90112
    s_add_u32 s20, s19, 196608
    buffer_load_dwordx4 v2, s[8:11], s20 offen  lds
    s_add_u32 m0, s18, 91136
    s_add_u32 s20, s19, 196608
    buffer_load_dwordx4 v3, s[8:11], s20 offen  lds
    s_waitcnt vmcnt(8)
    s_barrier
    s_cmp_lg_u32 s3, 4
    s_cbranch_scc1 Lonly_272
    s_add_u32 s28, s58, 13107200
    s_addc_u32 s29, s59, 0
    s_mov_b32 s30, 16384
    s_mov_b32 s31, 0x00020000
    s_mov_b64 s[32:33], exec
    s_mov_b64 exec, 1
    v_mov_b32 v12, 0
    v_mov_b32 v13, s62
    buffer_store_dword v13, v12, s[28:31], s63 offen sc1
    s_mov_b64 exec, s[32:33]
Lonly_272:
    s_cmp_lg_u32 s3, 5
    s_cbranch_scc1 Lonly_273
    s_lshl_b32 s21, s4, 7
    s_lshl_b32 s19, s5, 2
    s_add_u32 s21, s21, s19
    s_add_u32 s21, s21, 12288
    s_add_u32 s28, s58, 13107200
    s_addc_u32 s29, s59, 0
    s_mov_b32 s30, 16384
    s_mov_b32 s31, 0x00020000
    s_mov_b64 s[32:33], exec
    s_mov_b64 exec, 1
    v_mov_b32 v12, 0
    v_mov_b32 v13, s62
    buffer_store_dword v13, v12, s[28:31], s21 offen sc1
    s_mov_b64 exec, s[32:33]
Lonly_273:
    s_add_u32 s19, s100, 2
    s_and_b32 s19, s19, 3
    s_lshl_b32 s19, s19, 9
    s_add_u32 s19, s19, 2048
    s_add_u32 m0, s18, 98304
    s_add_u32 s20, s19, 0
    buffer_load_dwordx4 v2, s[8:11], s20 offen  lds
    s_add_u32 m0, s18, 99328
    s_add_u32 s20, s19, 0
    buffer_load_dwordx4 v3, s[8:11], s20 offen  lds
    s_add_u32 m0, s18, 106496
    s_add_u32 s20, s19, 65536
    buffer_load_dwordx4 v2, s[8:11], s20 offen  lds
    s_add_u32 m0, s18, 107520
    s_add_u32 s20, s19, 65536
    buffer_load_dwordx4 v3, s[8:11], s20 offen  lds
    s_add_u32 m0, s18, 114688
    s_add_u32 s20, s19, 131072
    buffer_load_dwordx4 v2, s[8:11], s20 offen  lds
    s_add_u32 m0, s18, 115712
    s_add_u32 s20, s19, 131072
    buffer_load_dwordx4 v3, s[8:11], s20 offen  lds
    s_add_u32 m0, s18, 122880
    s_add_u32 s20, s19, 196608
    buffer_load_dwordx4 v2, s[8:11], s20 offen  lds
    s_add_u32 m0, s18, 123904
    s_add_u32 s20, s19, 196608
    buffer_load_dwordx4 v3, s[8:11], s20 offen  lds
    s_add_u32 s19, s100, 3
    s_and_b32 s19, s19, 3
    s_lshl_b32 s19, s19, 9
    s_add_u32 m0, s18, 131072
    s_add_u32 s20, s19, 0
    buffer_load_dwordx4 v2, s[8:11], s20 offen  lds
    s_add_u32 m0, s18, 132096
    s_add_u32 s20, s19, 0
    buffer_load_dwordx4 v3, s[8:11], s20 offen  lds
    s_add_u32 m0, s18, 139264
    s_add_u32 s20, s19, 65536
    buffer_load_dwordx4 v2, s[8:11], s20 offen  lds
    s_add_u32 m0, s18, 140288
    s_add_u32 s20, s19, 65536
    buffer_load_dwordx4 v3, s[8:11], s20 offen  lds
    s_add_u32 m0, s18, 147456
    s_add_u32 s20, s19, 131072
    buffer_load_dwordx4 v2, s[8:11], s20 offen  lds
    s_add_u32 m0, s18, 148480
    s_add_u32 s20, s19, 131072
    buffer_load_dwordx4 v3, s[8:11], s20 offen  lds
    s_add_u32 m0, s18, 155648
    s_add_u32 s20, s19, 196608
    buffer_load_dwordx4 v2, s[8:11], s20 offen  lds
    s_add_u32 m0, s18, 156672
    s_add_u32 s20, s19, 196608
    buffer_load_dwordx4 v3, s[8:11], s20 offen  lds
    s_waitcnt vmcnt(8)
    s_barrier
    s_cmp_lg_u32 s3, 5
    s_cbranch_scc1 Lonly_274
    s_lshr_b32 s21, s4, 1
    s_lshl_b32 s21, s21, 5
    s_lshl_b32 s19, s5, 2
    s_add_u32 s21, s21, s19
    s_add_u32 s21, s21, 2048
    s_add_u32 s28, s58, 13107200
    s_addc_u32 s29, s59, 0
    s_mov_b32 s30, 16384
    s_mov_b32 s31, 0x00020000
    v_min_u32 v12, 0, v0
    v_lshlrev_b32 v12, 2, v12
    buffer_load_dword v16, v12, s[28:31], s21 offen sc1
Lonly_274:
    s_cmp_lg_u32 s3, 6
    s_cbranch_scc1 Lonly_275
    s_lshr_b32 s21, s4, 1
    s_lshl_b32 s21, s21, 7
    s_add_u32 s21, s21, 4096
    s_add_u32 s28, s58, 13107200
    s_addc_u32 s29, s59, 0
    s_mov_b32 s30, 16384
    s_mov_b32 s31, 0x00020000
    v_min_u32 v12, 7, v0
    v_lshlrev_b32 v12, 2, v12
    buffer_load_dword v16, v12, s[28:31], s21 offen sc1
Lonly_275:
    s_cmp_lg_u32 s3, 7
    s_cbranch_scc1 Lonly_276
    s_lshl_b32 s21, s4, 7
    s_add_u32 s21, s21, 12288
    s_add_u32 s28, s58, 13107200
    s_addc_u32 s29, s59, 0
    s_mov_b32 s30, 16384
    s_mov_b32 s31, 0x00020000
    v_min_u32 v12, 7, v0
    v_lshlrev_b32 v12, 2, v12
    buffer_load_dword v16, v12, s[28:31], s21 offen sc1
Lonly_276:
    s_lshl_b32 s21, s5, 8
    s_add_u32 s21, s21, 8192
    s_add_u32 s28, s58, 13107200
    s_addc_u32 s29, s59, 0
    s_mov_b32 s30, 16384
    s_mov_b32 s31, 0x00020000
    v_min_u32 v12, 43, v0
    v_lshlrev_b32 v12, 2, v12
    buffer_load_dword v17, v12, s[28:31], s21 offen sc1
    s_add_u32 s19, s100, 3
    s_and_b32 s19, s19, 3
    s_lshl_b32 s19, s19, 9
    s_add_u32 s19, s19, 2048
    s_add_u32 m0, s18, 0
    s_add_u32 s20, s19, 0
    buffer_load_dwordx4 v2, s[8:11], s20 offen  lds
    s_add_u32 m0, s18, 1024
    s_add_u32 s20, s19, 0
    buffer_load_dwordx4 v3, s[8:11], s20 offen  lds
    s_add_u32 m0, s18, 8192
    s_add_u32 s20, s19, 65536
    buffer_load_dwordx4 v2, s[8:11], s20 offen  lds
    s_add_u32 m0, s18, 9216
    s_add_u32 s20, s19, 65536
    buffer_load_dwordx4 v3, s[8:11], s20 offen  lds
    s_add_u32 m0, s18, 16384
    s_add_u32 s20, s19, 131072
    buffer_load_dwordx4 v2, s[8:11], s20 offen  lds
    s_add_u32 m0, s18, 17408
    s_add_u32 s20, s19, 131072
    buffer_load_dwordx4 v3, s[8:11], s20 offen  lds
    s_add_u32 m0, s18, 24576
    s_add_u32 s20, s19, 196608
    buffer_load_dwordx4 v2, s[8:11], s20 offen  lds
    s_add_u32 m0, s18, 25600
    s_add_u32 s20, s19, 196608
    buffer_load_dwordx4 v3, s[8:11], s20 offen  lds
    s_waitcnt vmcnt(0)
    s_waitcnt vmcnt(0)
    s_cmp_lg_u32 s3, 5
    s_cbranch_scc1 Lonly_277
    s_lshr_b32 s21, s4, 1
    s_lshl_b32 s21, s21, 5
    s_lshl_b32 s19, s5, 2
    s_add_u32 s21, s21, s19
    s_add_u32 s21, s21, 2048
    v_cmp_ne_u32 vcc, s62, v16
    s_nop 1
    s_cmp_eq_u64 vcc, 0
    s_cbranch_scc1 Lpok_278
    s_add_u32 s28, s58, 13107200
    s_addc_u32 s29, s59, 0
    s_mov_b32 s30, 16384
    s_mov_b32 s31, 0x00020000
    s_mov_b64 s[32:33], exec
    s_mov_b32 exec_lo, 0x1
    s_mov_b32 exec_hi, 0x0
    v_lshlrev_b32 v12, 2, v0
    s_mov_b32 s34, 0
Lw_279:
    buffer_load_dword v13, v12, s[28:31], s21 offen sc1
    s_waitcnt vmcnt(0)
    v_cmp_ne_u32 vcc, s62, v13
    s_nop 1
    s_cmp_eq_u64 vcc, 0
    s_cbranch_scc1 Lwok_280
    s_add_u32 s34, s34, 1
    s_cmp_gt_u32 s34, 16384
    s_cbranch_scc1 Lwok_280
    s_sleep 1
    s_branch Lw_279
Lwok_280:
    s_mov_b64 exec, s[32:33]
Lpok_278:
Lonly_277:
    s_cmp_lg_u32 s3, 6
    s_cbranch_scc1 Lonly_281
    s_lshr_b32 s21, s4, 1
    s_lshl_b32 s21, s21, 7
    s_add_u32 s21, s21, 4096
    v_cmp_ne_u32 vcc, s62, v16
    s_nop 1
    s_cmp_eq_u64 vcc, 0
    s_cbranch_scc1 Lpok_282
    s_add_u32 s28, s58, 13107200
    s_addc_u32 s29, s59, 0
    s_mov_b32 s30, 16384
    s_mov_b32 s31, 0x00020000
    s_mov_b64 s[32:33], exec
    s_mov_b32 exec_lo, 0xff
    s_mov_b32 exec_hi, 0x0
    v_lshlrev_b32 v12, 2, v0
    s_mov_b32 s34, 0
Lw_283:
    buffer_load_dword v13, v12, s[28:31], s21 offen sc1
    s_waitcnt vmcnt(0)
    v_cmp_ne_u32 vcc, s62, v13
    s_nop 1
    s_cmp_eq_u64 vcc, 0
    s_cbranch_scc1 Lwok_284
    s_add_u32 s34, s34, 1
    s_cmp_gt_u32 s34, 16384
    s_cbranch_scc1 Lwok_284
    s_sleep 1
    s_branch Lw_283
Lwok_284:
    s_mov_b64 exec, s[32:33]
Lpok_282:
Lonly_281:
    s_cmp_lg_u32 s3, 7
    s_cbranch_scc1 Lonly_285
    s_lshl_b32 s21, s4, 7
    s_add_u32 s21, s21, 12288
    v_cmp_ne_u32 vcc, s62, v16
    s_nop 1
    s_cmp_eq_u64 vcc, 0
    s_cbranch_scc1 Lpok_286
    s_add_u32 s28, s58, 13107200
    s_addc_u32 s29, s59, 0
    s_mov_b32 s30, 16384
    s_mov_b32 s31, 0x00020000
    s_mov_b64 s[32:33], exec
    s_mov_b32 exec_lo, 0xff
    s_mov_b32 exec_hi, 0x0
    v_lshlrev_b32 v12, 2, v0
    s_mov_b32 s34, 0
Lw_287:
    buffer_load_dword v13, v12, s[28:31], s21 offen sc1
    s_waitcnt vmcnt(0)
    v_cmp_ne_u32 vcc, s62, v13
    s_nop 1
    s_cmp_eq_u64 vcc, 0
    s_cbranch_scc1 Lwok_288
    s_add_u32 s34, s34, 1
    s_cmp_gt_u32 s34, 16384
    s_cbranch_scc1 Lwok_288
    s_sleep 1
    s_branch Lw_287
Lwok_288:
    s_mov_b64 exec, s[32:33]
Lpok_286:
Lonly_285:
    s_lshl_b32 s21, s5, 8
    s_add_u32 s21, s21, 8192
    v_cmp_ne_u32 vcc, s62, v17
    s_nop 1
    s_cmp_eq_u64 vcc, 0
    s_cbranch_scc1 Lpok_289
    s_add_u32 s28, s58, 13107200
    s_addc_u32 s29, s59, 0
    s_mov_b32 s30, 16384
    s_mov_b32 s31, 0x00020000
    s_mov_b64 s[32:33], exec
    s_mov_b32 exec_lo, 0xffffffff
    s_mov_b32 exec_hi, 0xfff
    v_lshlrev_b32 v12, 2, v0
    s_mov_b32 s34, 0
Lw_290:
    buffer_load_dword v13, v12, s[28:31], s21 offen sc1
    s_waitcnt vmcnt(0)
    v_cmp_ne_u32 vcc, s62, v13
    s_nop 1
    s_cmp_eq_u64 vcc, 0
    s_cbranch_scc1 Lwok_291
    s_add_u32 s34, s34, 1
    s_cmp_gt_u32 s34, 16384
    s_cbranch_scc1 Lwok_291
    s_sleep 1
    s_branch Lw_290
Lwok_291:
    s_mov_b64 exec, s[32:33]
Lpok_289:
    s_barrier
    s_sub_u32 s16, s3, 4
    s_mul_i32 s17, s5, 225280
    s_add_u32 s8, s58, 13631488
    s_addc_u32 s9, s59, 0
    s_add_u32 s8, s8, s17
    s_addc_u32 s9, s9, 0
    s_mov_b32 s10, 225280
    s_mov_b32 s11, 0x00020000
    s_mul_i32 s18, s16, 5120
    v_lshlrev_b32 v2, 4, v0
    v_add_u32 v2, s18, v2
    s_mov_b32 s20, 0
    s_add_u32 m0, s18, 32768
    s_nop 0
    buffer_load_dwordx4 v2, s[8:11], s20 offen offset:0 sc1 lds
    buffer_load_dwordx4 v2, s[8:11], s20 offen offset:1024 sc1 lds
    buffer_load_dwordx4 v2, s[8:11], s20 offen offset:2048 sc1 lds
    buffer_load_dwordx4 v2, s[8:11], s20 offen offset:3072 sc1 lds
    s_add_u32 m0, s18, 36864
    s_add_u32 s20, s20, 4096
    buffer_load_dwordx4 v2, s[8:11], s20 offen sc1 lds
    s_mov_b32 s20, 20480
    s_add_u32 m0, s18, 53248
    s_nop 0
    buffer_load_dwordx4 v2, s[8:11], s20 offen offset:0 sc1 lds
    buffer_load_dwordx4 v2, s[8:11], s20 offen offset:1024 sc1 lds
    buffer_load_dwordx4 v2, s[8:11], s20 offen offset:2048 sc1 lds
    buffer_load_dwordx4 v2, s[8:11], s20 offen offset:3072 sc1 lds
    s_add_u32 m0, s18, 57344
    s_add_u32 s20, s20, 4096
    buffer_load_dwordx4 v2, s[8:11], s20 offen sc1 lds
    s_mov_b32 s20, 40960
    s_add_u32 m0, s18, 73728
    s_nop 0
    buffer_load_dwordx4 v2, s[8:11], s20 offen offset:0 sc1 lds
    buffer_load_dwordx4 v2, s[8:11], s20 offen offset:1024 sc1 lds
    buffer_load_dwordx4 v2, s[8:11], s20 offen offset:2048 sc1 lds
    buffer_load_dwordx4 v2, s[8:11], s20 offen offset:3072 sc1 lds
    s_add_u32 m0, s18, 77824
    s_add_u32 s20, s20, 4096
    buffer_load_dwordx4 v2, s[8:11], s20 offen sc1 lds
    s_barrier
    s_waitcnt vmcnt(10)
    s_barrier
    s_mov_b32 s20, 61440
    s_add_u32 m0, s18, 94208
    s_nop 0
    buffer_load_dwordx4 v2, s[8:11], s20 offen offset:0 sc1 lds
    buffer_load_dwordx4 v2, s[8:11], s20 offen offset:1024 sc1 lds
    buffer_load_dwordx4 v2, s[8:11], s20 offen offset:2048 sc1 lds
    buffer_load_dwordx4 v2, s[8:11], s20 offen offset:3072 sc1 lds
    s_add_u32 m0, s18, 98304
    s_add_u32 s20, s20, 4096
    buffer_load_dwordx4 v2, s[8:11], s20 offen sc1 lds
    s_waitcnt vmcnt(10)
    s_barrier
    s_mov_b32 s20, 81920
    s_add_u32 m0, s18, 114688
    s_nop 0
    buffer_load_dwordx4 v2, s[8:11], s20 offen offset:0 sc1 lds
    buffer_load_dwordx4 v2, s[8:11], s20 offen offset:1024 sc1 lds
    buffer_load_dwordx4 v2, s[8:11], s20 offen offset:2048 sc1 lds
    buffer_load_dwordx4 v2, s[8:11], s20 offen offset:3072 sc1 lds
    s_add_u32 m0, s18, 118784
    s_add_u32 s20, s20, 4096
    buffer_load_dwordx4 v2, s[8:11], s20 offen sc1 lds
    s_waitcnt vmcnt(10)
    s_barrier
    s_mov_b32 s20, 102400
    s_add_u32 m0, s18, 135168
    s_nop 0
    buffer_load_dwordx4 v2, s[8:11], s20 offen offset:0 sc1 lds
    buffer_load_dwordx4 v2, s[8:11], s20 offen offset:1024 sc1 lds
    buffer_load_dwordx4 v2, s[8:11], s20 offen offset:2048 sc1 lds
    buffer_load_dwordx4 v2, s[8:11], s20 offen offset:3072 sc1 lds
    s_add_u32 m0, s18, 139264
    s_add_u32 s20, s20, 4096
    buffer_load_dwordx4 v2, s[8:11], s20 offen sc1 lds
    s_waitcnt vmcnt(10)
    s_barrier
    s_mov_b32 s20, 122880
    s_add_u32 m0, s18, 32768
    s_nop 0
    buffer_load_dwordx4 v2, s[8:11], s20 offen offset:0 sc1 lds
    buffer_load_dwordx4 v2, s[8:11], s20 offen offset:1024 sc1 lds
    buffer_load_dwordx4 v2, s[8:11], s20 offen offset:2048 sc1 lds
    buffer_load_dwordx4 v2, s[8:11], s20 offen offset:3072 sc1 lds
    s_add_u32 m0, s18, 36864
    s_add_u32 s20, s20, 4096
    buffer_load_dwordx4 v2, s[8:11], s20 offen sc1 lds
    s_waitcnt vmcnt(10)
    s_barrier
    s_mov_b32 s20, 143360
    s_add_u32 m0, s18, 53248
    s_nop 0
    buffer_load_dwordx4 v2, s[8:11], s20 offen offset:0 sc1 lds
    buffer_load_dwordx4 v2, s[8:11], s20 offen offset:1024 sc1 lds
    buffer_load_dwordx4 v2, s[8:11], s20 offen offset:2048 sc1 lds
    buffer_load_dwordx4 v2, s[8:11], s20 offen offset:3072 sc1 lds
    s_add_u32 m0, s18, 57344
    s_add_u32 s20, s20, 4096
    buffer_load_dwordx4 v2, s[8:11], s20 offen sc1 lds
    s_waitcnt vmcnt(10)
    s_barrier
    s_mov_b32 s20, 163840
    s_add_u32 m0, s18, 73728
    s_nop 0
    buffer_load_dwordx4 v2, s[8:11], s20 offen offset:0 sc1 lds
    buffer_load_dwordx4 v2, s[8:11], s20 offen offset:1024 sc1 lds
    buffer_load_dwordx4 v2, s[8:11], s20 offen offset:2048 sc1 lds
    buffer_load_dwordx4 v2, s[8:11], s20 offen offset:3072 sc1 lds
    s_add_u32 m0, s18, 77824
    s_add_u32 s20, s20, 4096
    buffer_load_dwordx4 v2, s[8:11], s20 offen sc1 lds
    s_waitcnt vmcnt(10)
    s_barrier
    s_mov_b32 s20, 184320
    s_add_u32 m0, s18, 94208
    s_nop 0
    buffer_load_dwordx4 v2, s[8:11], s20 offen offset:0 sc1 lds
    buffer_load_dwordx4 v2, s[8:11], s20 offen offset:1024 sc1 lds
    buffer_load_dwordx4 v2, s[8:11], s20 offen offset:2048 sc1 lds
    buffer_load_dwordx4 v2, s[8:11], s20 offen offset:3072 sc1 lds
    s_add_u32 m0, s18, 98304
    s_add_u32 s20, s20, 4096
    buffer_load_dwordx4 v2, s[8:11], s20 offen sc1 lds
    s_waitcnt vmcnt(10)
    s_barrier
    s_mov_b32 s20, 204800
    s_add_u32 m0, s18, 114688
    s_nop 0
    buffer_load_dwordx4 v2, s[8:11], s20 offen offset:0 sc1 lds
    buffer_load_dwordx4 v2, s[8:11], s20 offen offset:1024 sc1 lds
    buffer_load_dwordx4 v2, s[8:11], s20 offen offset:2048 sc1 lds
    buffer_load_dwordx4 v2, s[8:11], s20 offen offset:3072 sc1 lds
    s_add_u32 m0, s18, 118784
    s_add_u32 s20, s20, 4096
    buffer_load_dwordx4 v2, s[8:11], s20 offen sc1 lds
    s_waitcnt vmcnt(10)
    s_barrier
    s_waitcnt vmcnt(5)
    s_barrier
    s_waitcnt vmcnt(0)
    s_barrier
    s_barrier
Lfin_218:
Lp1exit_149:
Lexit_147:
    s_endpgm

.section .rodata,"a"
.p2align 6
.amdhsa_kernel gated_mix__sliding_local_dilated__mixer_gmlp__prompt_kernel
  .amdhsa_next_free_vgpr 256
  .amdhsa_next_free_sgpr 102
  .amdhsa_accum_offset 256
  .amdhsa_group_segment_fixed_size 0
  .amdhsa_kernarg_size 96
  .amdhsa_user_sgpr_count 2
  .amdhsa_user_sgpr_kernarg_segment_ptr 1
  .amdhsa_system_sgpr_workgroup_id_x 1
  .amdhsa_float_denorm_mode_32 3
.end_amdhsa_kernel
```
